```python
import torch

def _softmax(x, axis=-1):
    return torch.softmax(x, dim=axis)
def _gelu(x):
    return torch.nn.functional.gelu(x, approximate="tanh")
def _silu(x):
    return torch.nn.functional.silu(x)
def _sigmoid(x):
    return torch.sigmoid(x)
def _layernorm(x, axis=-1, eps=1e-5):
    m = x.mean(dim=axis, keepdim=True)
    v = x.var(dim=axis, keepdim=True, unbiased=False)
    return (x - m) / torch.sqrt(v + eps)
def _scatter_add(tgt, idx, src, axis=0):
    return tgt.clone().index_add_(axis, idx, src)
def _segment_sum(src, seg, n):
    out = torch.zeros((n,) + src.shape[1:], dtype=src.dtype)
    return out.index_add_(0, seg, src)
def _pad(x, pw):
    flat = tuple(v for pair in reversed(pw) for v in pair)
    return torch.nn.functional.pad(x, flat)

kernel_name = 'concat_heads__ssm_conv_s4__spectral_gfnet__prompt'

def setup_inputs():

    _w = (lambda a: (lambda t: t.to(torch.bfloat16) if t.is_floating_point() else t)(torch.as_tensor(a)))
    def _A_setup():
        B, L, D, N = 1, 2048, 1024, 128
        A_re = -(lambda _x: torch.exp(torch.as_tensor(_x)))((lambda *s: torch.randn(*s, dtype=torch.bfloat16) * 3.2)(D, N))
        A_im = torch.pi * (lambda *s: torch.randn(*s, dtype=torch.bfloat16) * 0.05)(D, N)
        B_re = (lambda *s: torch.randn(*s, dtype=torch.bfloat16) * 0.1)(D, N)
        B_im = (lambda *s: torch.randn(*s, dtype=torch.bfloat16) * 0.1)(D, N)
        C_re = (lambda *s: torch.randn(*s, dtype=torch.bfloat16) * 0.1)(D, N)
        C_im = (lambda *s: torch.randn(*s, dtype=torch.bfloat16) * 0.1)(D, N)
        log_dt = (lambda *s: torch.randn(*s, dtype=torch.bfloat16) * 0.05)(D) * 0.5 - 4.0
        Dskip = (lambda *s: torch.randn(*s, dtype=torch.bfloat16) * 0.05)(D)
        return {
            "u": _w((lambda *s: torch.randn(*s, dtype=torch.bfloat16) * 0.05)(B, L, D)),
            "A_re": _w(A_re),
            "A_im": _w(A_im),
            "B_re": _w(B_re),
            "B_im": _w(B_im),
            "C_re": _w(C_re),
            "C_im": _w(C_im),
            "log_dt": _w(log_dt),
            "Dskip": _w(Dskip),
        }
    _A_in = _A_setup()

    def _B_setup():
        B, S, D = 1, 2048, 1024
        Df = D // 2 + 1
        return {
            "x": _w((lambda *s: torch.randn(*s, dtype=torch.bfloat16) * 0.05)(B, S, D)),
            "w_r": _w((lambda *s: torch.randn(*s, dtype=torch.bfloat16) * 0.8)(S, Df) * 0.02),
            "w_i": _w((lambda *s: torch.randn(*s, dtype=torch.bfloat16) * 0.8)(S, Df) * 0.02),
        }
    _B_in = _B_setup()

    return {
        "A_u": _A_in["u"],
        "A_A_re": _A_in["A_re"],
        "A_A_im": _A_in["A_im"],
        "A_B_re": _A_in["B_re"],
        "A_B_im": _A_in["B_im"],
        "A_C_re": _A_in["C_re"],
        "A_C_im": _A_in["C_im"],
        "A_log_dt": _A_in["log_dt"],
        "A_Dskip": _A_in["Dskip"],
        "B_x": _B_in["x"],
        "B_w_r": _B_in["w_r"],
        "B_w_i": _B_in["w_i"],
    }

def reference(A_u, A_A_re, A_A_im, A_B_re, A_B_im, A_C_re, A_C_im, A_log_dt, A_Dskip, B_x, B_w_r, B_w_i):
    def _A_ref(u, A_re, A_im, B_re, B_im, C_re, C_im, log_dt, Dskip):
        Bsz, L, D = u.shape
        dt = torch.exp(log_dt)[:, None]
        A = A_re + 1j * A_im
        Bc = B_re + 1j * B_im
        Cc = C_re + 1j * C_im
        logdA = dt * A
        dB = dt * Bc
        l = (lambda x, dt: x.to(dt))(torch.arange(L), A_re.dtype)
        P = torch.exp(logdA[:, :, None] * l[None, None, :])
        K = torch.einsum("dn,dnl,dn->dl", Cc, P, dB).real
        L2 = 2 * L
        Kp = _pad(K, ((0, 0), (0, L)))
        up = (lambda x, *d: x.permute(*d))(u, 0, 2, 1)
        up = _pad(up, ((0, 0), (0, 0), (0, L)))
        Kf = (lambda x, axes=(-2,-1): torch.fft.rfft2(x.float(), dim=axes))(Kp[:, None, :], axes=(-2, -1))
        Uf = (lambda x, axes=(-2,-1): torch.fft.rfft2(x.float(), dim=axes))(up[:, :, None, :], axes=(-2, -1))
        Yf = Uf * Kf[None, :, :, :]
        y = (lambda x, s, axes=(-2,-1): torch.fft.irfft2(x, s=s, dim=axes).to(torch.bfloat16))(Yf, (1, L2), axes=(-2, -1))[:, :, 0, :L]
        y = (lambda x, *d: x.permute(*d))(y, 0, 2, 1) + u * Dskip[None, None, :]
        return y

    def _B_ref(x, w_r, w_i):
        B, S, D = x.shape
        X = (lambda x, axes=(-2,-1): torch.fft.rfft2(x.float(), dim=axes))(x, axes=(-2, -1))
        W = w_r + 1j * w_i
        X = X * W
        y = (lambda x, s, axes=(-2,-1): torch.fft.irfft2(x, s=s, dim=axes).to(torch.bfloat16))(X, (S, D), axes=(-2, -1))
        return y

    a = _A_ref(A_u, A_A_re, A_A_im, A_B_re, A_B_im, A_C_re, A_C_im, A_log_dt, A_Dskip)
    b = _B_ref(B_x, B_w_r, B_w_i)
    return torch.concatenate([a, b], axis=-1)
```

```asm
; @launch kernel=k1_kernel grid=(1424,1,1) block=(256,1,1) lds=37120
; @launch kernel=k2_kernel grid=(769,1,1) block=(256,1,1) lds=38912
; @launch kernel=k3_kernel grid=(512,1,1) block=(256,1,1) lds=51840
.amdgcn_target "amdgcn-amd-amdhsa--gfx950"
.text
.globl k1_kernel
.p2align 8
.type k1_kernel,@function
k1_kernel:

    s_cmp_lt_u32 s2, 144
    s_cbranch_scc1 k1_kernel_r0
    s_cmp_lt_u32 s2, 400
    s_cbranch_scc1 k1_kernel_r1
    s_cmp_lt_u32 s2, 912
    s_cbranch_scc1 k1_kernel_r2
    s_cmp_lt_u32 s2, 1424
    s_cbranch_scc1 k1_kernel_r3
    s_endpgm
k1_kernel_r0:
    s_cmp_ge_u32 s2, 144
    s_cbranch_scc1 k1_kernel_b0_end
    s_load_dwordx2 s[16:17], s[0:1], 80
    s_load_dwordx2 s[18:19], s[0:1], 88
    s_load_dwordx2 s[24:25], s[0:1], 112
    s_and_b32 s26, s2, 15
    s_lshr_b32 s27, s2, 4
    v_and_b32 v1, 63, v0
    v_lshrrev_b32 v2, 6, v0
    s_waitcnt lgkmcnt(0)
    s_mov_b32 s4, s16
    s_and_b32 s5, s17, 0xffff
    s_mov_b32 s6, 2101248
    s_mov_b32 s7, 0x00020000
    s_mov_b32 s8, s18
    s_and_b32 s9, s19, 0xffff
    s_mov_b32 s10, 2101248
    s_mov_b32 s11, 0x00020000
    s_add_u32 s12, s24, 18874368
    s_addc_u32 s13, s25, 0
    s_and_b32 s13, s13, 0xffff
    s_mov_b32 s14, 4202496
    s_mov_b32 s15, 0x00020000
    s_mul_i32 s28, s26, 1026
    s_lshl_b32 s29, s27, 7
    s_add_u32 s28, s28, s29
    v_mul_u32_u24 v3, 16416, v2
    v_lshl_add_u32 v3, v1, 1, v3
    v_mul_u32_u24 v4, 516, v1
    v_lshl_add_u32 v4, v2, 6, v4
    s_add_u32 s30, s28, 0
    buffer_load_ushort v8, v3, s[4:7], s30 offen
    buffer_load_ushort v40, v3, s[8:11], s30 offen
    s_add_u32 s30, s28, 65664
    buffer_load_ushort v9, v3, s[4:7], s30 offen
    buffer_load_ushort v41, v3, s[8:11], s30 offen
    s_add_u32 s30, s28, 131328
    buffer_load_ushort v10, v3, s[4:7], s30 offen
    buffer_load_ushort v42, v3, s[8:11], s30 offen
    s_add_u32 s30, s28, 196992
    buffer_load_ushort v11, v3, s[4:7], s30 offen
    buffer_load_ushort v43, v3, s[8:11], s30 offen
    s_add_u32 s30, s28, 262656
    buffer_load_ushort v12, v3, s[4:7], s30 offen
    buffer_load_ushort v44, v3, s[8:11], s30 offen
    s_add_u32 s30, s28, 328320
    buffer_load_ushort v13, v3, s[4:7], s30 offen
    buffer_load_ushort v45, v3, s[8:11], s30 offen
    s_add_u32 s30, s28, 393984
    buffer_load_ushort v14, v3, s[4:7], s30 offen
    buffer_load_ushort v46, v3, s[8:11], s30 offen
    s_add_u32 s30, s28, 459648
    buffer_load_ushort v15, v3, s[4:7], s30 offen
    buffer_load_ushort v47, v3, s[8:11], s30 offen
    s_add_u32 s30, s28, 525312
    buffer_load_ushort v16, v3, s[4:7], s30 offen
    buffer_load_ushort v48, v3, s[8:11], s30 offen
    s_add_u32 s30, s28, 590976
    buffer_load_ushort v17, v3, s[4:7], s30 offen
    buffer_load_ushort v49, v3, s[8:11], s30 offen
    s_add_u32 s30, s28, 656640
    buffer_load_ushort v18, v3, s[4:7], s30 offen
    buffer_load_ushort v50, v3, s[8:11], s30 offen
    s_add_u32 s30, s28, 722304
    buffer_load_ushort v19, v3, s[4:7], s30 offen
    buffer_load_ushort v51, v3, s[8:11], s30 offen
    s_add_u32 s30, s28, 787968
    buffer_load_ushort v20, v3, s[4:7], s30 offen
    buffer_load_ushort v52, v3, s[8:11], s30 offen
    s_add_u32 s30, s28, 853632
    buffer_load_ushort v21, v3, s[4:7], s30 offen
    buffer_load_ushort v53, v3, s[8:11], s30 offen
    s_add_u32 s30, s28, 919296
    buffer_load_ushort v22, v3, s[4:7], s30 offen
    buffer_load_ushort v54, v3, s[8:11], s30 offen
    s_add_u32 s30, s28, 984960
    buffer_load_ushort v23, v3, s[4:7], s30 offen
    buffer_load_ushort v55, v3, s[8:11], s30 offen
    s_add_u32 s30, s28, 1050624
    buffer_load_ushort v24, v3, s[4:7], s30 offen
    buffer_load_ushort v56, v3, s[8:11], s30 offen
    s_add_u32 s30, s28, 1116288
    buffer_load_ushort v25, v3, s[4:7], s30 offen
    buffer_load_ushort v57, v3, s[8:11], s30 offen
    s_add_u32 s30, s28, 1181952
    buffer_load_ushort v26, v3, s[4:7], s30 offen
    buffer_load_ushort v58, v3, s[8:11], s30 offen
    s_add_u32 s30, s28, 1247616
    buffer_load_ushort v27, v3, s[4:7], s30 offen
    buffer_load_ushort v59, v3, s[8:11], s30 offen
    s_add_u32 s30, s28, 1313280
    buffer_load_ushort v28, v3, s[4:7], s30 offen
    buffer_load_ushort v60, v3, s[8:11], s30 offen
    s_add_u32 s30, s28, 1378944
    buffer_load_ushort v29, v3, s[4:7], s30 offen
    buffer_load_ushort v61, v3, s[8:11], s30 offen
    s_add_u32 s30, s28, 1444608
    buffer_load_ushort v30, v3, s[4:7], s30 offen
    buffer_load_ushort v62, v3, s[8:11], s30 offen
    s_add_u32 s30, s28, 1510272
    buffer_load_ushort v31, v3, s[4:7], s30 offen
    buffer_load_ushort v63, v3, s[8:11], s30 offen
    s_add_u32 s30, s28, 1575936
    buffer_load_ushort v32, v3, s[4:7], s30 offen
    buffer_load_ushort v64, v3, s[8:11], s30 offen
    s_add_u32 s30, s28, 1641600
    buffer_load_ushort v33, v3, s[4:7], s30 offen
    buffer_load_ushort v65, v3, s[8:11], s30 offen
    s_add_u32 s30, s28, 1707264
    buffer_load_ushort v34, v3, s[4:7], s30 offen
    buffer_load_ushort v66, v3, s[8:11], s30 offen
    s_add_u32 s30, s28, 1772928
    buffer_load_ushort v35, v3, s[4:7], s30 offen
    buffer_load_ushort v67, v3, s[8:11], s30 offen
    s_add_u32 s30, s28, 1838592
    buffer_load_ushort v36, v3, s[4:7], s30 offen
    buffer_load_ushort v68, v3, s[8:11], s30 offen
    s_add_u32 s30, s28, 1904256
    buffer_load_ushort v37, v3, s[4:7], s30 offen
    buffer_load_ushort v69, v3, s[8:11], s30 offen
    s_add_u32 s30, s28, 1969920
    buffer_load_ushort v38, v3, s[4:7], s30 offen
    buffer_load_ushort v70, v3, s[8:11], s30 offen
    s_add_u32 s30, s28, 2035584
    buffer_load_ushort v39, v3, s[4:7], s30 offen
    buffer_load_ushort v71, v3, s[8:11], s30 offen
    s_waitcnt vmcnt(62)
    v_lshl_or_b32 v8, v40, 16, v8
    ds_write_b32 v4, v8 offset:0
    s_waitcnt vmcnt(60)
    v_lshl_or_b32 v9, v41, 16, v9
    ds_write_b32 v4, v9 offset:256
    s_waitcnt vmcnt(58)
    v_lshl_or_b32 v10, v42, 16, v10
    ds_write_b32 v4, v10 offset:32
    s_waitcnt vmcnt(56)
    v_lshl_or_b32 v11, v43, 16, v11
    ds_write_b32 v4, v11 offset:288
    s_waitcnt vmcnt(54)
    v_lshl_or_b32 v12, v44, 16, v12
    ds_write_b32 v4, v12 offset:4
    s_waitcnt vmcnt(52)
    v_lshl_or_b32 v13, v45, 16, v13
    ds_write_b32 v4, v13 offset:260
    s_waitcnt vmcnt(50)
    v_lshl_or_b32 v14, v46, 16, v14
    ds_write_b32 v4, v14 offset:36
    s_waitcnt vmcnt(48)
    v_lshl_or_b32 v15, v47, 16, v15
    ds_write_b32 v4, v15 offset:292
    s_waitcnt vmcnt(46)
    v_lshl_or_b32 v16, v48, 16, v16
    ds_write_b32 v4, v16 offset:8
    s_waitcnt vmcnt(44)
    v_lshl_or_b32 v17, v49, 16, v17
    ds_write_b32 v4, v17 offset:264
    s_waitcnt vmcnt(42)
    v_lshl_or_b32 v18, v50, 16, v18
    ds_write_b32 v4, v18 offset:40
    s_waitcnt vmcnt(40)
    v_lshl_or_b32 v19, v51, 16, v19
    ds_write_b32 v4, v19 offset:296
    s_waitcnt vmcnt(38)
    v_lshl_or_b32 v20, v52, 16, v20
    ds_write_b32 v4, v20 offset:12
    s_waitcnt vmcnt(36)
    v_lshl_or_b32 v21, v53, 16, v21
    ds_write_b32 v4, v21 offset:268
    s_waitcnt vmcnt(34)
    v_lshl_or_b32 v22, v54, 16, v22
    ds_write_b32 v4, v22 offset:44
    s_waitcnt vmcnt(32)
    v_lshl_or_b32 v23, v55, 16, v23
    ds_write_b32 v4, v23 offset:300
    s_waitcnt vmcnt(30)
    v_lshl_or_b32 v24, v56, 16, v24
    ds_write_b32 v4, v24 offset:16
    s_waitcnt vmcnt(28)
    v_lshl_or_b32 v25, v57, 16, v25
    ds_write_b32 v4, v25 offset:272
    s_waitcnt vmcnt(26)
    v_lshl_or_b32 v26, v58, 16, v26
    ds_write_b32 v4, v26 offset:48
    s_waitcnt vmcnt(24)
    v_lshl_or_b32 v27, v59, 16, v27
    ds_write_b32 v4, v27 offset:304
    s_waitcnt vmcnt(22)
    v_lshl_or_b32 v28, v60, 16, v28
    ds_write_b32 v4, v28 offset:20
    s_waitcnt vmcnt(20)
    v_lshl_or_b32 v29, v61, 16, v29
    ds_write_b32 v4, v29 offset:276
    s_waitcnt vmcnt(18)
    v_lshl_or_b32 v30, v62, 16, v30
    ds_write_b32 v4, v30 offset:52
    s_waitcnt vmcnt(16)
    v_lshl_or_b32 v31, v63, 16, v31
    ds_write_b32 v4, v31 offset:308
    s_waitcnt vmcnt(14)
    v_lshl_or_b32 v32, v64, 16, v32
    ds_write_b32 v4, v32 offset:24
    s_waitcnt vmcnt(12)
    v_lshl_or_b32 v33, v65, 16, v33
    ds_write_b32 v4, v33 offset:280
    s_waitcnt vmcnt(10)
    v_lshl_or_b32 v34, v66, 16, v34
    ds_write_b32 v4, v34 offset:56
    s_waitcnt vmcnt(8)
    v_lshl_or_b32 v35, v67, 16, v35
    ds_write_b32 v4, v35 offset:312
    s_waitcnt vmcnt(6)
    v_lshl_or_b32 v36, v68, 16, v36
    ds_write_b32 v4, v36 offset:28
    s_waitcnt vmcnt(4)
    v_lshl_or_b32 v37, v69, 16, v37
    ds_write_b32 v4, v37 offset:284
    s_waitcnt vmcnt(2)
    v_lshl_or_b32 v38, v70, 16, v38
    ds_write_b32 v4, v38 offset:60
    s_waitcnt vmcnt(0)
    v_lshl_or_b32 v39, v71, 16, v39
    ds_write_b32 v4, v39 offset:316
    s_waitcnt lgkmcnt(0)
    s_barrier
    v_lshrrev_b32 v7, 5, v0
    v_and_b32 v24, 31, v0
    v_mul_u32_u24 v5, 516, v7
    v_lshl_add_u32 v5, v24, 4, v5
    v_lshlrev_b32 v6, 13, v7
    v_lshl_add_u32 v6, v24, 4, v6
    s_lshl_b32 s28, s27, 19
    s_lshl_b32 s29, s26, 9
    s_add_u32 s28, s28, s29
    ds_read_b128 v[32:35], v5 offset:0
    ds_read_b128 v[36:39], v5 offset:4128
    ds_read_b128 v[40:43], v5 offset:8256
    ds_read_b128 v[44:47], v5 offset:12384
    ds_read_b128 v[48:51], v5 offset:16512
    ds_read_b128 v[52:55], v5 offset:20640
    ds_read_b128 v[56:59], v5 offset:24768
    ds_read_b128 v[60:63], v5 offset:28896
    s_waitcnt lgkmcnt(0)
    s_add_u32 s30, s28, 0
    buffer_store_dwordx4 v[32:35], v6, s[12:15], s30 offen
    s_add_u32 s30, s28, 65536
    buffer_store_dwordx4 v[36:39], v6, s[12:15], s30 offen
    s_add_u32 s30, s28, 131072
    buffer_store_dwordx4 v[40:43], v6, s[12:15], s30 offen
    s_add_u32 s30, s28, 196608
    buffer_store_dwordx4 v[44:47], v6, s[12:15], s30 offen
    s_add_u32 s30, s28, 262144
    buffer_store_dwordx4 v[48:51], v6, s[12:15], s30 offen
    s_add_u32 s30, s28, 327680
    buffer_store_dwordx4 v[52:55], v6, s[12:15], s30 offen
    s_add_u32 s30, s28, 393216
    buffer_store_dwordx4 v[56:59], v6, s[12:15], s30 offen
    s_add_u32 s30, s28, 458752
    buffer_store_dwordx4 v[60:63], v6, s[12:15], s30 offen
k1_kernel_b0_end:
    s_endpgm
k1_kernel_r1:
    s_sub_u32 s2, s2, 144
    s_cmp_ge_u32 s2, 256
    s_cbranch_scc1 k1_kernel_b1_end
    s_load_dwordx2 s[16:17], s[0:1], 72
    s_load_dwordx2 s[18:19], s[0:1], 112
    s_mov_b32 s12, 0x3f3504f3
    s_mov_b32 s13, 0x3f3504f3
    s_mov_b32 s14, 0x3f6c835e
    s_mov_b32 s15, 0x3ec3ef15
    v_and_b32 v1, 63, v0
    v_lshrrev_b32 v2, 6, v0
    v_mul_u32_u24 v80, 9280, v2
    s_waitcnt lgkmcnt(0)
    s_mov_b32 s4, s16
    s_and_b32 s5, s17, 0xffff
    s_mov_b32 s6, 4194304
    s_mov_b32 s7, 0x00020000
    s_mov_b32 s8, s18
    s_and_b32 s9, s19, 0xffff
    s_mov_b32 s10, 8404992
    s_mov_b32 s11, 0x00020000
    s_lshl_b32 s20, s2, 14
    v_lshlrev_b32 v81, 12, v2
    v_lshl_add_u32 v81, v1, 2, v81
    buffer_load_dword v9, v81, s[4:7], s20 offen offset:0
    buffer_load_dword v11, v81, s[4:7], s20 offen offset:256
    buffer_load_dword v13, v81, s[4:7], s20 offen offset:512
    buffer_load_dword v15, v81, s[4:7], s20 offen offset:768
    buffer_load_dword v17, v81, s[4:7], s20 offen offset:1024
    buffer_load_dword v19, v81, s[4:7], s20 offen offset:1280
    buffer_load_dword v21, v81, s[4:7], s20 offen offset:1536
    buffer_load_dword v23, v81, s[4:7], s20 offen offset:1792
    buffer_load_dword v25, v81, s[4:7], s20 offen offset:2048
    buffer_load_dword v27, v81, s[4:7], s20 offen offset:2304
    buffer_load_dword v29, v81, s[4:7], s20 offen offset:2560
    buffer_load_dword v31, v81, s[4:7], s20 offen offset:2816
    buffer_load_dword v33, v81, s[4:7], s20 offen offset:3072
    buffer_load_dword v35, v81, s[4:7], s20 offen offset:3328
    buffer_load_dword v37, v81, s[4:7], s20 offen offset:3584
    buffer_load_dword v39, v81, s[4:7], s20 offen offset:3840
    v_cvt_f32_u32 v72, v1
    v_mul_f32 v73, 0xbb000000, v72
    v_cos_f32 v44, v73
    v_sin_f32 v45, v73
    v_mul_f32 v73, 0xbb800000, v72
    v_cos_f32 v46, v73
    v_sin_f32 v47, v73
    v_mul_f32 v73, 0xbbc00000, v72
    v_cos_f32 v48, v73
    v_sin_f32 v49, v73
    v_mul_f32 v73, 0xbc000000, v72
    v_cos_f32 v50, v73
    v_sin_f32 v51, v73
    v_mul_f32 v73, 0xbc200000, v72
    v_cos_f32 v52, v73
    v_sin_f32 v53, v73
    v_mul_f32 v73, 0xbc400000, v72
    v_cos_f32 v54, v73
    v_sin_f32 v55, v73
    v_mul_f32 v73, 0xbc600000, v72
    v_cos_f32 v56, v73
    v_sin_f32 v57, v73
    v_and_b32 v74, 7, v1
    v_cvt_f32_u32 v72, v74
    v_mul_f32 v73, 0xbc800000, v72
    v_cos_f32 v58, v73
    v_sin_f32 v59, v73
    v_mul_f32 v73, 0xbd000000, v72
    v_cos_f32 v60, v73
    v_sin_f32 v61, v73
    v_mul_f32 v73, 0xbd400000, v72
    v_cos_f32 v62, v73
    v_sin_f32 v63, v73
    v_mul_f32 v73, 0xbd800000, v72
    v_cos_f32 v64, v73
    v_sin_f32 v65, v73
    v_mul_f32 v73, 0xbda00000, v72
    v_cos_f32 v66, v73
    v_sin_f32 v67, v73
    v_mul_f32 v73, 0xbdc00000, v72
    v_cos_f32 v68, v73
    v_sin_f32 v69, v73
    v_mul_f32 v73, 0xbde00000, v72
    v_cos_f32 v70, v73
    v_sin_f32 v71, v73
    v_lshl_add_u32 v76, v1, 3, v80
    v_lshrrev_b32 v72, 3, v1
    v_mul_u32_u24 v73, 576, v72
    v_lshl_add_u32 v77, v74, 3, v73
    v_add_u32 v77, v77, v80
    v_mov_b32 v78, v76
    v_mul_u32_u24 v73, 520, v72
    v_lshl_add_u32 v79, v74, 6, v73
    v_add_u32 v79, v79, v80
    s_waitcnt vmcnt(0)
    v_lshlrev_b32 v8, 16, v9
    v_and_b32 v9, 0xffff0000, v9
    v_lshlrev_b32 v10, 16, v11
    v_and_b32 v11, 0xffff0000, v11
    v_lshlrev_b32 v12, 16, v13
    v_and_b32 v13, 0xffff0000, v13
    v_lshlrev_b32 v14, 16, v15
    v_and_b32 v15, 0xffff0000, v15
    v_lshlrev_b32 v16, 16, v17
    v_and_b32 v17, 0xffff0000, v17
    v_lshlrev_b32 v18, 16, v19
    v_and_b32 v19, 0xffff0000, v19
    v_lshlrev_b32 v20, 16, v21
    v_and_b32 v21, 0xffff0000, v21
    v_lshlrev_b32 v22, 16, v23
    v_and_b32 v23, 0xffff0000, v23
    v_lshlrev_b32 v24, 16, v25
    v_and_b32 v25, 0xffff0000, v25
    v_lshlrev_b32 v26, 16, v27
    v_and_b32 v27, 0xffff0000, v27
    v_lshlrev_b32 v28, 16, v29
    v_and_b32 v29, 0xffff0000, v29
    v_lshlrev_b32 v30, 16, v31
    v_and_b32 v31, 0xffff0000, v31
    v_lshlrev_b32 v32, 16, v33
    v_and_b32 v33, 0xffff0000, v33
    v_lshlrev_b32 v34, 16, v35
    v_and_b32 v35, 0xffff0000, v35
    v_lshlrev_b32 v36, 16, v37
    v_and_b32 v37, 0xffff0000, v37
    v_lshlrev_b32 v38, 16, v39
    v_and_b32 v39, 0xffff0000, v39
    v_pk_add_f32 v[40:41], v[8:9], v[16:17]
    v_pk_add_f32 v[16:17], v[8:9], v[16:17] neg_lo:[0,1] neg_hi:[0,1]
    v_pk_add_f32 v[8:9], v[10:11], v[18:19]
    v_pk_add_f32 v[18:19], v[10:11], v[18:19] neg_lo:[0,1] neg_hi:[0,1]
    v_pk_mul_f32 v[42:43], v[18:19], s[12:13] op_sel:[0,0] op_sel_hi:[0,1] neg_lo:[0,0] neg_hi:[0,1]
    v_pk_fma_f32 v[18:19], v[18:19], s[12:13], v[42:43] op_sel:[1,1,0] op_sel_hi:[1,0,1] neg_lo:[0,0,0] neg_hi:[0,0,0]
    v_pk_add_f32 v[10:11], v[12:13], v[20:21]
    v_pk_add_f32 v[20:21], v[12:13], v[20:21] op_sel:[1,1] op_sel_hi:[0,0] neg_lo:[0,1] neg_hi:[1,0]
    v_pk_add_f32 v[12:13], v[14:15], v[22:23]
    v_pk_add_f32 v[22:23], v[14:15], v[22:23] neg_lo:[0,1] neg_hi:[0,1]
    v_pk_mul_f32 v[42:43], v[22:23], s[12:13] op_sel:[0,0] op_sel_hi:[0,1] neg_lo:[0,1] neg_hi:[0,1]
    v_pk_fma_f32 v[22:23], v[22:23], s[12:13], v[42:43] op_sel:[1,1,0] op_sel_hi:[1,0,1] neg_lo:[0,0,0] neg_hi:[0,1,0]
    v_pk_add_f32 v[14:15], v[40:41], v[10:11]
    v_pk_add_f32 v[10:11], v[40:41], v[10:11] neg_lo:[0,1] neg_hi:[0,1]
    v_pk_add_f32 v[40:41], v[8:9], v[12:13]
    v_pk_add_f32 v[12:13], v[8:9], v[12:13] op_sel:[1,1] op_sel_hi:[0,0] neg_lo:[0,1] neg_hi:[1,0]
    v_pk_add_f32 v[8:9], v[14:15], v[40:41]
    v_pk_add_f32 v[40:41], v[14:15], v[40:41] neg_lo:[0,1] neg_hi:[0,1]
    v_pk_add_f32 v[14:15], v[10:11], v[12:13]
    v_pk_add_f32 v[12:13], v[10:11], v[12:13] neg_lo:[0,1] neg_hi:[0,1]
    v_pk_add_f32 v[10:11], v[16:17], v[20:21]
    v_pk_add_f32 v[20:21], v[16:17], v[20:21] neg_lo:[0,1] neg_hi:[0,1]
    v_pk_add_f32 v[16:17], v[18:19], v[22:23]
    v_pk_add_f32 v[22:23], v[18:19], v[22:23] op_sel:[1,1] op_sel_hi:[0,0] neg_lo:[0,1] neg_hi:[1,0]
    v_pk_add_f32 v[18:19], v[10:11], v[16:17]
    v_pk_add_f32 v[16:17], v[10:11], v[16:17] neg_lo:[0,1] neg_hi:[0,1]
    v_pk_add_f32 v[10:11], v[20:21], v[22:23]
    v_pk_add_f32 v[22:23], v[20:21], v[22:23] neg_lo:[0,1] neg_hi:[0,1]
    v_pk_mul_f32 v[42:43], v[18:19], v[44:45] op_sel:[0,0] op_sel_hi:[0,1] neg_hi:[0,0]
    v_pk_fma_f32 v[18:19], v[18:19], v[44:45], v[42:43] op_sel:[1,1,0] op_sel_hi:[1,0,1] neg_lo:[0,1,0]
    v_pk_mul_f32 v[42:43], v[14:15], v[46:47] op_sel:[0,0] op_sel_hi:[0,1] neg_hi:[0,0]
    v_pk_fma_f32 v[14:15], v[14:15], v[46:47], v[42:43] op_sel:[1,1,0] op_sel_hi:[1,0,1] neg_lo:[0,1,0]
    v_pk_mul_f32 v[42:43], v[10:11], v[48:49] op_sel:[0,0] op_sel_hi:[0,1] neg_hi:[0,0]
    v_pk_fma_f32 v[10:11], v[10:11], v[48:49], v[42:43] op_sel:[1,1,0] op_sel_hi:[1,0,1] neg_lo:[0,1,0]
    v_pk_mul_f32 v[42:43], v[40:41], v[50:51] op_sel:[0,0] op_sel_hi:[0,1] neg_hi:[0,0]
    v_pk_fma_f32 v[40:41], v[40:41], v[50:51], v[42:43] op_sel:[1,1,0] op_sel_hi:[1,0,1] neg_lo:[0,1,0]
    v_pk_mul_f32 v[42:43], v[16:17], v[52:53] op_sel:[0,0] op_sel_hi:[0,1] neg_hi:[0,0]
    v_pk_fma_f32 v[16:17], v[16:17], v[52:53], v[42:43] op_sel:[1,1,0] op_sel_hi:[1,0,1] neg_lo:[0,1,0]
    v_pk_mul_f32 v[42:43], v[12:13], v[54:55] op_sel:[0,0] op_sel_hi:[0,1] neg_hi:[0,0]
    v_pk_fma_f32 v[12:13], v[12:13], v[54:55], v[42:43] op_sel:[1,1,0] op_sel_hi:[1,0,1] neg_lo:[0,1,0]
    v_pk_mul_f32 v[42:43], v[22:23], v[56:57] op_sel:[0,0] op_sel_hi:[0,1] neg_hi:[0,0]
    v_pk_fma_f32 v[22:23], v[22:23], v[56:57], v[42:43] op_sel:[1,1,0] op_sel_hi:[1,0,1] neg_lo:[0,1,0]
    ds_write_b64 v76, v[8:9] offset:0
    ds_write_b64 v76, v[18:19] offset:576
    ds_write_b64 v76, v[14:15] offset:1152
    ds_write_b64 v76, v[10:11] offset:1728
    ds_write_b64 v76, v[40:41] offset:2304
    ds_write_b64 v76, v[16:17] offset:2880
    ds_write_b64 v76, v[12:13] offset:3456
    ds_write_b64 v76, v[22:23] offset:4032
    v_pk_add_f32 v[20:21], v[24:25], v[32:33]
    v_pk_add_f32 v[32:33], v[24:25], v[32:33] neg_lo:[0,1] neg_hi:[0,1]
    v_pk_add_f32 v[24:25], v[26:27], v[34:35]
    v_pk_add_f32 v[34:35], v[26:27], v[34:35] neg_lo:[0,1] neg_hi:[0,1]
    v_pk_mul_f32 v[42:43], v[34:35], s[12:13] op_sel:[0,0] op_sel_hi:[0,1] neg_lo:[0,0] neg_hi:[0,1]
    v_pk_fma_f32 v[34:35], v[34:35], s[12:13], v[42:43] op_sel:[1,1,0] op_sel_hi:[1,0,1] neg_lo:[0,0,0] neg_hi:[0,0,0]
    v_pk_add_f32 v[26:27], v[28:29], v[36:37]
    v_pk_add_f32 v[36:37], v[28:29], v[36:37] op_sel:[1,1] op_sel_hi:[0,0] neg_lo:[0,1] neg_hi:[1,0]
    v_pk_add_f32 v[28:29], v[30:31], v[38:39]
    v_pk_add_f32 v[38:39], v[30:31], v[38:39] neg_lo:[0,1] neg_hi:[0,1]
    v_pk_mul_f32 v[42:43], v[38:39], s[12:13] op_sel:[0,0] op_sel_hi:[0,1] neg_lo:[0,1] neg_hi:[0,1]
    v_pk_fma_f32 v[38:39], v[38:39], s[12:13], v[42:43] op_sel:[1,1,0] op_sel_hi:[1,0,1] neg_lo:[0,0,0] neg_hi:[0,1,0]
    v_pk_add_f32 v[30:31], v[20:21], v[26:27]
    v_pk_add_f32 v[26:27], v[20:21], v[26:27] neg_lo:[0,1] neg_hi:[0,1]
    v_pk_add_f32 v[20:21], v[24:25], v[28:29]
    v_pk_add_f32 v[28:29], v[24:25], v[28:29] op_sel:[1,1] op_sel_hi:[0,0] neg_lo:[0,1] neg_hi:[1,0]
    v_pk_add_f32 v[24:25], v[30:31], v[20:21]
    v_pk_add_f32 v[20:21], v[30:31], v[20:21] neg_lo:[0,1] neg_hi:[0,1]
    v_pk_add_f32 v[30:31], v[26:27], v[28:29]
    v_pk_add_f32 v[28:29], v[26:27], v[28:29] neg_lo:[0,1] neg_hi:[0,1]
    v_pk_add_f32 v[26:27], v[32:33], v[36:37]
    v_pk_add_f32 v[36:37], v[32:33], v[36:37] neg_lo:[0,1] neg_hi:[0,1]
    v_pk_add_f32 v[32:33], v[34:35], v[38:39]
    v_pk_add_f32 v[38:39], v[34:35], v[38:39] op_sel:[1,1] op_sel_hi:[0,0] neg_lo:[0,1] neg_hi:[1,0]
    v_pk_add_f32 v[34:35], v[26:27], v[32:33]
    v_pk_add_f32 v[32:33], v[26:27], v[32:33] neg_lo:[0,1] neg_hi:[0,1]
    v_pk_add_f32 v[26:27], v[36:37], v[38:39]
    v_pk_add_f32 v[38:39], v[36:37], v[38:39] neg_lo:[0,1] neg_hi:[0,1]
    v_pk_mul_f32 v[42:43], v[34:35], v[44:45] op_sel:[0,0] op_sel_hi:[0,1] neg_hi:[0,0]
    v_pk_fma_f32 v[34:35], v[34:35], v[44:45], v[42:43] op_sel:[1,1,0] op_sel_hi:[1,0,1] neg_lo:[0,1,0]
    v_pk_mul_f32 v[42:43], v[30:31], v[46:47] op_sel:[0,0] op_sel_hi:[0,1] neg_hi:[0,0]
    v_pk_fma_f32 v[30:31], v[30:31], v[46:47], v[42:43] op_sel:[1,1,0] op_sel_hi:[1,0,1] neg_lo:[0,1,0]
    v_pk_mul_f32 v[42:43], v[26:27], v[48:49] op_sel:[0,0] op_sel_hi:[0,1] neg_hi:[0,0]
    v_pk_fma_f32 v[26:27], v[26:27], v[48:49], v[42:43] op_sel:[1,1,0] op_sel_hi:[1,0,1] neg_lo:[0,1,0]
    v_pk_mul_f32 v[42:43], v[20:21], v[50:51] op_sel:[0,0] op_sel_hi:[0,1] neg_hi:[0,0]
    v_pk_fma_f32 v[20:21], v[20:21], v[50:51], v[42:43] op_sel:[1,1,0] op_sel_hi:[1,0,1] neg_lo:[0,1,0]
    v_pk_mul_f32 v[42:43], v[32:33], v[52:53] op_sel:[0,0] op_sel_hi:[0,1] neg_hi:[0,0]
    v_pk_fma_f32 v[32:33], v[32:33], v[52:53], v[42:43] op_sel:[1,1,0] op_sel_hi:[1,0,1] neg_lo:[0,1,0]
    v_pk_mul_f32 v[42:43], v[28:29], v[54:55] op_sel:[0,0] op_sel_hi:[0,1] neg_hi:[0,0]
    v_pk_fma_f32 v[28:29], v[28:29], v[54:55], v[42:43] op_sel:[1,1,0] op_sel_hi:[1,0,1] neg_lo:[0,1,0]
    v_pk_mul_f32 v[42:43], v[38:39], v[56:57] op_sel:[0,0] op_sel_hi:[0,1] neg_hi:[0,0]
    v_pk_fma_f32 v[38:39], v[38:39], v[56:57], v[42:43] op_sel:[1,1,0] op_sel_hi:[1,0,1] neg_lo:[0,1,0]
    ds_write_b64 v76, v[24:25] offset:4640
    ds_write_b64 v76, v[34:35] offset:5216
    ds_write_b64 v76, v[30:31] offset:5792
    ds_write_b64 v76, v[26:27] offset:6368
    ds_write_b64 v76, v[20:21] offset:6944
    ds_write_b64 v76, v[32:33] offset:7520
    ds_write_b64 v76, v[28:29] offset:8096
    ds_write_b64 v76, v[38:39] offset:8672
    s_waitcnt lgkmcnt(0)
    ds_read_b64 v[8:9], v77 offset:0
    ds_read_b64 v[18:19], v77 offset:64
    ds_read_b64 v[14:15], v77 offset:128
    ds_read_b64 v[10:11], v77 offset:192
    ds_read_b64 v[40:41], v77 offset:256
    ds_read_b64 v[16:17], v77 offset:320
    ds_read_b64 v[12:13], v77 offset:384
    ds_read_b64 v[22:23], v77 offset:448
    ds_read_b64 v[24:25], v77 offset:4640
    ds_read_b64 v[34:35], v77 offset:4704
    ds_read_b64 v[30:31], v77 offset:4768
    ds_read_b64 v[26:27], v77 offset:4832
    ds_read_b64 v[20:21], v77 offset:4896
    ds_read_b64 v[32:33], v77 offset:4960
    ds_read_b64 v[28:29], v77 offset:5024
    ds_read_b64 v[38:39], v77 offset:5088
    s_waitcnt lgkmcnt(0)
    v_pk_add_f32 v[36:37], v[8:9], v[40:41]
    v_pk_add_f32 v[40:41], v[8:9], v[40:41] neg_lo:[0,1] neg_hi:[0,1]
    v_pk_add_f32 v[8:9], v[18:19], v[16:17]
    v_pk_add_f32 v[16:17], v[18:19], v[16:17] neg_lo:[0,1] neg_hi:[0,1]
    v_pk_mul_f32 v[42:43], v[16:17], s[12:13] op_sel:[0,0] op_sel_hi:[0,1] neg_lo:[0,0] neg_hi:[0,1]
    v_pk_fma_f32 v[16:17], v[16:17], s[12:13], v[42:43] op_sel:[1,1,0] op_sel_hi:[1,0,1] neg_lo:[0,0,0] neg_hi:[0,0,0]
    v_pk_add_f32 v[18:19], v[14:15], v[12:13]
    v_pk_add_f32 v[12:13], v[14:15], v[12:13] op_sel:[1,1] op_sel_hi:[0,0] neg_lo:[0,1] neg_hi:[1,0]
    v_pk_add_f32 v[14:15], v[10:11], v[22:23]
    v_pk_add_f32 v[22:23], v[10:11], v[22:23] neg_lo:[0,1] neg_hi:[0,1]
    v_pk_mul_f32 v[42:43], v[22:23], s[12:13] op_sel:[0,0] op_sel_hi:[0,1] neg_lo:[0,1] neg_hi:[0,1]
    v_pk_fma_f32 v[22:23], v[22:23], s[12:13], v[42:43] op_sel:[1,1,0] op_sel_hi:[1,0,1] neg_lo:[0,0,0] neg_hi:[0,1,0]
    v_pk_add_f32 v[10:11], v[36:37], v[18:19]
    v_pk_add_f32 v[18:19], v[36:37], v[18:19] neg_lo:[0,1] neg_hi:[0,1]
    v_pk_add_f32 v[36:37], v[8:9], v[14:15]
    v_pk_add_f32 v[14:15], v[8:9], v[14:15] op_sel:[1,1] op_sel_hi:[0,0] neg_lo:[0,1] neg_hi:[1,0]
    v_pk_add_f32 v[8:9], v[10:11], v[36:37]
    v_pk_add_f32 v[36:37], v[10:11], v[36:37] neg_lo:[0,1] neg_hi:[0,1]
    v_pk_add_f32 v[10:11], v[18:19], v[14:15]
    v_pk_add_f32 v[14:15], v[18:19], v[14:15] neg_lo:[0,1] neg_hi:[0,1]
    v_pk_add_f32 v[18:19], v[40:41], v[12:13]
    v_pk_add_f32 v[12:13], v[40:41], v[12:13] neg_lo:[0,1] neg_hi:[0,1]
    v_pk_add_f32 v[40:41], v[16:17], v[22:23]
    v_pk_add_f32 v[22:23], v[16:17], v[22:23] op_sel:[1,1] op_sel_hi:[0,0] neg_lo:[0,1] neg_hi:[1,0]
    v_pk_add_f32 v[16:17], v[18:19], v[40:41]
    v_pk_add_f32 v[40:41], v[18:19], v[40:41] neg_lo:[0,1] neg_hi:[0,1]
    v_pk_add_f32 v[18:19], v[12:13], v[22:23]
    v_pk_add_f32 v[22:23], v[12:13], v[22:23] neg_lo:[0,1] neg_hi:[0,1]
    v_pk_mul_f32 v[42:43], v[16:17], v[58:59] op_sel:[0,0] op_sel_hi:[0,1] neg_hi:[0,0]
    v_pk_fma_f32 v[16:17], v[16:17], v[58:59], v[42:43] op_sel:[1,1,0] op_sel_hi:[1,0,1] neg_lo:[0,1,0]
    v_pk_mul_f32 v[42:43], v[10:11], v[60:61] op_sel:[0,0] op_sel_hi:[0,1] neg_hi:[0,0]
    v_pk_fma_f32 v[10:11], v[10:11], v[60:61], v[42:43] op_sel:[1,1,0] op_sel_hi:[1,0,1] neg_lo:[0,1,0]
    v_pk_mul_f32 v[42:43], v[18:19], v[62:63] op_sel:[0,0] op_sel_hi:[0,1] neg_hi:[0,0]
    v_pk_fma_f32 v[18:19], v[18:19], v[62:63], v[42:43] op_sel:[1,1,0] op_sel_hi:[1,0,1] neg_lo:[0,1,0]
    v_pk_mul_f32 v[42:43], v[36:37], v[64:65] op_sel:[0,0] op_sel_hi:[0,1] neg_hi:[0,0]
    v_pk_fma_f32 v[36:37], v[36:37], v[64:65], v[42:43] op_sel:[1,1,0] op_sel_hi:[1,0,1] neg_lo:[0,1,0]
    v_pk_mul_f32 v[42:43], v[40:41], v[66:67] op_sel:[0,0] op_sel_hi:[0,1] neg_hi:[0,0]
    v_pk_fma_f32 v[40:41], v[40:41], v[66:67], v[42:43] op_sel:[1,1,0] op_sel_hi:[1,0,1] neg_lo:[0,1,0]
    v_pk_mul_f32 v[42:43], v[14:15], v[68:69] op_sel:[0,0] op_sel_hi:[0,1] neg_hi:[0,0]
    v_pk_fma_f32 v[14:15], v[14:15], v[68:69], v[42:43] op_sel:[1,1,0] op_sel_hi:[1,0,1] neg_lo:[0,1,0]
    v_pk_mul_f32 v[42:43], v[22:23], v[70:71] op_sel:[0,0] op_sel_hi:[0,1] neg_hi:[0,0]
    v_pk_fma_f32 v[22:23], v[22:23], v[70:71], v[42:43] op_sel:[1,1,0] op_sel_hi:[1,0,1] neg_lo:[0,1,0]
    ds_write_b64 v78, v[8:9] offset:0
    ds_write_b64 v78, v[16:17] offset:520
    ds_write_b64 v78, v[10:11] offset:1040
    ds_write_b64 v78, v[18:19] offset:1560
    ds_write_b64 v78, v[36:37] offset:2080
    ds_write_b64 v78, v[40:41] offset:2600
    ds_write_b64 v78, v[14:15] offset:3120
    ds_write_b64 v78, v[22:23] offset:3640
    v_pk_add_f32 v[12:13], v[24:25], v[20:21]
    v_pk_add_f32 v[20:21], v[24:25], v[20:21] neg_lo:[0,1] neg_hi:[0,1]
    v_pk_add_f32 v[24:25], v[34:35], v[32:33]
    v_pk_add_f32 v[32:33], v[34:35], v[32:33] neg_lo:[0,1] neg_hi:[0,1]
    v_pk_mul_f32 v[42:43], v[32:33], s[12:13] op_sel:[0,0] op_sel_hi:[0,1] neg_lo:[0,0] neg_hi:[0,1]
    v_pk_fma_f32 v[32:33], v[32:33], s[12:13], v[42:43] op_sel:[1,1,0] op_sel_hi:[1,0,1] neg_lo:[0,0,0] neg_hi:[0,0,0]
    v_pk_add_f32 v[34:35], v[30:31], v[28:29]
    v_pk_add_f32 v[28:29], v[30:31], v[28:29] op_sel:[1,1] op_sel_hi:[0,0] neg_lo:[0,1] neg_hi:[1,0]
    v_pk_add_f32 v[30:31], v[26:27], v[38:39]
    v_pk_add_f32 v[38:39], v[26:27], v[38:39] neg_lo:[0,1] neg_hi:[0,1]
    v_pk_mul_f32 v[42:43], v[38:39], s[12:13] op_sel:[0,0] op_sel_hi:[0,1] neg_lo:[0,1] neg_hi:[0,1]
    v_pk_fma_f32 v[38:39], v[38:39], s[12:13], v[42:43] op_sel:[1,1,0] op_sel_hi:[1,0,1] neg_lo:[0,0,0] neg_hi:[0,1,0]
    v_pk_add_f32 v[26:27], v[12:13], v[34:35]
    v_pk_add_f32 v[34:35], v[12:13], v[34:35] neg_lo:[0,1] neg_hi:[0,1]
    v_pk_add_f32 v[12:13], v[24:25], v[30:31]
    v_pk_add_f32 v[30:31], v[24:25], v[30:31] op_sel:[1,1] op_sel_hi:[0,0] neg_lo:[0,1] neg_hi:[1,0]
    v_pk_add_f32 v[24:25], v[26:27], v[12:13]
    v_pk_add_f32 v[12:13], v[26:27], v[12:13] neg_lo:[0,1] neg_hi:[0,1]
    v_pk_add_f32 v[26:27], v[34:35], v[30:31]
    v_pk_add_f32 v[30:31], v[34:35], v[30:31] neg_lo:[0,1] neg_hi:[0,1]
    v_pk_add_f32 v[34:35], v[20:21], v[28:29]
    v_pk_add_f32 v[28:29], v[20:21], v[28:29] neg_lo:[0,1] neg_hi:[0,1]
    v_pk_add_f32 v[20:21], v[32:33], v[38:39]
    v_pk_add_f32 v[38:39], v[32:33], v[38:39] op_sel:[1,1] op_sel_hi:[0,0] neg_lo:[0,1] neg_hi:[1,0]
    v_pk_add_f32 v[32:33], v[34:35], v[20:21]
    v_pk_add_f32 v[20:21], v[34:35], v[20:21] neg_lo:[0,1] neg_hi:[0,1]
    v_pk_add_f32 v[34:35], v[28:29], v[38:39]
    v_pk_add_f32 v[38:39], v[28:29], v[38:39] neg_lo:[0,1] neg_hi:[0,1]
    v_pk_mul_f32 v[42:43], v[32:33], v[58:59] op_sel:[0,0] op_sel_hi:[0,1] neg_hi:[0,0]
    v_pk_fma_f32 v[32:33], v[32:33], v[58:59], v[42:43] op_sel:[1,1,0] op_sel_hi:[1,0,1] neg_lo:[0,1,0]
    v_pk_mul_f32 v[42:43], v[26:27], v[60:61] op_sel:[0,0] op_sel_hi:[0,1] neg_hi:[0,0]
    v_pk_fma_f32 v[26:27], v[26:27], v[60:61], v[42:43] op_sel:[1,1,0] op_sel_hi:[1,0,1] neg_lo:[0,1,0]
    v_pk_mul_f32 v[42:43], v[34:35], v[62:63] op_sel:[0,0] op_sel_hi:[0,1] neg_hi:[0,0]
    v_pk_fma_f32 v[34:35], v[34:35], v[62:63], v[42:43] op_sel:[1,1,0] op_sel_hi:[1,0,1] neg_lo:[0,1,0]
    v_pk_mul_f32 v[42:43], v[12:13], v[64:65] op_sel:[0,0] op_sel_hi:[0,1] neg_hi:[0,0]
    v_pk_fma_f32 v[12:13], v[12:13], v[64:65], v[42:43] op_sel:[1,1,0] op_sel_hi:[1,0,1] neg_lo:[0,1,0]
    v_pk_mul_f32 v[42:43], v[20:21], v[66:67] op_sel:[0,0] op_sel_hi:[0,1] neg_hi:[0,0]
    v_pk_fma_f32 v[20:21], v[20:21], v[66:67], v[42:43] op_sel:[1,1,0] op_sel_hi:[1,0,1] neg_lo:[0,1,0]
    v_pk_mul_f32 v[42:43], v[30:31], v[68:69] op_sel:[0,0] op_sel_hi:[0,1] neg_hi:[0,0]
    v_pk_fma_f32 v[30:31], v[30:31], v[68:69], v[42:43] op_sel:[1,1,0] op_sel_hi:[1,0,1] neg_lo:[0,1,0]
    v_pk_mul_f32 v[42:43], v[38:39], v[70:71] op_sel:[0,0] op_sel_hi:[0,1] neg_hi:[0,0]
    v_pk_fma_f32 v[38:39], v[38:39], v[70:71], v[42:43] op_sel:[1,1,0] op_sel_hi:[1,0,1] neg_lo:[0,1,0]
    ds_write_b64 v78, v[24:25] offset:4640
    ds_write_b64 v78, v[32:33] offset:5160
    ds_write_b64 v78, v[26:27] offset:5680
    ds_write_b64 v78, v[34:35] offset:6200
    ds_write_b64 v78, v[12:13] offset:6720
    ds_write_b64 v78, v[20:21] offset:7240
    ds_write_b64 v78, v[30:31] offset:7760
    ds_write_b64 v78, v[38:39] offset:8280
    s_waitcnt lgkmcnt(0)
    ds_read_b64 v[8:9], v79 offset:0
    ds_read_b64 v[16:17], v79 offset:8
    ds_read_b64 v[10:11], v79 offset:16
    ds_read_b64 v[18:19], v79 offset:24
    ds_read_b64 v[36:37], v79 offset:32
    ds_read_b64 v[40:41], v79 offset:40
    ds_read_b64 v[14:15], v79 offset:48
    ds_read_b64 v[22:23], v79 offset:56
    ds_read_b64 v[24:25], v79 offset:4640
    ds_read_b64 v[32:33], v79 offset:4648
    ds_read_b64 v[26:27], v79 offset:4656
    ds_read_b64 v[34:35], v79 offset:4664
    ds_read_b64 v[12:13], v79 offset:4672
    ds_read_b64 v[20:21], v79 offset:4680
    ds_read_b64 v[30:31], v79 offset:4688
    ds_read_b64 v[38:39], v79 offset:4696
    s_waitcnt lgkmcnt(0)
    v_pk_add_f32 v[28:29], v[8:9], v[36:37]
    v_pk_add_f32 v[36:37], v[8:9], v[36:37] neg_lo:[0,1] neg_hi:[0,1]
    v_pk_add_f32 v[8:9], v[16:17], v[40:41]
    v_pk_add_f32 v[40:41], v[16:17], v[40:41] neg_lo:[0,1] neg_hi:[0,1]
    v_pk_mul_f32 v[42:43], v[40:41], s[12:13] op_sel:[0,0] op_sel_hi:[0,1] neg_lo:[0,0] neg_hi:[0,1]
    v_pk_fma_f32 v[40:41], v[40:41], s[12:13], v[42:43] op_sel:[1,1,0] op_sel_hi:[1,0,1] neg_lo:[0,0,0] neg_hi:[0,0,0]
    v_pk_add_f32 v[16:17], v[10:11], v[14:15]
    v_pk_add_f32 v[14:15], v[10:11], v[14:15] op_sel:[1,1] op_sel_hi:[0,0] neg_lo:[0,1] neg_hi:[1,0]
    v_pk_add_f32 v[10:11], v[18:19], v[22:23]
    v_pk_add_f32 v[22:23], v[18:19], v[22:23] neg_lo:[0,1] neg_hi:[0,1]
    v_pk_mul_f32 v[42:43], v[22:23], s[12:13] op_sel:[0,0] op_sel_hi:[0,1] neg_lo:[0,1] neg_hi:[0,1]
    v_pk_fma_f32 v[22:23], v[22:23], s[12:13], v[42:43] op_sel:[1,1,0] op_sel_hi:[1,0,1] neg_lo:[0,0,0] neg_hi:[0,1,0]
    v_pk_add_f32 v[18:19], v[28:29], v[16:17]
    v_pk_add_f32 v[16:17], v[28:29], v[16:17] neg_lo:[0,1] neg_hi:[0,1]
    v_pk_add_f32 v[28:29], v[8:9], v[10:11]
    v_pk_add_f32 v[10:11], v[8:9], v[10:11] op_sel:[1,1] op_sel_hi:[0,0] neg_lo:[0,1] neg_hi:[1,0]
    v_pk_add_f32 v[8:9], v[18:19], v[28:29]
    v_pk_add_f32 v[28:29], v[18:19], v[28:29] neg_lo:[0,1] neg_hi:[0,1]
    v_pk_add_f32 v[18:19], v[16:17], v[10:11]
    v_pk_add_f32 v[10:11], v[16:17], v[10:11] neg_lo:[0,1] neg_hi:[0,1]
    v_pk_add_f32 v[16:17], v[36:37], v[14:15]
    v_pk_add_f32 v[14:15], v[36:37], v[14:15] neg_lo:[0,1] neg_hi:[0,1]
    v_pk_add_f32 v[36:37], v[40:41], v[22:23]
    v_pk_add_f32 v[22:23], v[40:41], v[22:23] op_sel:[1,1] op_sel_hi:[0,0] neg_lo:[0,1] neg_hi:[1,0]
    v_pk_add_f32 v[40:41], v[16:17], v[36:37]
    v_pk_add_f32 v[36:37], v[16:17], v[36:37] neg_lo:[0,1] neg_hi:[0,1]
    v_pk_add_f32 v[16:17], v[14:15], v[22:23]
    v_pk_add_f32 v[22:23], v[14:15], v[22:23] neg_lo:[0,1] neg_hi:[0,1]
    v_pk_add_f32 v[14:15], v[24:25], v[12:13]
    v_pk_add_f32 v[12:13], v[24:25], v[12:13] neg_lo:[0,1] neg_hi:[0,1]
    v_pk_add_f32 v[24:25], v[32:33], v[20:21]
    v_pk_add_f32 v[20:21], v[32:33], v[20:21] neg_lo:[0,1] neg_hi:[0,1]
    v_pk_mul_f32 v[42:43], v[20:21], s[12:13] op_sel:[0,0] op_sel_hi:[0,1] neg_lo:[0,0] neg_hi:[0,1]
    v_pk_fma_f32 v[20:21], v[20:21], s[12:13], v[42:43] op_sel:[1,1,0] op_sel_hi:[1,0,1] neg_lo:[0,0,0] neg_hi:[0,0,0]
    v_pk_add_f32 v[32:33], v[26:27], v[30:31]
    v_pk_add_f32 v[30:31], v[26:27], v[30:31] op_sel:[1,1] op_sel_hi:[0,0] neg_lo:[0,1] neg_hi:[1,0]
    v_pk_add_f32 v[26:27], v[34:35], v[38:39]
    v_pk_add_f32 v[38:39], v[34:35], v[38:39] neg_lo:[0,1] neg_hi:[0,1]
    v_pk_mul_f32 v[42:43], v[38:39], s[12:13] op_sel:[0,0] op_sel_hi:[0,1] neg_lo:[0,1] neg_hi:[0,1]
    v_pk_fma_f32 v[38:39], v[38:39], s[12:13], v[42:43] op_sel:[1,1,0] op_sel_hi:[1,0,1] neg_lo:[0,0,0] neg_hi:[0,1,0]
    v_pk_add_f32 v[34:35], v[14:15], v[32:33]
    v_pk_add_f32 v[32:33], v[14:15], v[32:33] neg_lo:[0,1] neg_hi:[0,1]
    v_pk_add_f32 v[14:15], v[24:25], v[26:27]
    v_pk_add_f32 v[26:27], v[24:25], v[26:27] op_sel:[1,1] op_sel_hi:[0,0] neg_lo:[0,1] neg_hi:[1,0]
    v_pk_add_f32 v[24:25], v[34:35], v[14:15]
    v_pk_add_f32 v[14:15], v[34:35], v[14:15] neg_lo:[0,1] neg_hi:[0,1]
    v_pk_add_f32 v[34:35], v[32:33], v[26:27]
    v_pk_add_f32 v[26:27], v[32:33], v[26:27] neg_lo:[0,1] neg_hi:[0,1]
    v_pk_add_f32 v[32:33], v[12:13], v[30:31]
    v_pk_add_f32 v[30:31], v[12:13], v[30:31] neg_lo:[0,1] neg_hi:[0,1]
    v_pk_add_f32 v[12:13], v[20:21], v[38:39]
    v_pk_add_f32 v[38:39], v[20:21], v[38:39] op_sel:[1,1] op_sel_hi:[0,0] neg_lo:[0,1] neg_hi:[1,0]
    v_pk_add_f32 v[20:21], v[32:33], v[12:13]
    v_pk_add_f32 v[12:13], v[32:33], v[12:13] neg_lo:[0,1] neg_hi:[0,1]
    v_pk_add_f32 v[32:33], v[30:31], v[38:39]
    v_pk_add_f32 v[38:39], v[30:31], v[38:39] neg_lo:[0,1] neg_hi:[0,1]
    ds_write_b64 v76, v[8:9] offset:0
    ds_write_b64 v76, v[40:41] offset:512
    ds_write_b64 v76, v[18:19] offset:1024
    ds_write_b64 v76, v[16:17] offset:1536
    ds_write_b64 v76, v[28:29] offset:2048
    ds_write_b64 v76, v[36:37] offset:2560
    ds_write_b64 v76, v[10:11] offset:3072
    ds_write_b64 v76, v[22:23] offset:3584
    ds_write_b64 v76, v[24:25] offset:4640
    ds_write_b64 v76, v[20:21] offset:5152
    ds_write_b64 v76, v[34:35] offset:5664
    ds_write_b64 v76, v[32:33] offset:6176
    ds_write_b64 v76, v[14:15] offset:6688
    ds_write_b64 v76, v[12:13] offset:7200
    ds_write_b64 v76, v[26:27] offset:7712
    ds_write_b64 v76, v[38:39] offset:8224
    v_cmp_eq_u32 vcc, 0, v1
    s_and_saveexec_b64 s[22:23], vcc
    ds_write_b64 v76, v[8:9] offset:4096
    ds_write_b64 v76, v[24:25] offset:8736
    s_mov_b64 exec, s[22:23]
    s_waitcnt lgkmcnt(0)
    s_barrier
    v_and_b32 v8, 7, v0
    v_lshrrev_b32 v9, 3, v0
    v_mul_u32_u24 v10, 4640, v8
    v_lshlrev_b32 v11, 3, v9
    v_sub_u32 v11, v10, v11
    v_lshl_add_u32 v10, v9, 3, v10
    v_lshlrev_b32 v12, 14, v9
    v_lshl_add_u32 v12, v8, 3, v12
    s_lshl_b32 s20, s2, 6
    v_add_u32 v12, s20, v12
    v_cvt_f32_u32 v13, v9
    v_mul_f32 v13, 0xba800000, v13
    ds_read_b64 v[16:17], v10 offset:0
    ds_read_b64 v[24:25], v11 offset:4096
    ds_read_b64 v[18:19], v10 offset:256
    ds_read_b64 v[26:27], v11 offset:3840
    ds_read_b64 v[20:21], v10 offset:512
    ds_read_b64 v[28:29], v11 offset:3584
    ds_read_b64 v[22:23], v10 offset:768
    ds_read_b64 v[30:31], v11 offset:3328
    v_add_f32 v56, 0x0, v13
    v_add_f32 v57, 0xbd000000, v13
    v_add_f32 v58, 0xbd800000, v13
    v_add_f32 v59, 0xbdc00000, v13
    v_cos_f32 v32, v56
    v_sin_f32 v33, v56
    v_cos_f32 v34, v57
    v_sin_f32 v35, v57
    v_cos_f32 v36, v58
    v_sin_f32 v37, v58
    v_cos_f32 v38, v59
    v_sin_f32 v39, v59
    s_waitcnt lgkmcnt(0)
    v_pk_add_f32 v[48:49], v[16:17], v[24:25] neg_hi:[0,1]
    v_pk_add_f32 v[16:17], v[16:17], v[24:25] op_sel:[1,1] op_sel_hi:[0,0] neg_hi:[1,0]
    v_pk_mul_f32 v[40:41], v[16:17], v[32:33] op_sel:[0,0] op_sel_hi:[0,1] neg_hi:[0,0]
    v_pk_fma_f32 v[24:25], v[16:17], v[32:33], v[40:41] op_sel:[1,1,0] op_sel_hi:[1,0,1] neg_lo:[0,1,0]
    v_pk_add_f32 v[48:49], v[48:49], v[24:25]
    v_pk_add_f32 v[50:51], v[18:19], v[26:27] neg_hi:[0,1]
    v_pk_add_f32 v[18:19], v[18:19], v[26:27] op_sel:[1,1] op_sel_hi:[0,0] neg_hi:[1,0]
    v_pk_mul_f32 v[42:43], v[18:19], v[34:35] op_sel:[0,0] op_sel_hi:[0,1] neg_hi:[0,0]
    v_pk_fma_f32 v[26:27], v[18:19], v[34:35], v[42:43] op_sel:[1,1,0] op_sel_hi:[1,0,1] neg_lo:[0,1,0]
    v_pk_add_f32 v[50:51], v[50:51], v[26:27]
    v_pk_add_f32 v[52:53], v[20:21], v[28:29] neg_hi:[0,1]
    v_pk_add_f32 v[20:21], v[20:21], v[28:29] op_sel:[1,1] op_sel_hi:[0,0] neg_hi:[1,0]
    v_pk_mul_f32 v[44:45], v[20:21], v[36:37] op_sel:[0,0] op_sel_hi:[0,1] neg_hi:[0,0]
    v_pk_fma_f32 v[28:29], v[20:21], v[36:37], v[44:45] op_sel:[1,1,0] op_sel_hi:[1,0,1] neg_lo:[0,1,0]
    v_pk_add_f32 v[52:53], v[52:53], v[28:29]
    v_pk_add_f32 v[54:55], v[22:23], v[30:31] neg_hi:[0,1]
    v_pk_add_f32 v[22:23], v[22:23], v[30:31] op_sel:[1,1] op_sel_hi:[0,0] neg_hi:[1,0]
    v_pk_mul_f32 v[46:47], v[22:23], v[38:39] op_sel:[0,0] op_sel_hi:[0,1] neg_hi:[0,0]
    v_pk_fma_f32 v[30:31], v[22:23], v[38:39], v[46:47] op_sel:[1,1,0] op_sel_hi:[1,0,1] neg_lo:[0,1,0]
    v_pk_add_f32 v[54:55], v[54:55], v[30:31]
    s_mov_b32 s21, 0
    buffer_store_dwordx2 v[48:49], v12, s[8:11], s21 offen
    s_mov_b32 s21, 524288
    buffer_store_dwordx2 v[50:51], v12, s[8:11], s21 offen
    s_mov_b32 s21, 1048576
    buffer_store_dwordx2 v[52:53], v12, s[8:11], s21 offen
    s_mov_b32 s21, 1572864
    buffer_store_dwordx2 v[54:55], v12, s[8:11], s21 offen
    ds_read_b64 v[16:17], v10 offset:1024
    ds_read_b64 v[24:25], v11 offset:3072
    ds_read_b64 v[18:19], v10 offset:1280
    ds_read_b64 v[26:27], v11 offset:2816
    ds_read_b64 v[20:21], v10 offset:1536
    ds_read_b64 v[28:29], v11 offset:2560
    ds_read_b64 v[22:23], v10 offset:1792
    ds_read_b64 v[30:31], v11 offset:2304
    v_add_f32 v56, 0xbe000000, v13
    v_add_f32 v57, 0xbe200000, v13
    v_add_f32 v58, 0xbe400000, v13
    v_add_f32 v59, 0xbe600000, v13
    v_cos_f32 v32, v56
    v_sin_f32 v33, v56
    v_cos_f32 v34, v57
    v_sin_f32 v35, v57
    v_cos_f32 v36, v58
    v_sin_f32 v37, v58
    v_cos_f32 v38, v59
    v_sin_f32 v39, v59
    s_waitcnt lgkmcnt(0)
    v_pk_add_f32 v[48:49], v[16:17], v[24:25] neg_hi:[0,1]
    v_pk_add_f32 v[16:17], v[16:17], v[24:25] op_sel:[1,1] op_sel_hi:[0,0] neg_hi:[1,0]
    v_pk_mul_f32 v[40:41], v[16:17], v[32:33] op_sel:[0,0] op_sel_hi:[0,1] neg_hi:[0,0]
    v_pk_fma_f32 v[24:25], v[16:17], v[32:33], v[40:41] op_sel:[1,1,0] op_sel_hi:[1,0,1] neg_lo:[0,1,0]
    v_pk_add_f32 v[48:49], v[48:49], v[24:25]
    v_pk_add_f32 v[50:51], v[18:19], v[26:27] neg_hi:[0,1]
    v_pk_add_f32 v[18:19], v[18:19], v[26:27] op_sel:[1,1] op_sel_hi:[0,0] neg_hi:[1,0]
    v_pk_mul_f32 v[42:43], v[18:19], v[34:35] op_sel:[0,0] op_sel_hi:[0,1] neg_hi:[0,0]
    v_pk_fma_f32 v[26:27], v[18:19], v[34:35], v[42:43] op_sel:[1,1,0] op_sel_hi:[1,0,1] neg_lo:[0,1,0]
    v_pk_add_f32 v[50:51], v[50:51], v[26:27]
    v_pk_add_f32 v[52:53], v[20:21], v[28:29] neg_hi:[0,1]
    v_pk_add_f32 v[20:21], v[20:21], v[28:29] op_sel:[1,1] op_sel_hi:[0,0] neg_hi:[1,0]
    v_pk_mul_f32 v[44:45], v[20:21], v[36:37] op_sel:[0,0] op_sel_hi:[0,1] neg_hi:[0,0]
    v_pk_fma_f32 v[28:29], v[20:21], v[36:37], v[44:45] op_sel:[1,1,0] op_sel_hi:[1,0,1] neg_lo:[0,1,0]
    v_pk_add_f32 v[52:53], v[52:53], v[28:29]
    v_pk_add_f32 v[54:55], v[22:23], v[30:31] neg_hi:[0,1]
    v_pk_add_f32 v[22:23], v[22:23], v[30:31] op_sel:[1,1] op_sel_hi:[0,0] neg_hi:[1,0]
    v_pk_mul_f32 v[46:47], v[22:23], v[38:39] op_sel:[0,0] op_sel_hi:[0,1] neg_hi:[0,0]
    v_pk_fma_f32 v[30:31], v[22:23], v[38:39], v[46:47] op_sel:[1,1,0] op_sel_hi:[1,0,1] neg_lo:[0,1,0]
    v_pk_add_f32 v[54:55], v[54:55], v[30:31]
    s_mov_b32 s21, 2097152
    buffer_store_dwordx2 v[48:49], v12, s[8:11], s21 offen
    s_mov_b32 s21, 2621440
    buffer_store_dwordx2 v[50:51], v12, s[8:11], s21 offen
    s_mov_b32 s21, 3145728
    buffer_store_dwordx2 v[52:53], v12, s[8:11], s21 offen
    s_mov_b32 s21, 3670016
    buffer_store_dwordx2 v[54:55], v12, s[8:11], s21 offen
    ds_read_b64 v[16:17], v10 offset:2048
    ds_read_b64 v[24:25], v11 offset:2048
    ds_read_b64 v[18:19], v10 offset:2304
    ds_read_b64 v[26:27], v11 offset:1792
    ds_read_b64 v[20:21], v10 offset:2560
    ds_read_b64 v[28:29], v11 offset:1536
    ds_read_b64 v[22:23], v10 offset:2816
    ds_read_b64 v[30:31], v11 offset:1280
    v_add_f32 v56, 0xbe800000, v13
    v_add_f32 v57, 0xbe900000, v13
    v_add_f32 v58, 0xbea00000, v13
    v_add_f32 v59, 0xbeb00000, v13
    v_cos_f32 v32, v56
    v_sin_f32 v33, v56
    v_cos_f32 v34, v57
    v_sin_f32 v35, v57
    v_cos_f32 v36, v58
    v_sin_f32 v37, v58
    v_cos_f32 v38, v59
    v_sin_f32 v39, v59
    s_waitcnt lgkmcnt(0)
    v_pk_add_f32 v[48:49], v[16:17], v[24:25] neg_hi:[0,1]
    v_pk_add_f32 v[16:17], v[16:17], v[24:25] op_sel:[1,1] op_sel_hi:[0,0] neg_hi:[1,0]
    v_pk_mul_f32 v[40:41], v[16:17], v[32:33] op_sel:[0,0] op_sel_hi:[0,1] neg_hi:[0,0]
    v_pk_fma_f32 v[24:25], v[16:17], v[32:33], v[40:41] op_sel:[1,1,0] op_sel_hi:[1,0,1] neg_lo:[0,1,0]
    v_pk_add_f32 v[48:49], v[48:49], v[24:25]
    v_pk_add_f32 v[50:51], v[18:19], v[26:27] neg_hi:[0,1]
    v_pk_add_f32 v[18:19], v[18:19], v[26:27] op_sel:[1,1] op_sel_hi:[0,0] neg_hi:[1,0]
    v_pk_mul_f32 v[42:43], v[18:19], v[34:35] op_sel:[0,0] op_sel_hi:[0,1] neg_hi:[0,0]
    v_pk_fma_f32 v[26:27], v[18:19], v[34:35], v[42:43] op_sel:[1,1,0] op_sel_hi:[1,0,1] neg_lo:[0,1,0]
    v_pk_add_f32 v[50:51], v[50:51], v[26:27]
    v_pk_add_f32 v[52:53], v[20:21], v[28:29] neg_hi:[0,1]
    v_pk_add_f32 v[20:21], v[20:21], v[28:29] op_sel:[1,1] op_sel_hi:[0,0] neg_hi:[1,0]
    v_pk_mul_f32 v[44:45], v[20:21], v[36:37] op_sel:[0,0] op_sel_hi:[0,1] neg_hi:[0,0]
    v_pk_fma_f32 v[28:29], v[20:21], v[36:37], v[44:45] op_sel:[1,1,0] op_sel_hi:[1,0,1] neg_lo:[0,1,0]
    v_pk_add_f32 v[52:53], v[52:53], v[28:29]
    v_pk_add_f32 v[54:55], v[22:23], v[30:31] neg_hi:[0,1]
    v_pk_add_f32 v[22:23], v[22:23], v[30:31] op_sel:[1,1] op_sel_hi:[0,0] neg_hi:[1,0]
    v_pk_mul_f32 v[46:47], v[22:23], v[38:39] op_sel:[0,0] op_sel_hi:[0,1] neg_hi:[0,0]
    v_pk_fma_f32 v[30:31], v[22:23], v[38:39], v[46:47] op_sel:[1,1,0] op_sel_hi:[1,0,1] neg_lo:[0,1,0]
    v_pk_add_f32 v[54:55], v[54:55], v[30:31]
    s_mov_b32 s21, 4194304
    buffer_store_dwordx2 v[48:49], v12, s[8:11], s21 offen
    s_mov_b32 s21, 4718592
    buffer_store_dwordx2 v[50:51], v12, s[8:11], s21 offen
    s_mov_b32 s21, 5242880
    buffer_store_dwordx2 v[52:53], v12, s[8:11], s21 offen
    s_mov_b32 s21, 5767168
    buffer_store_dwordx2 v[54:55], v12, s[8:11], s21 offen
    ds_read_b64 v[16:17], v10 offset:3072
    ds_read_b64 v[24:25], v11 offset:1024
    ds_read_b64 v[18:19], v10 offset:3328
    ds_read_b64 v[26:27], v11 offset:768
    ds_read_b64 v[20:21], v10 offset:3584
    ds_read_b64 v[28:29], v11 offset:512
    ds_read_b64 v[22:23], v10 offset:3840
    ds_read_b64 v[30:31], v11 offset:256
    v_add_f32 v56, 0xbec00000, v13
    v_add_f32 v57, 0xbed00000, v13
    v_add_f32 v58, 0xbee00000, v13
    v_add_f32 v59, 0xbef00000, v13
    v_cos_f32 v32, v56
    v_sin_f32 v33, v56
    v_cos_f32 v34, v57
    v_sin_f32 v35, v57
    v_cos_f32 v36, v58
    v_sin_f32 v37, v58
    v_cos_f32 v38, v59
    v_sin_f32 v39, v59
    s_waitcnt lgkmcnt(0)
    v_pk_add_f32 v[48:49], v[16:17], v[24:25] neg_hi:[0,1]
    v_pk_add_f32 v[16:17], v[16:17], v[24:25] op_sel:[1,1] op_sel_hi:[0,0] neg_hi:[1,0]
    v_pk_mul_f32 v[40:41], v[16:17], v[32:33] op_sel:[0,0] op_sel_hi:[0,1] neg_hi:[0,0]
    v_pk_fma_f32 v[24:25], v[16:17], v[32:33], v[40:41] op_sel:[1,1,0] op_sel_hi:[1,0,1] neg_lo:[0,1,0]
    v_pk_add_f32 v[48:49], v[48:49], v[24:25]
    v_pk_add_f32 v[50:51], v[18:19], v[26:27] neg_hi:[0,1]
    v_pk_add_f32 v[18:19], v[18:19], v[26:27] op_sel:[1,1] op_sel_hi:[0,0] neg_hi:[1,0]
    v_pk_mul_f32 v[42:43], v[18:19], v[34:35] op_sel:[0,0] op_sel_hi:[0,1] neg_hi:[0,0]
    v_pk_fma_f32 v[26:27], v[18:19], v[34:35], v[42:43] op_sel:[1,1,0] op_sel_hi:[1,0,1] neg_lo:[0,1,0]
    v_pk_add_f32 v[50:51], v[50:51], v[26:27]
    v_pk_add_f32 v[52:53], v[20:21], v[28:29] neg_hi:[0,1]
    v_pk_add_f32 v[20:21], v[20:21], v[28:29] op_sel:[1,1] op_sel_hi:[0,0] neg_hi:[1,0]
    v_pk_mul_f32 v[44:45], v[20:21], v[36:37] op_sel:[0,0] op_sel_hi:[0,1] neg_hi:[0,0]
    v_pk_fma_f32 v[28:29], v[20:21], v[36:37], v[44:45] op_sel:[1,1,0] op_sel_hi:[1,0,1] neg_lo:[0,1,0]
    v_pk_add_f32 v[52:53], v[52:53], v[28:29]
    v_pk_add_f32 v[54:55], v[22:23], v[30:31] neg_hi:[0,1]
    v_pk_add_f32 v[22:23], v[22:23], v[30:31] op_sel:[1,1] op_sel_hi:[0,0] neg_hi:[1,0]
    v_pk_mul_f32 v[46:47], v[22:23], v[38:39] op_sel:[0,0] op_sel_hi:[0,1] neg_hi:[0,0]
    v_pk_fma_f32 v[30:31], v[22:23], v[38:39], v[46:47] op_sel:[1,1,0] op_sel_hi:[1,0,1] neg_lo:[0,1,0]
    v_pk_add_f32 v[54:55], v[54:55], v[30:31]
    s_mov_b32 s21, 6291456
    buffer_store_dwordx2 v[48:49], v12, s[8:11], s21 offen
    s_mov_b32 s21, 6815744
    buffer_store_dwordx2 v[50:51], v12, s[8:11], s21 offen
    s_mov_b32 s21, 7340032
    buffer_store_dwordx2 v[52:53], v12, s[8:11], s21 offen
    s_mov_b32 s21, 7864320
    buffer_store_dwordx2 v[54:55], v12, s[8:11], s21 offen
    v_cmp_gt_u32 vcc, 8, v0
    s_and_saveexec_b64 s[22:23], vcc
    s_cbranch_execz k1_kernel_b1_end
    ds_read_b64 v[16:17], v10 offset:4096
    ds_read_b64 v[24:25], v11 offset:0
    v_add_f32 v56, 0xbf000000, v13
    v_cos_f32 v32, v56
    v_sin_f32 v33, v56
    s_waitcnt lgkmcnt(0)
    v_pk_add_f32 v[48:49], v[16:17], v[24:25] neg_hi:[0,1]
    v_pk_add_f32 v[16:17], v[16:17], v[24:25] op_sel:[1,1] op_sel_hi:[0,0] neg_hi:[1,0]
    v_pk_mul_f32 v[40:41], v[16:17], v[32:33] op_sel:[0,0] op_sel_hi:[0,1] neg_hi:[0,0]
    v_pk_fma_f32 v[24:25], v[16:17], v[32:33], v[40:41] op_sel:[1,1,0] op_sel_hi:[1,0,1] neg_lo:[0,1,0]
    v_pk_add_f32 v[48:49], v[48:49], v[24:25]
    s_mov_b32 s21, 8388608
    buffer_store_dwordx2 v[48:49], v12, s[8:11], s21 offen
k1_kernel_b1_end:
    s_endpgm
k1_kernel_r2:
    s_sub_u32 s2, s2, 400
    s_load_dwordx4 s[16:19], s[0:1], 8
    s_load_dwordx4 s[20:23], s[0:1], 24
    s_load_dwordx4 s[24:27], s[0:1], 40
    s_load_dwordx2 s[28:29], s[0:1], 56
    s_load_dwordx2 s[30:31], s[0:1], 112
    v_lshrrev_b32 v3, 6, v0
    v_and_b32 v10, 127, v0
    v_readfirstlane_b32 s9, v3
    s_waitcnt lgkmcnt(0)
    s_mov_b32 s32, s16
    s_and_b32 s33, s17, 0xffff
    s_mov_b32 s34, 262144
    s_mov_b32 s35, 0x00020000
    s_mov_b32 s36, s18
    s_and_b32 s37, s19, 0xffff
    s_mov_b32 s38, 262144
    s_mov_b32 s39, 0x00020000
    s_mov_b32 s40, s20
    s_and_b32 s41, s21, 0xffff
    s_mov_b32 s42, 262144
    s_mov_b32 s43, 0x00020000
    s_mov_b32 s44, s22
    s_and_b32 s45, s23, 0xffff
    s_mov_b32 s46, 262144
    s_mov_b32 s47, 0x00020000
    s_mov_b32 s48, s24
    s_and_b32 s49, s25, 0xffff
    s_mov_b32 s50, 262144
    s_mov_b32 s51, 0x00020000
    s_mov_b32 s52, s26
    s_and_b32 s53, s27, 0xffff
    s_mov_b32 s54, 262144
    s_mov_b32 s55, 0x00020000
    s_mov_b32 s56, s28
    s_and_b32 s57, s29, 0xffff
    s_mov_b32 s58, 2048
    s_mov_b32 s59, 0x00020000
    s_add_u32 s60, s30, 25165824
    s_addc_u32 s61, s31, 0
    s_and_b32 s61, s61, 0xffff
    s_mov_b32 s62, 4259840
    s_mov_b32 s63, 0x00020000
    s_lshl_b32 s6, s2, 8
    v_lshlrev_b32 v1, 1, v10
    buffer_load_ushort v2, v1, s[32:35], s6 offen
    buffer_load_ushort v3, v1, s[36:39], s6 offen
    buffer_load_ushort v4, v1, s[40:43], s6 offen
    buffer_load_ushort v5, v1, s[44:47], s6 offen
    buffer_load_ushort v6, v1, s[48:51], s6 offen
    buffer_load_ushort v7, v1, s[52:55], s6 offen
    s_lshl_b32 s7, s2, 1
    v_mov_b32 v9, 0
    buffer_load_ushort v8, v9, s[56:59], s7 offen
    s_waitcnt vmcnt(0)
    v_lshlrev_b32 v2, 16, v2
    v_lshlrev_b32 v3, 16, v3
    v_lshlrev_b32 v4, 16, v4
    v_lshlrev_b32 v5, 16, v5
    v_lshlrev_b32 v6, 16, v6
    v_lshlrev_b32 v7, 16, v7
    v_lshlrev_b32 v8, 16, v8
    v_mul_f32 v8, 0x3fb8aa3b, v8
    v_exp_f32 v8, v8
    s_nop 0
    v_cvt_pk_bf16_f32 v8, v8, v8
    v_lshlrev_b32 v8, 16, v8
    v_mul_f32 v2, v8, v2
    v_mul_f32 v12, 0x3fb8aa3b, v2
    v_mul_f32 v3, v8, v3
    v_mul_f32 v13, 0x3e22f983, v3
    v_mul_f32 v4, v8, v4
    v_mul_f32 v5, v8, v5
    v_mul_f32 v14, v6, v4
    v_fma_f32 v14, -v7, v5, v14
    v_mul_f32 v15, v6, v5
    v_fma_f32 v15, v7, v4, v15
    v_lshlrev_b32 v1, 2, v10
    s_cmp_ge_u32 s9, 2
    s_cbranch_scc1 k1_kernel_b2_roleA
    v_mul_f32 v40, 0x3f800000, v12
    v_mul_f32 v41, 0x3f800000, v13
    v_fract_f32 v41, v41
    v_mul_f32 v44, 0x40000000, v12
    v_mul_f32 v45, 0x40000000, v13
    v_fract_f32 v45, v45
    v_mul_f32 v48, 0x40800000, v12
    v_mul_f32 v49, 0x40800000, v13
    v_fract_f32 v49, v49
    v_mul_f32 v52, 0x41000000, v12
    v_mul_f32 v53, 0x41000000, v13
    v_fract_f32 v53, v53
    v_exp_f32 v40, v40
    v_cos_f32 v42, v41
    v_sin_f32 v43, v41
    v_exp_f32 v44, v44
    v_cos_f32 v46, v45
    v_sin_f32 v47, v45
    v_exp_f32 v48, v48
    v_cos_f32 v50, v49
    v_sin_f32 v51, v49
    v_exp_f32 v52, v52
    v_cos_f32 v54, v53
    v_sin_f32 v55, v53
    v_mul_f32 v16, v40, v42
    v_mul_f32 v17, v40, v43
    v_mul_f32 v18, v44, v46
    v_mul_f32 v19, v44, v47
    v_mul_f32 v20, v48, v50
    v_mul_f32 v21, v48, v51
    v_mul_f32 v22, v52, v54
    v_mul_f32 v23, v52, v55
    v_mov_b32 v56, 0x3f80
    v_and_b32 v2, 63, v0
    v_and_b32 v4, 15, v2
    v_lshrrev_b32 v5, 4, v2
    v_mul_u32_u24 v6, 528, v4
    v_lshl_add_u32 v6, v5, 4, v6
    s_mul_i32 s10, s9, 8448
    v_add_u32 v6, s10, v6
    v_lshl_add_u32 v7, v5, 6, v4
    v_lshlrev_b32 v7, 2, v7
    ds_write_b32 v1, v56 offset:16896
    v_mov_b32 v60, v16
    v_mov_b32 v61, v17
    ds_write_b32 v1, v56 offset:25344
    v_mov_b32 v62, v18
    v_mov_b32 v63, v19
    v_cvt_pk_bf16_f32 v84, v60, v61
    ds_write_b32 v1, v84 offset:17424
    v_pk_mul_f32 v[76:77], v[60:61], v[16:17] op_sel:[0,0] op_sel_hi:[0,1] neg_hi:[0,0]
    v_pk_fma_f32 v[60:61], v[60:61], v[16:17], v[76:77] op_sel:[1,1,0] op_sel_hi:[1,0,1] neg_lo:[0,1,0]
    v_cvt_pk_bf16_f32 v85, v62, v63
    ds_write_b32 v1, v85 offset:25872
    v_pk_mul_f32 v[78:79], v[62:63], v[18:19] op_sel:[0,0] op_sel_hi:[0,1] neg_hi:[0,0]
    v_pk_fma_f32 v[62:63], v[62:63], v[18:19], v[78:79] op_sel:[1,1,0] op_sel_hi:[1,0,1] neg_lo:[0,1,0]
    v_cvt_pk_bf16_f32 v84, v60, v61
    ds_write_b32 v1, v84 offset:17952
    v_pk_mul_f32 v[76:77], v[60:61], v[16:17] op_sel:[0,0] op_sel_hi:[0,1] neg_hi:[0,0]
    v_pk_fma_f32 v[60:61], v[60:61], v[16:17], v[76:77] op_sel:[1,1,0] op_sel_hi:[1,0,1] neg_lo:[0,1,0]
    v_cvt_pk_bf16_f32 v85, v62, v63
    ds_write_b32 v1, v85 offset:26400
    v_pk_mul_f32 v[78:79], v[62:63], v[18:19] op_sel:[0,0] op_sel_hi:[0,1] neg_hi:[0,0]
    v_pk_fma_f32 v[62:63], v[62:63], v[18:19], v[78:79] op_sel:[1,1,0] op_sel_hi:[1,0,1] neg_lo:[0,1,0]
    v_cvt_pk_bf16_f32 v84, v60, v61
    ds_write_b32 v1, v84 offset:18480
    v_pk_mul_f32 v[76:77], v[60:61], v[16:17] op_sel:[0,0] op_sel_hi:[0,1] neg_hi:[0,0]
    v_pk_fma_f32 v[60:61], v[60:61], v[16:17], v[76:77] op_sel:[1,1,0] op_sel_hi:[1,0,1] neg_lo:[0,1,0]
    v_cvt_pk_bf16_f32 v85, v62, v63
    ds_write_b32 v1, v85 offset:26928
    v_pk_mul_f32 v[78:79], v[62:63], v[18:19] op_sel:[0,0] op_sel_hi:[0,1] neg_hi:[0,0]
    v_pk_fma_f32 v[62:63], v[62:63], v[18:19], v[78:79] op_sel:[1,1,0] op_sel_hi:[1,0,1] neg_lo:[0,1,0]
    v_cvt_pk_bf16_f32 v84, v60, v61
    ds_write_b32 v1, v84 offset:19008
    v_pk_mul_f32 v[76:77], v[60:61], v[16:17] op_sel:[0,0] op_sel_hi:[0,1] neg_hi:[0,0]
    v_pk_fma_f32 v[60:61], v[60:61], v[16:17], v[76:77] op_sel:[1,1,0] op_sel_hi:[1,0,1] neg_lo:[0,1,0]
    v_cvt_pk_bf16_f32 v85, v62, v63
    ds_write_b32 v1, v85 offset:27456
    v_pk_mul_f32 v[78:79], v[62:63], v[18:19] op_sel:[0,0] op_sel_hi:[0,1] neg_hi:[0,0]
    v_pk_fma_f32 v[62:63], v[62:63], v[18:19], v[78:79] op_sel:[1,1,0] op_sel_hi:[1,0,1] neg_lo:[0,1,0]
    v_cvt_pk_bf16_f32 v84, v60, v61
    ds_write_b32 v1, v84 offset:19536
    v_pk_mul_f32 v[76:77], v[60:61], v[16:17] op_sel:[0,0] op_sel_hi:[0,1] neg_hi:[0,0]
    v_pk_fma_f32 v[60:61], v[60:61], v[16:17], v[76:77] op_sel:[1,1,0] op_sel_hi:[1,0,1] neg_lo:[0,1,0]
    v_cvt_pk_bf16_f32 v85, v62, v63
    ds_write_b32 v1, v85 offset:27984
    v_pk_mul_f32 v[78:79], v[62:63], v[18:19] op_sel:[0,0] op_sel_hi:[0,1] neg_hi:[0,0]
    v_pk_fma_f32 v[62:63], v[62:63], v[18:19], v[78:79] op_sel:[1,1,0] op_sel_hi:[1,0,1] neg_lo:[0,1,0]
    v_cvt_pk_bf16_f32 v84, v60, v61
    ds_write_b32 v1, v84 offset:20064
    v_pk_mul_f32 v[76:77], v[60:61], v[16:17] op_sel:[0,0] op_sel_hi:[0,1] neg_hi:[0,0]
    v_pk_fma_f32 v[60:61], v[60:61], v[16:17], v[76:77] op_sel:[1,1,0] op_sel_hi:[1,0,1] neg_lo:[0,1,0]
    v_cvt_pk_bf16_f32 v85, v62, v63
    ds_write_b32 v1, v85 offset:28512
    v_pk_mul_f32 v[78:79], v[62:63], v[18:19] op_sel:[0,0] op_sel_hi:[0,1] neg_hi:[0,0]
    v_pk_fma_f32 v[62:63], v[62:63], v[18:19], v[78:79] op_sel:[1,1,0] op_sel_hi:[1,0,1] neg_lo:[0,1,0]
    v_cvt_pk_bf16_f32 v84, v60, v61
    ds_write_b32 v1, v84 offset:20592
    v_pk_mul_f32 v[76:77], v[60:61], v[16:17] op_sel:[0,0] op_sel_hi:[0,1] neg_hi:[0,0]
    v_pk_fma_f32 v[60:61], v[60:61], v[16:17], v[76:77] op_sel:[1,1,0] op_sel_hi:[1,0,1] neg_lo:[0,1,0]
    v_cvt_pk_bf16_f32 v85, v62, v63
    ds_write_b32 v1, v85 offset:29040
    v_pk_mul_f32 v[78:79], v[62:63], v[18:19] op_sel:[0,0] op_sel_hi:[0,1] neg_hi:[0,0]
    v_pk_fma_f32 v[62:63], v[62:63], v[18:19], v[78:79] op_sel:[1,1,0] op_sel_hi:[1,0,1] neg_lo:[0,1,0]
    v_cvt_pk_bf16_f32 v84, v60, v61
    ds_write_b32 v1, v84 offset:21120
    v_pk_mul_f32 v[76:77], v[60:61], v[16:17] op_sel:[0,0] op_sel_hi:[0,1] neg_hi:[0,0]
    v_pk_fma_f32 v[60:61], v[60:61], v[16:17], v[76:77] op_sel:[1,1,0] op_sel_hi:[1,0,1] neg_lo:[0,1,0]
    v_cvt_pk_bf16_f32 v85, v62, v63
    ds_write_b32 v1, v85 offset:29568
    v_pk_mul_f32 v[78:79], v[62:63], v[18:19] op_sel:[0,0] op_sel_hi:[0,1] neg_hi:[0,0]
    v_pk_fma_f32 v[62:63], v[62:63], v[18:19], v[78:79] op_sel:[1,1,0] op_sel_hi:[1,0,1] neg_lo:[0,1,0]
    v_cvt_pk_bf16_f32 v84, v60, v61
    ds_write_b32 v1, v84 offset:21648
    v_pk_mul_f32 v[76:77], v[60:61], v[16:17] op_sel:[0,0] op_sel_hi:[0,1] neg_hi:[0,0]
    v_pk_fma_f32 v[60:61], v[60:61], v[16:17], v[76:77] op_sel:[1,1,0] op_sel_hi:[1,0,1] neg_lo:[0,1,0]
    v_cvt_pk_bf16_f32 v85, v62, v63
    ds_write_b32 v1, v85 offset:30096
    v_pk_mul_f32 v[78:79], v[62:63], v[18:19] op_sel:[0,0] op_sel_hi:[0,1] neg_hi:[0,0]
    v_pk_fma_f32 v[62:63], v[62:63], v[18:19], v[78:79] op_sel:[1,1,0] op_sel_hi:[1,0,1] neg_lo:[0,1,0]
    v_cvt_pk_bf16_f32 v84, v60, v61
    ds_write_b32 v1, v84 offset:22176
    v_pk_mul_f32 v[76:77], v[60:61], v[16:17] op_sel:[0,0] op_sel_hi:[0,1] neg_hi:[0,0]
    v_pk_fma_f32 v[60:61], v[60:61], v[16:17], v[76:77] op_sel:[1,1,0] op_sel_hi:[1,0,1] neg_lo:[0,1,0]
    v_cvt_pk_bf16_f32 v85, v62, v63
    ds_write_b32 v1, v85 offset:30624
    v_pk_mul_f32 v[78:79], v[62:63], v[18:19] op_sel:[0,0] op_sel_hi:[0,1] neg_hi:[0,0]
    v_pk_fma_f32 v[62:63], v[62:63], v[18:19], v[78:79] op_sel:[1,1,0] op_sel_hi:[1,0,1] neg_lo:[0,1,0]
    v_cvt_pk_bf16_f32 v84, v60, v61
    ds_write_b32 v1, v84 offset:22704
    v_pk_mul_f32 v[76:77], v[60:61], v[16:17] op_sel:[0,0] op_sel_hi:[0,1] neg_hi:[0,0]
    v_pk_fma_f32 v[60:61], v[60:61], v[16:17], v[76:77] op_sel:[1,1,0] op_sel_hi:[1,0,1] neg_lo:[0,1,0]
    v_cvt_pk_bf16_f32 v85, v62, v63
    ds_write_b32 v1, v85 offset:31152
    v_pk_mul_f32 v[78:79], v[62:63], v[18:19] op_sel:[0,0] op_sel_hi:[0,1] neg_hi:[0,0]
    v_pk_fma_f32 v[62:63], v[62:63], v[18:19], v[78:79] op_sel:[1,1,0] op_sel_hi:[1,0,1] neg_lo:[0,1,0]
    v_cvt_pk_bf16_f32 v84, v60, v61
    ds_write_b32 v1, v84 offset:23232
    v_pk_mul_f32 v[76:77], v[60:61], v[16:17] op_sel:[0,0] op_sel_hi:[0,1] neg_hi:[0,0]
    v_pk_fma_f32 v[60:61], v[60:61], v[16:17], v[76:77] op_sel:[1,1,0] op_sel_hi:[1,0,1] neg_lo:[0,1,0]
    v_cvt_pk_bf16_f32 v85, v62, v63
    ds_write_b32 v1, v85 offset:31680
    v_pk_mul_f32 v[78:79], v[62:63], v[18:19] op_sel:[0,0] op_sel_hi:[0,1] neg_hi:[0,0]
    v_pk_fma_f32 v[62:63], v[62:63], v[18:19], v[78:79] op_sel:[1,1,0] op_sel_hi:[1,0,1] neg_lo:[0,1,0]
    v_cvt_pk_bf16_f32 v84, v60, v61
    ds_write_b32 v1, v84 offset:23760
    v_pk_mul_f32 v[76:77], v[60:61], v[16:17] op_sel:[0,0] op_sel_hi:[0,1] neg_hi:[0,0]
    v_pk_fma_f32 v[60:61], v[60:61], v[16:17], v[76:77] op_sel:[1,1,0] op_sel_hi:[1,0,1] neg_lo:[0,1,0]
    v_cvt_pk_bf16_f32 v85, v62, v63
    ds_write_b32 v1, v85 offset:32208
    v_pk_mul_f32 v[78:79], v[62:63], v[18:19] op_sel:[0,0] op_sel_hi:[0,1] neg_hi:[0,0]
    v_pk_fma_f32 v[62:63], v[62:63], v[18:19], v[78:79] op_sel:[1,1,0] op_sel_hi:[1,0,1] neg_lo:[0,1,0]
    v_cvt_pk_bf16_f32 v84, v60, v61
    ds_write_b32 v1, v84 offset:24288
    v_pk_mul_f32 v[76:77], v[60:61], v[16:17] op_sel:[0,0] op_sel_hi:[0,1] neg_hi:[0,0]
    v_pk_fma_f32 v[60:61], v[60:61], v[16:17], v[76:77] op_sel:[1,1,0] op_sel_hi:[1,0,1] neg_lo:[0,1,0]
    v_cvt_pk_bf16_f32 v85, v62, v63
    ds_write_b32 v1, v85 offset:32736
    v_pk_mul_f32 v[78:79], v[62:63], v[18:19] op_sel:[0,0] op_sel_hi:[0,1] neg_hi:[0,0]
    v_pk_fma_f32 v[62:63], v[62:63], v[18:19], v[78:79] op_sel:[1,1,0] op_sel_hi:[1,0,1] neg_lo:[0,1,0]
    v_cvt_pk_bf16_f32 v84, v60, v61
    ds_write_b32 v1, v84 offset:24816
    v_cvt_pk_bf16_f32 v85, v62, v63
    ds_write_b32 v1, v85 offset:33264
    s_waitcnt lgkmcnt(0)
    s_barrier
    v_mov_b32 v8, 0
    v_mov_b32 v9, 0
    v_mov_b32 v10, 0
    v_mov_b32 v11, 0
    ds_read_b128 v[88:91], v6 offset:0
    ds_read_b128 v[92:95], v6 offset:16896
    ds_read_b128 v[96:99], v6 offset:64
    ds_read_b128 v[100:103], v6 offset:16960
    ds_read_b128 v[104:107], v6 offset:128
    ds_read_b128 v[108:111], v6 offset:17024
    ds_read_b128 v[112:115], v6 offset:192
    ds_read_b128 v[116:119], v6 offset:17088
    s_waitcnt lgkmcnt(0)
    v_mfma_f32_16x16x32_bf16 v[8:11], v[88:91], v[92:95], v[8:11]
    v_mfma_f32_16x16x32_bf16 v[8:11], v[96:99], v[100:103], v[8:11]
    v_mfma_f32_16x16x32_bf16 v[8:11], v[104:107], v[108:111], v[8:11]
    v_mfma_f32_16x16x32_bf16 v[8:11], v[112:115], v[116:119], v[8:11]
    ds_read_b128 v[88:91], v6 offset:256
    ds_read_b128 v[92:95], v6 offset:17152
    ds_read_b128 v[96:99], v6 offset:320
    ds_read_b128 v[100:103], v6 offset:17216
    ds_read_b128 v[104:107], v6 offset:384
    ds_read_b128 v[108:111], v6 offset:17280
    ds_read_b128 v[112:115], v6 offset:448
    ds_read_b128 v[116:119], v6 offset:17344
    s_waitcnt lgkmcnt(0)
    v_mfma_f32_16x16x32_bf16 v[8:11], v[88:91], v[92:95], v[8:11]
    v_mfma_f32_16x16x32_bf16 v[8:11], v[96:99], v[100:103], v[8:11]
    v_mfma_f32_16x16x32_bf16 v[8:11], v[104:107], v[108:111], v[8:11]
    v_mfma_f32_16x16x32_bf16 v[8:11], v[112:115], v[116:119], v[8:11]
    s_cmp_eq_u32 s9, 1
    s_cbranch_scc1 k1_kernel_b2_k0w1
    s_nop 5
    ds_write_b32 v7, v8 offset:33792
    ds_write_b32 v7, v9 offset:33856
    ds_write_b32 v7, v10 offset:33920
    ds_write_b32 v7, v11 offset:33984
    s_branch k1_kernel_b2_k0d
k1_kernel_b2_k0w1:
    s_nop 7
    v_cmp_gt_u32 vcc, 2, v5
    s_and_saveexec_b64 s[4:5], vcc
    ds_write_b32 v7, v8 offset:34816
    ds_write_b32 v7, v9 offset:34880
    ds_write_b32 v7, v10 offset:34944
    ds_write_b32 v7, v11 offset:35008
    s_mov_b64 exec, s[4:5]
k1_kernel_b2_k0d:
    s_waitcnt lgkmcnt(0)
    s_barrier
    ds_write_b32 v1, v56 offset:16896
    v_mov_b32 v60, v20
    v_mov_b32 v61, v21
    ds_write_b32 v1, v56 offset:25344
    v_mov_b32 v62, v22
    v_mov_b32 v63, v23
    v_cvt_pk_bf16_f32 v84, v60, v61
    ds_write_b32 v1, v84 offset:17424
    v_pk_mul_f32 v[76:77], v[60:61], v[20:21] op_sel:[0,0] op_sel_hi:[0,1] neg_hi:[0,0]
    v_pk_fma_f32 v[60:61], v[60:61], v[20:21], v[76:77] op_sel:[1,1,0] op_sel_hi:[1,0,1] neg_lo:[0,1,0]
    v_cvt_pk_bf16_f32 v85, v62, v63
    ds_write_b32 v1, v85 offset:25872
    v_pk_mul_f32 v[78:79], v[62:63], v[22:23] op_sel:[0,0] op_sel_hi:[0,1] neg_hi:[0,0]
    v_pk_fma_f32 v[62:63], v[62:63], v[22:23], v[78:79] op_sel:[1,1,0] op_sel_hi:[1,0,1] neg_lo:[0,1,0]
    v_cvt_pk_bf16_f32 v84, v60, v61
    ds_write_b32 v1, v84 offset:17952
    v_pk_mul_f32 v[76:77], v[60:61], v[20:21] op_sel:[0,0] op_sel_hi:[0,1] neg_hi:[0,0]
    v_pk_fma_f32 v[60:61], v[60:61], v[20:21], v[76:77] op_sel:[1,1,0] op_sel_hi:[1,0,1] neg_lo:[0,1,0]
    v_cvt_pk_bf16_f32 v85, v62, v63
    ds_write_b32 v1, v85 offset:26400
    v_pk_mul_f32 v[78:79], v[62:63], v[22:23] op_sel:[0,0] op_sel_hi:[0,1] neg_hi:[0,0]
    v_pk_fma_f32 v[62:63], v[62:63], v[22:23], v[78:79] op_sel:[1,1,0] op_sel_hi:[1,0,1] neg_lo:[0,1,0]
    v_cvt_pk_bf16_f32 v84, v60, v61
    ds_write_b32 v1, v84 offset:18480
    v_pk_mul_f32 v[76:77], v[60:61], v[20:21] op_sel:[0,0] op_sel_hi:[0,1] neg_hi:[0,0]
    v_pk_fma_f32 v[60:61], v[60:61], v[20:21], v[76:77] op_sel:[1,1,0] op_sel_hi:[1,0,1] neg_lo:[0,1,0]
    v_cvt_pk_bf16_f32 v85, v62, v63
    ds_write_b32 v1, v85 offset:26928
    v_pk_mul_f32 v[78:79], v[62:63], v[22:23] op_sel:[0,0] op_sel_hi:[0,1] neg_hi:[0,0]
    v_pk_fma_f32 v[62:63], v[62:63], v[22:23], v[78:79] op_sel:[1,1,0] op_sel_hi:[1,0,1] neg_lo:[0,1,0]
    v_cvt_pk_bf16_f32 v84, v60, v61
    ds_write_b32 v1, v84 offset:19008
    v_pk_mul_f32 v[76:77], v[60:61], v[20:21] op_sel:[0,0] op_sel_hi:[0,1] neg_hi:[0,0]
    v_pk_fma_f32 v[60:61], v[60:61], v[20:21], v[76:77] op_sel:[1,1,0] op_sel_hi:[1,0,1] neg_lo:[0,1,0]
    v_cvt_pk_bf16_f32 v85, v62, v63
    ds_write_b32 v1, v85 offset:27456
    v_pk_mul_f32 v[78:79], v[62:63], v[22:23] op_sel:[0,0] op_sel_hi:[0,1] neg_hi:[0,0]
    v_pk_fma_f32 v[62:63], v[62:63], v[22:23], v[78:79] op_sel:[1,1,0] op_sel_hi:[1,0,1] neg_lo:[0,1,0]
    v_cvt_pk_bf16_f32 v84, v60, v61
    ds_write_b32 v1, v84 offset:19536
    v_pk_mul_f32 v[76:77], v[60:61], v[20:21] op_sel:[0,0] op_sel_hi:[0,1] neg_hi:[0,0]
    v_pk_fma_f32 v[60:61], v[60:61], v[20:21], v[76:77] op_sel:[1,1,0] op_sel_hi:[1,0,1] neg_lo:[0,1,0]
    v_cvt_pk_bf16_f32 v85, v62, v63
    ds_write_b32 v1, v85 offset:27984
    v_pk_mul_f32 v[78:79], v[62:63], v[22:23] op_sel:[0,0] op_sel_hi:[0,1] neg_hi:[0,0]
    v_pk_fma_f32 v[62:63], v[62:63], v[22:23], v[78:79] op_sel:[1,1,0] op_sel_hi:[1,0,1] neg_lo:[0,1,0]
    v_cvt_pk_bf16_f32 v84, v60, v61
    ds_write_b32 v1, v84 offset:20064
    v_pk_mul_f32 v[76:77], v[60:61], v[20:21] op_sel:[0,0] op_sel_hi:[0,1] neg_hi:[0,0]
    v_pk_fma_f32 v[60:61], v[60:61], v[20:21], v[76:77] op_sel:[1,1,0] op_sel_hi:[1,0,1] neg_lo:[0,1,0]
    v_cvt_pk_bf16_f32 v85, v62, v63
    ds_write_b32 v1, v85 offset:28512
    v_pk_mul_f32 v[78:79], v[62:63], v[22:23] op_sel:[0,0] op_sel_hi:[0,1] neg_hi:[0,0]
    v_pk_fma_f32 v[62:63], v[62:63], v[22:23], v[78:79] op_sel:[1,1,0] op_sel_hi:[1,0,1] neg_lo:[0,1,0]
    v_cvt_pk_bf16_f32 v84, v60, v61
    ds_write_b32 v1, v84 offset:20592
    v_pk_mul_f32 v[76:77], v[60:61], v[20:21] op_sel:[0,0] op_sel_hi:[0,1] neg_hi:[0,0]
    v_pk_fma_f32 v[60:61], v[60:61], v[20:21], v[76:77] op_sel:[1,1,0] op_sel_hi:[1,0,1] neg_lo:[0,1,0]
    v_cvt_pk_bf16_f32 v85, v62, v63
    ds_write_b32 v1, v85 offset:29040
    v_pk_mul_f32 v[78:79], v[62:63], v[22:23] op_sel:[0,0] op_sel_hi:[0,1] neg_hi:[0,0]
    v_pk_fma_f32 v[62:63], v[62:63], v[22:23], v[78:79] op_sel:[1,1,0] op_sel_hi:[1,0,1] neg_lo:[0,1,0]
    v_cvt_pk_bf16_f32 v84, v60, v61
    ds_write_b32 v1, v84 offset:21120
    v_pk_mul_f32 v[76:77], v[60:61], v[20:21] op_sel:[0,0] op_sel_hi:[0,1] neg_hi:[0,0]
    v_pk_fma_f32 v[60:61], v[60:61], v[20:21], v[76:77] op_sel:[1,1,0] op_sel_hi:[1,0,1] neg_lo:[0,1,0]
    v_cvt_pk_bf16_f32 v85, v62, v63
    ds_write_b32 v1, v85 offset:29568
    v_pk_mul_f32 v[78:79], v[62:63], v[22:23] op_sel:[0,0] op_sel_hi:[0,1] neg_hi:[0,0]
    v_pk_fma_f32 v[62:63], v[62:63], v[22:23], v[78:79] op_sel:[1,1,0] op_sel_hi:[1,0,1] neg_lo:[0,1,0]
    v_cvt_pk_bf16_f32 v84, v60, v61
    ds_write_b32 v1, v84 offset:21648
    v_pk_mul_f32 v[76:77], v[60:61], v[20:21] op_sel:[0,0] op_sel_hi:[0,1] neg_hi:[0,0]
    v_pk_fma_f32 v[60:61], v[60:61], v[20:21], v[76:77] op_sel:[1,1,0] op_sel_hi:[1,0,1] neg_lo:[0,1,0]
    v_cvt_pk_bf16_f32 v85, v62, v63
    ds_write_b32 v1, v85 offset:30096
    v_pk_mul_f32 v[78:79], v[62:63], v[22:23] op_sel:[0,0] op_sel_hi:[0,1] neg_hi:[0,0]
    v_pk_fma_f32 v[62:63], v[62:63], v[22:23], v[78:79] op_sel:[1,1,0] op_sel_hi:[1,0,1] neg_lo:[0,1,0]
    v_cvt_pk_bf16_f32 v84, v60, v61
    ds_write_b32 v1, v84 offset:22176
    v_pk_mul_f32 v[76:77], v[60:61], v[20:21] op_sel:[0,0] op_sel_hi:[0,1] neg_hi:[0,0]
    v_pk_fma_f32 v[60:61], v[60:61], v[20:21], v[76:77] op_sel:[1,1,0] op_sel_hi:[1,0,1] neg_lo:[0,1,0]
    v_cvt_pk_bf16_f32 v85, v62, v63
    ds_write_b32 v1, v85 offset:30624
    v_pk_mul_f32 v[78:79], v[62:63], v[22:23] op_sel:[0,0] op_sel_hi:[0,1] neg_hi:[0,0]
    v_pk_fma_f32 v[62:63], v[62:63], v[22:23], v[78:79] op_sel:[1,1,0] op_sel_hi:[1,0,1] neg_lo:[0,1,0]
    v_cvt_pk_bf16_f32 v84, v60, v61
    ds_write_b32 v1, v84 offset:22704
    v_pk_mul_f32 v[76:77], v[60:61], v[20:21] op_sel:[0,0] op_sel_hi:[0,1] neg_hi:[0,0]
    v_pk_fma_f32 v[60:61], v[60:61], v[20:21], v[76:77] op_sel:[1,1,0] op_sel_hi:[1,0,1] neg_lo:[0,1,0]
    v_cvt_pk_bf16_f32 v85, v62, v63
    ds_write_b32 v1, v85 offset:31152
    v_pk_mul_f32 v[78:79], v[62:63], v[22:23] op_sel:[0,0] op_sel_hi:[0,1] neg_hi:[0,0]
    v_pk_fma_f32 v[62:63], v[62:63], v[22:23], v[78:79] op_sel:[1,1,0] op_sel_hi:[1,0,1] neg_lo:[0,1,0]
    v_cvt_pk_bf16_f32 v84, v60, v61
    ds_write_b32 v1, v84 offset:23232
    v_pk_mul_f32 v[76:77], v[60:61], v[20:21] op_sel:[0,0] op_sel_hi:[0,1] neg_hi:[0,0]
    v_pk_fma_f32 v[60:61], v[60:61], v[20:21], v[76:77] op_sel:[1,1,0] op_sel_hi:[1,0,1] neg_lo:[0,1,0]
    v_cvt_pk_bf16_f32 v85, v62, v63
    ds_write_b32 v1, v85 offset:31680
    v_pk_mul_f32 v[78:79], v[62:63], v[22:23] op_sel:[0,0] op_sel_hi:[0,1] neg_hi:[0,0]
    v_pk_fma_f32 v[62:63], v[62:63], v[22:23], v[78:79] op_sel:[1,1,0] op_sel_hi:[1,0,1] neg_lo:[0,1,0]
    v_cvt_pk_bf16_f32 v84, v60, v61
    ds_write_b32 v1, v84 offset:23760
    v_pk_mul_f32 v[76:77], v[60:61], v[20:21] op_sel:[0,0] op_sel_hi:[0,1] neg_hi:[0,0]
    v_pk_fma_f32 v[60:61], v[60:61], v[20:21], v[76:77] op_sel:[1,1,0] op_sel_hi:[1,0,1] neg_lo:[0,1,0]
    v_cvt_pk_bf16_f32 v85, v62, v63
    ds_write_b32 v1, v85 offset:32208
    v_pk_mul_f32 v[78:79], v[62:63], v[22:23] op_sel:[0,0] op_sel_hi:[0,1] neg_hi:[0,0]
    v_pk_fma_f32 v[62:63], v[62:63], v[22:23], v[78:79] op_sel:[1,1,0] op_sel_hi:[1,0,1] neg_lo:[0,1,0]
    v_cvt_pk_bf16_f32 v84, v60, v61
    ds_write_b32 v1, v84 offset:24288
    v_pk_mul_f32 v[76:77], v[60:61], v[20:21] op_sel:[0,0] op_sel_hi:[0,1] neg_hi:[0,0]
    v_pk_fma_f32 v[60:61], v[60:61], v[20:21], v[76:77] op_sel:[1,1,0] op_sel_hi:[1,0,1] neg_lo:[0,1,0]
    v_cvt_pk_bf16_f32 v85, v62, v63
    ds_write_b32 v1, v85 offset:32736
    v_pk_mul_f32 v[78:79], v[62:63], v[22:23] op_sel:[0,0] op_sel_hi:[0,1] neg_hi:[0,0]
    v_pk_fma_f32 v[62:63], v[62:63], v[22:23], v[78:79] op_sel:[1,1,0] op_sel_hi:[1,0,1] neg_lo:[0,1,0]
    v_cvt_pk_bf16_f32 v84, v60, v61
    ds_write_b32 v1, v84 offset:24816
    v_cvt_pk_bf16_f32 v85, v62, v63
    ds_write_b32 v1, v85 offset:33264
    s_waitcnt lgkmcnt(0)
    s_barrier
    v_mov_b32 v8, 0
    v_mov_b32 v9, 0
    v_mov_b32 v10, 0
    v_mov_b32 v11, 0
    ds_read_b128 v[88:91], v6 offset:0
    ds_read_b128 v[92:95], v6 offset:16896
    ds_read_b128 v[96:99], v6 offset:64
    ds_read_b128 v[100:103], v6 offset:16960
    ds_read_b128 v[104:107], v6 offset:128
    ds_read_b128 v[108:111], v6 offset:17024
    ds_read_b128 v[112:115], v6 offset:192
    ds_read_b128 v[116:119], v6 offset:17088
    s_waitcnt lgkmcnt(0)
    v_mfma_f32_16x16x32_bf16 v[8:11], v[88:91], v[92:95], v[8:11]
    v_mfma_f32_16x16x32_bf16 v[8:11], v[96:99], v[100:103], v[8:11]
    v_mfma_f32_16x16x32_bf16 v[8:11], v[104:107], v[108:111], v[8:11]
    v_mfma_f32_16x16x32_bf16 v[8:11], v[112:115], v[116:119], v[8:11]
    ds_read_b128 v[88:91], v6 offset:256
    ds_read_b128 v[92:95], v6 offset:17152
    ds_read_b128 v[96:99], v6 offset:320
    ds_read_b128 v[100:103], v6 offset:17216
    ds_read_b128 v[104:107], v6 offset:384
    ds_read_b128 v[108:111], v6 offset:17280
    ds_read_b128 v[112:115], v6 offset:448
    ds_read_b128 v[116:119], v6 offset:17344
    s_waitcnt lgkmcnt(0)
    v_mfma_f32_16x16x32_bf16 v[8:11], v[88:91], v[92:95], v[8:11]
    v_mfma_f32_16x16x32_bf16 v[8:11], v[96:99], v[100:103], v[8:11]
    v_mfma_f32_16x16x32_bf16 v[8:11], v[104:107], v[108:111], v[8:11]
    v_mfma_f32_16x16x32_bf16 v[8:11], v[112:115], v[116:119], v[8:11]
    s_cmp_eq_u32 s9, 1
    s_cbranch_scc1 k1_kernel_b2_k1w1
    v_cmp_gt_u32 vcc, 2, v5
    s_and_saveexec_b64 s[4:5], vcc
    s_nop 3
    ds_write_b32 v7, v8 offset:35328
    ds_write_b32 v7, v9 offset:35392
    ds_write_b32 v7, v10 offset:35456
    ds_write_b32 v7, v11 offset:35520
    s_mov_b64 exec, s[4:5]
    s_branch k1_kernel_b2_k1d
k1_kernel_b2_k1w1:
    s_nop 7
    v_cmp_gt_u32 vcc, 2, v5
    s_and_saveexec_b64 s[4:5], vcc
    ds_write_b32 v7, v8 offset:35840
    ds_write_b32 v7, v9 offset:35904
    ds_write_b32 v7, v10 offset:35968
    ds_write_b32 v7, v11 offset:36032
    s_mov_b64 exec, s[4:5]
    v_cmp_eq_u32 vcc, 32, v2
    s_and_saveexec_b64 s[4:5], vcc
    ds_write_b32 v7, v8 offset:35840
    s_mov_b64 exec, s[4:5]
k1_kernel_b2_k1d:
    s_waitcnt lgkmcnt(0)
    s_barrier
    s_branch k1_kernel_b2_expand
k1_kernel_b2_roleA:
    v_mul_f32 v40, 0x41800000, v12
    v_mul_f32 v41, 0x41800000, v13
    v_fract_f32 v41, v41
    v_mul_f32 v44, 0x42000000, v12
    v_mul_f32 v45, 0x42000000, v13
    v_fract_f32 v45, v45
    v_mul_f32 v48, 0x42800000, v12
    v_mul_f32 v49, 0x42800000, v13
    v_fract_f32 v49, v49
    v_mul_f32 v52, 0x43000000, v12
    v_mul_f32 v53, 0x43000000, v13
    v_fract_f32 v53, v53
    v_exp_f32 v40, v40
    v_cos_f32 v42, v41
    v_sin_f32 v43, v41
    v_exp_f32 v44, v44
    v_cos_f32 v46, v45
    v_sin_f32 v47, v45
    v_exp_f32 v48, v48
    v_cos_f32 v50, v49
    v_sin_f32 v51, v49
    v_exp_f32 v52, v52
    v_cos_f32 v54, v53
    v_sin_f32 v55, v53
    v_mul_f32 v24, v40, v42
    v_mul_f32 v25, v40, v43
    v_mul_f32 v26, v44, v46
    v_mul_f32 v27, v44, v47
    v_mul_f32 v28, v48, v50
    v_mul_f32 v29, v48, v51
    v_mul_f32 v30, v52, v54
    v_mul_f32 v31, v52, v55
    v_mul_f32 v40, 0x43800000, v12
    v_mul_f32 v41, 0x43800000, v13
    v_fract_f32 v41, v41
    v_mul_f32 v44, 0x44000000, v12
    v_mul_f32 v45, 0x44000000, v13
    v_fract_f32 v45, v45
    v_mul_f32 v48, 0x44800000, v12
    v_mul_f32 v49, 0x44800000, v13
    v_fract_f32 v49, v49
    v_exp_f32 v40, v40
    v_cos_f32 v42, v41
    v_sin_f32 v43, v41
    v_exp_f32 v44, v44
    v_cos_f32 v46, v45
    v_sin_f32 v47, v45
    v_exp_f32 v48, v48
    v_cos_f32 v50, v49
    v_sin_f32 v51, v49
    v_mul_f32 v32, v40, v42
    v_mul_f32 v33, v40, v43
    v_mul_f32 v34, v44, v46
    v_mul_f32 v35, v44, v47
    v_mul_f32 v36, v48, v50
    v_mul_f32 v37, v48, v51
    v_mov_b32 v60, v14
    v_mov_b32 v61, v15
    v_pk_mul_f32 v[78:79], v[14:15], v[32:33] op_sel:[0,0] op_sel_hi:[0,1] neg_hi:[0,0]
    v_pk_fma_f32 v[62:63], v[14:15], v[32:33], v[78:79] op_sel:[1,1,0] op_sel_hi:[1,0,1] neg_lo:[0,1,0]
    v_cvt_pk_bf16_f32 v84, v60, -v61
    ds_write_b32 v1, v84 offset:0
    v_pk_mul_f32 v[76:77], v[60:61], v[24:25] op_sel:[0,0] op_sel_hi:[0,1] neg_hi:[0,0]
    v_pk_fma_f32 v[60:61], v[60:61], v[24:25], v[76:77] op_sel:[1,1,0] op_sel_hi:[1,0,1] neg_lo:[0,1,0]
    v_cvt_pk_bf16_f32 v85, v62, -v63
    ds_write_b32 v1, v85 offset:8448
    v_pk_mul_f32 v[78:79], v[62:63], v[26:27] op_sel:[0,0] op_sel_hi:[0,1] neg_hi:[0,0]
    v_pk_fma_f32 v[62:63], v[62:63], v[26:27], v[78:79] op_sel:[1,1,0] op_sel_hi:[1,0,1] neg_lo:[0,1,0]
    v_cvt_pk_bf16_f32 v84, v60, -v61
    ds_write_b32 v1, v84 offset:528
    v_pk_mul_f32 v[76:77], v[60:61], v[24:25] op_sel:[0,0] op_sel_hi:[0,1] neg_hi:[0,0]
    v_pk_fma_f32 v[60:61], v[60:61], v[24:25], v[76:77] op_sel:[1,1,0] op_sel_hi:[1,0,1] neg_lo:[0,1,0]
    v_cvt_pk_bf16_f32 v85, v62, -v63
    ds_write_b32 v1, v85 offset:8976
    v_pk_mul_f32 v[78:79], v[62:63], v[26:27] op_sel:[0,0] op_sel_hi:[0,1] neg_hi:[0,0]
    v_pk_fma_f32 v[62:63], v[62:63], v[26:27], v[78:79] op_sel:[1,1,0] op_sel_hi:[1,0,1] neg_lo:[0,1,0]
    v_cvt_pk_bf16_f32 v84, v60, -v61
    ds_write_b32 v1, v84 offset:1056
    v_pk_mul_f32 v[76:77], v[60:61], v[24:25] op_sel:[0,0] op_sel_hi:[0,1] neg_hi:[0,0]
    v_pk_fma_f32 v[60:61], v[60:61], v[24:25], v[76:77] op_sel:[1,1,0] op_sel_hi:[1,0,1] neg_lo:[0,1,0]
    v_cvt_pk_bf16_f32 v85, v62, -v63
    ds_write_b32 v1, v85 offset:9504
    v_pk_mul_f32 v[78:79], v[62:63], v[26:27] op_sel:[0,0] op_sel_hi:[0,1] neg_hi:[0,0]
    v_pk_fma_f32 v[62:63], v[62:63], v[26:27], v[78:79] op_sel:[1,1,0] op_sel_hi:[1,0,1] neg_lo:[0,1,0]
    v_cvt_pk_bf16_f32 v84, v60, -v61
    ds_write_b32 v1, v84 offset:1584
    v_pk_mul_f32 v[76:77], v[60:61], v[24:25] op_sel:[0,0] op_sel_hi:[0,1] neg_hi:[0,0]
    v_pk_fma_f32 v[60:61], v[60:61], v[24:25], v[76:77] op_sel:[1,1,0] op_sel_hi:[1,0,1] neg_lo:[0,1,0]
    v_cvt_pk_bf16_f32 v85, v62, -v63
    ds_write_b32 v1, v85 offset:10032
    v_pk_mul_f32 v[78:79], v[62:63], v[26:27] op_sel:[0,0] op_sel_hi:[0,1] neg_hi:[0,0]
    v_pk_fma_f32 v[62:63], v[62:63], v[26:27], v[78:79] op_sel:[1,1,0] op_sel_hi:[1,0,1] neg_lo:[0,1,0]
    v_cvt_pk_bf16_f32 v84, v60, -v61
    ds_write_b32 v1, v84 offset:2112
    v_pk_mul_f32 v[76:77], v[60:61], v[24:25] op_sel:[0,0] op_sel_hi:[0,1] neg_hi:[0,0]
    v_pk_fma_f32 v[60:61], v[60:61], v[24:25], v[76:77] op_sel:[1,1,0] op_sel_hi:[1,0,1] neg_lo:[0,1,0]
    v_cvt_pk_bf16_f32 v85, v62, -v63
    ds_write_b32 v1, v85 offset:10560
    v_pk_mul_f32 v[78:79], v[62:63], v[26:27] op_sel:[0,0] op_sel_hi:[0,1] neg_hi:[0,0]
    v_pk_fma_f32 v[62:63], v[62:63], v[26:27], v[78:79] op_sel:[1,1,0] op_sel_hi:[1,0,1] neg_lo:[0,1,0]
    v_cvt_pk_bf16_f32 v84, v60, -v61
    ds_write_b32 v1, v84 offset:2640
    v_pk_mul_f32 v[76:77], v[60:61], v[24:25] op_sel:[0,0] op_sel_hi:[0,1] neg_hi:[0,0]
    v_pk_fma_f32 v[60:61], v[60:61], v[24:25], v[76:77] op_sel:[1,1,0] op_sel_hi:[1,0,1] neg_lo:[0,1,0]
    v_cvt_pk_bf16_f32 v85, v62, -v63
    ds_write_b32 v1, v85 offset:11088
    v_pk_mul_f32 v[78:79], v[62:63], v[26:27] op_sel:[0,0] op_sel_hi:[0,1] neg_hi:[0,0]
    v_pk_fma_f32 v[62:63], v[62:63], v[26:27], v[78:79] op_sel:[1,1,0] op_sel_hi:[1,0,1] neg_lo:[0,1,0]
    v_cvt_pk_bf16_f32 v84, v60, -v61
    ds_write_b32 v1, v84 offset:3168
    v_pk_mul_f32 v[76:77], v[60:61], v[24:25] op_sel:[0,0] op_sel_hi:[0,1] neg_hi:[0,0]
    v_pk_fma_f32 v[60:61], v[60:61], v[24:25], v[76:77] op_sel:[1,1,0] op_sel_hi:[1,0,1] neg_lo:[0,1,0]
    v_cvt_pk_bf16_f32 v85, v62, -v63
    ds_write_b32 v1, v85 offset:11616
    v_pk_mul_f32 v[78:79], v[62:63], v[26:27] op_sel:[0,0] op_sel_hi:[0,1] neg_hi:[0,0]
    v_pk_fma_f32 v[62:63], v[62:63], v[26:27], v[78:79] op_sel:[1,1,0] op_sel_hi:[1,0,1] neg_lo:[0,1,0]
    v_cvt_pk_bf16_f32 v84, v60, -v61
    ds_write_b32 v1, v84 offset:3696
    v_pk_mul_f32 v[76:77], v[60:61], v[24:25] op_sel:[0,0] op_sel_hi:[0,1] neg_hi:[0,0]
    v_pk_fma_f32 v[60:61], v[60:61], v[24:25], v[76:77] op_sel:[1,1,0] op_sel_hi:[1,0,1] neg_lo:[0,1,0]
    v_cvt_pk_bf16_f32 v85, v62, -v63
    ds_write_b32 v1, v85 offset:12144
    v_cvt_pk_bf16_f32 v84, v60, -v61
    ds_write_b32 v1, v84 offset:4224
    v_pk_mul_f32 v[76:77], v[60:61], v[24:25] op_sel:[0,0] op_sel_hi:[0,1] neg_hi:[0,0]
    v_pk_fma_f32 v[60:61], v[60:61], v[24:25], v[76:77] op_sel:[1,1,0] op_sel_hi:[1,0,1] neg_lo:[0,1,0]
    v_cvt_pk_bf16_f32 v84, v60, -v61
    ds_write_b32 v1, v84 offset:4752
    v_pk_mul_f32 v[76:77], v[60:61], v[24:25] op_sel:[0,0] op_sel_hi:[0,1] neg_hi:[0,0]
    v_pk_fma_f32 v[60:61], v[60:61], v[24:25], v[76:77] op_sel:[1,1,0] op_sel_hi:[1,0,1] neg_lo:[0,1,0]
    v_cvt_pk_bf16_f32 v84, v60, -v61
    ds_write_b32 v1, v84 offset:5280
    v_pk_mul_f32 v[76:77], v[60:61], v[24:25] op_sel:[0,0] op_sel_hi:[0,1] neg_hi:[0,0]
    v_pk_fma_f32 v[60:61], v[60:61], v[24:25], v[76:77] op_sel:[1,1,0] op_sel_hi:[1,0,1] neg_lo:[0,1,0]
    v_cvt_pk_bf16_f32 v84, v60, -v61
    ds_write_b32 v1, v84 offset:5808
    v_pk_mul_f32 v[76:77], v[60:61], v[24:25] op_sel:[0,0] op_sel_hi:[0,1] neg_hi:[0,0]
    v_pk_fma_f32 v[60:61], v[60:61], v[24:25], v[76:77] op_sel:[1,1,0] op_sel_hi:[1,0,1] neg_lo:[0,1,0]
    v_cvt_pk_bf16_f32 v84, v60, -v61
    ds_write_b32 v1, v84 offset:6336
    v_pk_mul_f32 v[76:77], v[60:61], v[24:25] op_sel:[0,0] op_sel_hi:[0,1] neg_hi:[0,0]
    v_pk_fma_f32 v[60:61], v[60:61], v[24:25], v[76:77] op_sel:[1,1,0] op_sel_hi:[1,0,1] neg_lo:[0,1,0]
    v_cvt_pk_bf16_f32 v84, v60, -v61
    ds_write_b32 v1, v84 offset:6864
    v_pk_mul_f32 v[76:77], v[60:61], v[24:25] op_sel:[0,0] op_sel_hi:[0,1] neg_hi:[0,0]
    v_pk_fma_f32 v[60:61], v[60:61], v[24:25], v[76:77] op_sel:[1,1,0] op_sel_hi:[1,0,1] neg_lo:[0,1,0]
    v_cvt_pk_bf16_f32 v84, v60, -v61
    ds_write_b32 v1, v84 offset:7392
    v_pk_mul_f32 v[76:77], v[60:61], v[24:25] op_sel:[0,0] op_sel_hi:[0,1] neg_hi:[0,0]
    v_pk_fma_f32 v[60:61], v[60:61], v[24:25], v[76:77] op_sel:[1,1,0] op_sel_hi:[1,0,1] neg_lo:[0,1,0]
    v_cvt_pk_bf16_f32 v84, v60, -v61
    ds_write_b32 v1, v84 offset:7920
    s_waitcnt lgkmcnt(0)
    s_barrier
    s_barrier
    v_pk_mul_f32 v[76:77], v[14:15], v[34:35] op_sel:[0,0] op_sel_hi:[0,1] neg_hi:[0,0]
    v_pk_fma_f32 v[60:61], v[14:15], v[34:35], v[76:77] op_sel:[1,1,0] op_sel_hi:[1,0,1] neg_lo:[0,1,0]
    v_pk_mul_f32 v[78:79], v[14:15], v[36:37] op_sel:[0,0] op_sel_hi:[0,1] neg_hi:[0,0]
    v_pk_fma_f32 v[62:63], v[14:15], v[36:37], v[78:79] op_sel:[1,1,0] op_sel_hi:[1,0,1] neg_lo:[0,1,0]
    v_cvt_pk_bf16_f32 v84, v60, -v61
    ds_write_b32 v1, v84 offset:0
    v_pk_mul_f32 v[76:77], v[60:61], v[28:29] op_sel:[0,0] op_sel_hi:[0,1] neg_hi:[0,0]
    v_pk_fma_f32 v[60:61], v[60:61], v[28:29], v[76:77] op_sel:[1,1,0] op_sel_hi:[1,0,1] neg_lo:[0,1,0]
    v_cvt_pk_bf16_f32 v85, v62, -v63
    ds_write_b32 v1, v85 offset:8448
    v_pk_mul_f32 v[78:79], v[62:63], v[30:31] op_sel:[0,0] op_sel_hi:[0,1] neg_hi:[0,0]
    v_pk_fma_f32 v[62:63], v[62:63], v[30:31], v[78:79] op_sel:[1,1,0] op_sel_hi:[1,0,1] neg_lo:[0,1,0]
    v_cvt_pk_bf16_f32 v84, v60, -v61
    ds_write_b32 v1, v84 offset:528
    v_pk_mul_f32 v[76:77], v[60:61], v[28:29] op_sel:[0,0] op_sel_hi:[0,1] neg_hi:[0,0]
    v_pk_fma_f32 v[60:61], v[60:61], v[28:29], v[76:77] op_sel:[1,1,0] op_sel_hi:[1,0,1] neg_lo:[0,1,0]
    v_cvt_pk_bf16_f32 v85, v62, -v63
    ds_write_b32 v1, v85 offset:8976
    v_pk_mul_f32 v[78:79], v[62:63], v[30:31] op_sel:[0,0] op_sel_hi:[0,1] neg_hi:[0,0]
    v_pk_fma_f32 v[62:63], v[62:63], v[30:31], v[78:79] op_sel:[1,1,0] op_sel_hi:[1,0,1] neg_lo:[0,1,0]
    v_cvt_pk_bf16_f32 v84, v60, -v61
    ds_write_b32 v1, v84 offset:1056
    v_pk_mul_f32 v[76:77], v[60:61], v[28:29] op_sel:[0,0] op_sel_hi:[0,1] neg_hi:[0,0]
    v_pk_fma_f32 v[60:61], v[60:61], v[28:29], v[76:77] op_sel:[1,1,0] op_sel_hi:[1,0,1] neg_lo:[0,1,0]
    v_cvt_pk_bf16_f32 v85, v62, -v63
    ds_write_b32 v1, v85 offset:9504
    v_pk_mul_f32 v[78:79], v[62:63], v[30:31] op_sel:[0,0] op_sel_hi:[0,1] neg_hi:[0,0]
    v_pk_fma_f32 v[62:63], v[62:63], v[30:31], v[78:79] op_sel:[1,1,0] op_sel_hi:[1,0,1] neg_lo:[0,1,0]
    v_cvt_pk_bf16_f32 v84, v60, -v61
    ds_write_b32 v1, v84 offset:1584
    v_pk_mul_f32 v[76:77], v[60:61], v[28:29] op_sel:[0,0] op_sel_hi:[0,1] neg_hi:[0,0]
    v_pk_fma_f32 v[60:61], v[60:61], v[28:29], v[76:77] op_sel:[1,1,0] op_sel_hi:[1,0,1] neg_lo:[0,1,0]
    v_cvt_pk_bf16_f32 v85, v62, -v63
    ds_write_b32 v1, v85 offset:10032
    v_pk_mul_f32 v[78:79], v[62:63], v[30:31] op_sel:[0,0] op_sel_hi:[0,1] neg_hi:[0,0]
    v_pk_fma_f32 v[62:63], v[62:63], v[30:31], v[78:79] op_sel:[1,1,0] op_sel_hi:[1,0,1] neg_lo:[0,1,0]
    v_cvt_pk_bf16_f32 v84, v60, -v61
    ds_write_b32 v1, v84 offset:2112
    v_pk_mul_f32 v[76:77], v[60:61], v[28:29] op_sel:[0,0] op_sel_hi:[0,1] neg_hi:[0,0]
    v_pk_fma_f32 v[60:61], v[60:61], v[28:29], v[76:77] op_sel:[1,1,0] op_sel_hi:[1,0,1] neg_lo:[0,1,0]
    v_cvt_pk_bf16_f32 v85, v62, -v63
    ds_write_b32 v1, v85 offset:10560
    v_pk_mul_f32 v[78:79], v[62:63], v[30:31] op_sel:[0,0] op_sel_hi:[0,1] neg_hi:[0,0]
    v_pk_fma_f32 v[62:63], v[62:63], v[30:31], v[78:79] op_sel:[1,1,0] op_sel_hi:[1,0,1] neg_lo:[0,1,0]
    v_cvt_pk_bf16_f32 v84, v60, -v61
    ds_write_b32 v1, v84 offset:2640
    v_pk_mul_f32 v[76:77], v[60:61], v[28:29] op_sel:[0,0] op_sel_hi:[0,1] neg_hi:[0,0]
    v_pk_fma_f32 v[60:61], v[60:61], v[28:29], v[76:77] op_sel:[1,1,0] op_sel_hi:[1,0,1] neg_lo:[0,1,0]
    v_cvt_pk_bf16_f32 v85, v62, -v63
    ds_write_b32 v1, v85 offset:11088
    v_pk_mul_f32 v[78:79], v[62:63], v[30:31] op_sel:[0,0] op_sel_hi:[0,1] neg_hi:[0,0]
    v_pk_fma_f32 v[62:63], v[62:63], v[30:31], v[78:79] op_sel:[1,1,0] op_sel_hi:[1,0,1] neg_lo:[0,1,0]
    v_cvt_pk_bf16_f32 v84, v60, -v61
    ds_write_b32 v1, v84 offset:3168
    v_pk_mul_f32 v[76:77], v[60:61], v[28:29] op_sel:[0,0] op_sel_hi:[0,1] neg_hi:[0,0]
    v_pk_fma_f32 v[60:61], v[60:61], v[28:29], v[76:77] op_sel:[1,1,0] op_sel_hi:[1,0,1] neg_lo:[0,1,0]
    v_cvt_pk_bf16_f32 v85, v62, -v63
    ds_write_b32 v1, v85 offset:11616
    v_pk_mul_f32 v[78:79], v[62:63], v[30:31] op_sel:[0,0] op_sel_hi:[0,1] neg_hi:[0,0]
    v_pk_fma_f32 v[62:63], v[62:63], v[30:31], v[78:79] op_sel:[1,1,0] op_sel_hi:[1,0,1] neg_lo:[0,1,0]
    v_cvt_pk_bf16_f32 v84, v60, -v61
    ds_write_b32 v1, v84 offset:3696
    v_cvt_pk_bf16_f32 v85, v62, -v63
    ds_write_b32 v1, v85 offset:12144
    v_pk_mul_f32 v[78:79], v[62:63], v[30:31] op_sel:[0,0] op_sel_hi:[0,1] neg_hi:[0,0]
    v_pk_fma_f32 v[62:63], v[62:63], v[30:31], v[78:79] op_sel:[1,1,0] op_sel_hi:[1,0,1] neg_lo:[0,1,0]
    v_cvt_pk_bf16_f32 v85, v62, -v63
    ds_write_b32 v1, v85 offset:12672
    s_waitcnt lgkmcnt(0)
    s_barrier
    s_barrier
k1_kernel_b2_expand:
    s_mov_b32 s8, 33792
    v_lshlrev_b32 v1, 3, v0
    v_sub_u32 v1, 2047, v1
    v_subrev_u32 v16, 0, v1
    v_cvt_f32_u32 v16, v16
    v_cvt_pk_bf16_f32 v16, v16, v16
    v_bfe_u32 v24, v16, 7, 8
    v_lshlrev_b32 v16, 16, v16
    v_max_u32 v24, 134, v24
    v_cvt_u32_f32 v16, v16
    v_subrev_u32 v24, 134, v24
    v_lshrrev_b32 v16, v24, v16
    v_lshl_add_u32 v16, v24, 7, v16
    v_lshl_add_u32 v16, v16, 2, s8
    ds_read_b32 v16, v16
    v_subrev_u32 v17, 1, v1
    v_cvt_f32_u32 v17, v17
    v_cvt_pk_bf16_f32 v17, v17, v17
    v_bfe_u32 v25, v17, 7, 8
    v_lshlrev_b32 v17, 16, v17
    v_max_u32 v25, 134, v25
    v_cvt_u32_f32 v17, v17
    v_subrev_u32 v25, 134, v25
    v_lshrrev_b32 v17, v25, v17
    v_lshl_add_u32 v17, v25, 7, v17
    v_lshl_add_u32 v17, v17, 2, s8
    ds_read_b32 v17, v17
    v_subrev_u32 v18, 2, v1
    v_cvt_f32_u32 v18, v18
    v_cvt_pk_bf16_f32 v18, v18, v18
    v_bfe_u32 v26, v18, 7, 8
    v_lshlrev_b32 v18, 16, v18
    v_max_u32 v26, 134, v26
    v_cvt_u32_f32 v18, v18
    v_subrev_u32 v26, 134, v26
    v_lshrrev_b32 v18, v26, v18
    v_lshl_add_u32 v18, v26, 7, v18
    v_lshl_add_u32 v18, v18, 2, s8
    ds_read_b32 v18, v18
    v_subrev_u32 v19, 3, v1
    v_cvt_f32_u32 v19, v19
    v_cvt_pk_bf16_f32 v19, v19, v19
    v_bfe_u32 v27, v19, 7, 8
    v_lshlrev_b32 v19, 16, v19
    v_max_u32 v27, 134, v27
    v_cvt_u32_f32 v19, v19
    v_subrev_u32 v27, 134, v27
    v_lshrrev_b32 v19, v27, v19
    v_lshl_add_u32 v19, v27, 7, v19
    v_lshl_add_u32 v19, v19, 2, s8
    ds_read_b32 v19, v19
    v_subrev_u32 v20, 4, v1
    v_cvt_f32_u32 v20, v20
    v_cvt_pk_bf16_f32 v20, v20, v20
    v_bfe_u32 v28, v20, 7, 8
    v_lshlrev_b32 v20, 16, v20
    v_max_u32 v28, 134, v28
    v_cvt_u32_f32 v20, v20
    v_subrev_u32 v28, 134, v28
    v_lshrrev_b32 v20, v28, v20
    v_lshl_add_u32 v20, v28, 7, v20
    v_lshl_add_u32 v20, v20, 2, s8
    ds_read_b32 v20, v20
    v_subrev_u32 v21, 5, v1
    v_cvt_f32_u32 v21, v21
    v_cvt_pk_bf16_f32 v21, v21, v21
    v_bfe_u32 v29, v21, 7, 8
    v_lshlrev_b32 v21, 16, v21
    v_max_u32 v29, 134, v29
    v_cvt_u32_f32 v21, v21
    v_subrev_u32 v29, 134, v29
    v_lshrrev_b32 v21, v29, v21
    v_lshl_add_u32 v21, v29, 7, v21
    v_lshl_add_u32 v21, v21, 2, s8
    ds_read_b32 v21, v21
    v_subrev_u32 v22, 6, v1
    v_cvt_f32_u32 v22, v22
    v_cvt_pk_bf16_f32 v22, v22, v22
    v_bfe_u32 v30, v22, 7, 8
    v_lshlrev_b32 v22, 16, v22
    v_max_u32 v30, 134, v30
    v_cvt_u32_f32 v22, v22
    v_subrev_u32 v30, 134, v30
    v_lshrrev_b32 v22, v30, v22
    v_lshl_add_u32 v22, v30, 7, v22
    v_lshl_add_u32 v22, v22, 2, s8
    ds_read_b32 v22, v22
    v_subrev_u32 v23, 7, v1
    v_cvt_f32_u32 v23, v23
    v_cvt_pk_bf16_f32 v23, v23, v23
    v_bfe_u32 v31, v23, 7, 8
    v_lshlrev_b32 v23, 16, v23
    v_max_u32 v31, 134, v31
    v_cvt_u32_f32 v23, v23
    v_subrev_u32 v31, 134, v31
    v_lshrrev_b32 v23, v31, v23
    v_lshl_add_u32 v23, v31, 7, v23
    v_lshl_add_u32 v23, v23, 2, s8
    ds_read_b32 v23, v23
    s_waitcnt lgkmcnt(0)
    v_cvt_pk_bf16_f32 v32, v16, v17
    v_cvt_pk_bf16_f32 v33, v18, v19
    v_cvt_pk_bf16_f32 v34, v20, v21
    v_cvt_pk_bf16_f32 v35, v22, v23
    v_lshlrev_b32 v1, 4, v0
    s_mul_i32 s6, s2, 4160
    buffer_store_dwordx4 v[32:35], v1, s[60:63], s6 offen
    v_cmp_gt_u32 vcc, 4, v0
    s_and_saveexec_b64 s[4:5], vcc
    s_cbranch_execz k1_kernel_b2_kend
    v_mov_b32 v40, 0
    v_mov_b32 v41, 0
    v_mov_b32 v42, 0
    v_mov_b32 v43, 0
    s_add_u32 s6, s6, 4096
    buffer_store_dwordx4 v[40:43], v1, s[60:63], s6 offen
k1_kernel_b2_kend:
    s_endpgm
k1_kernel_r3:
    s_sub_u32 s2, s2, 912
    s_cmp_ge_u32 s2, 512
    s_cbranch_scc1 k1_kernel_b3_end
    s_load_dwordx2 s[16:17], s[0:1], 0
    s_load_dwordx2 s[18:19], s[0:1], 112
    s_and_b32 s20, s2, 15
    s_lshr_b32 s21, s2, 4
    s_waitcnt lgkmcnt(0)
    s_mov_b32 s4, s16
    s_and_b32 s5, s17, 0xffff
    s_mov_b32 s6, 4194304
    s_mov_b32 s7, 0x00020000
    s_add_u32 s8, s18, 30408704
    s_addc_u32 s9, s19, 0
    s_and_b32 s9, s9, 0xffff
    s_mov_b32 s10, 4194304
    s_mov_b32 s11, 0x00020000
    v_lshrrev_b32 v1, 3, v0
    v_and_b32 v2, 7, v0
    v_lshlrev_b32 v3, 11, v1
    v_lshl_add_u32 v3, v2, 4, v3
    s_lshl_b32 s22, s21, 17
    s_lshl_b32 s23, s20, 7
    s_add_u32 s22, s22, s23
    s_add_u32 s23, s22, 65536
    buffer_load_dwordx4 v[8:11], v3, s[4:7], s22 offen
    buffer_load_dwordx4 v[12:15], v3, s[4:7], s23 offen
    v_mul_u32_u24 v4, 1056, v2
    v_lshl_add_u32 v4, v1, 1, v4
    s_waitcnt vmcnt(0)
    ds_write_b16 v4, v8 offset:0
    ds_write_b16_d16_hi v4, v8 offset:132
    ds_write_b16 v4, v9 offset:264
    ds_write_b16_d16_hi v4, v9 offset:396
    ds_write_b16 v4, v10 offset:528
    ds_write_b16_d16_hi v4, v10 offset:660
    ds_write_b16 v4, v11 offset:792
    ds_write_b16_d16_hi v4, v11 offset:924
    ds_write_b16 v4, v12 offset:64
    ds_write_b16_d16_hi v4, v12 offset:196
    ds_write_b16 v4, v13 offset:328
    ds_write_b16_d16_hi v4, v13 offset:460
    ds_write_b16 v4, v14 offset:592
    ds_write_b16_d16_hi v4, v14 offset:724
    ds_write_b16 v4, v15 offset:856
    ds_write_b16_d16_hi v4, v15 offset:988
    s_waitcnt lgkmcnt(0)
    s_barrier
    v_lshrrev_b32 v1, 2, v0
    v_and_b32 v2, 3, v0
    v_mul_u32_u24 v4, 132, v1
    v_lshl_add_u32 v4, v2, 5, v4
    ds_read_b128 v[8:11], v4
    ds_read_b128 v[12:15], v4 offset:16
    v_lshlrev_b32 v3, 12, v1
    v_lshl_add_u32 v3, v2, 5, v3
    s_lshl_b32 s22, s20, 18
    s_lshl_b32 s23, s21, 7
    s_add_u32 s22, s22, s23
    s_waitcnt lgkmcnt(0)
    buffer_store_dwordx4 v[8:11], v3, s[8:11], s22 offen
    buffer_store_dwordx4 v[12:15], v3, s[8:11], s22 offen offset:16
k1_kernel_b3_end:
    s_endpgm
.globl k2_kernel
.p2align 8
.type k2_kernel,@function
k2_kernel:

    s_cmp_lt_u32 s2, 257
    s_cbranch_scc1 k2_kernel_r0
    s_cmp_lt_u32 s2, 769
    s_cbranch_scc1 k2_kernel_r1
    s_endpgm
k2_kernel_r0:
    s_cmp_ge_u32 s2, 257
    s_cbranch_scc1 k2_kernel_b0_end
    s_load_dwordx2 s[18:19], s[0:1], 112
    s_mov_b32 s12, 0x3f3504f3
    s_mov_b32 s13, 0x3f3504f3
    s_mov_b32 s14, 0x3f6c835e
    s_mov_b32 s15, 0x3ec3ef15
    s_mov_b32 s28, 0x34800000
    s_mov_b32 s29, 0x34800000
    v_and_b32 v6, 127, v0
    v_lshrrev_b32 v7, 7, v0
    s_waitcnt lgkmcnt(0)
    s_mov_b32 s4, s18
    s_and_b32 s5, s19, 0xffff
    s_mov_b32 s6, 8404992
    s_mov_b32 s7, 0x00020000
    s_add_u32 s8, s18, 9437184
    s_addc_u32 s9, s19, 0
    s_and_b32 s9, s9, 0xffff
    s_mov_b32 s10, 8404992
    s_mov_b32 s11, 0x00020000
    s_add_u32 s20, s18, 18874368
    s_addc_u32 s21, s19, 0
    s_and_b32 s21, s21, 0xffff
    s_mov_b32 s22, 4202496
    s_mov_b32 s23, 0x00020000
    v_lshlrev_b32 v123, 14, v7
    v_lshl_add_u32 v123, v6, 3, v123
    s_lshl_b32 s24, s2, 15
    s_add_u32 s30, s24, 0
    s_add_u32 s31, s24, 4096
    s_add_u32 s32, s24, 8192
    s_add_u32 s33, s24, 12288
    buffer_load_dwordx2 v[8:9], v123, s[4:7], s30 offen offset:0
    buffer_load_dwordx2 v[10:11], v123, s[4:7], s30 offen offset:1024
    buffer_load_dwordx2 v[12:13], v123, s[4:7], s30 offen offset:2048
    buffer_load_dwordx2 v[14:15], v123, s[4:7], s30 offen offset:3072
    buffer_load_dwordx2 v[16:17], v123, s[4:7], s31 offen offset:0
    buffer_load_dwordx2 v[18:19], v123, s[4:7], s31 offen offset:1024
    buffer_load_dwordx2 v[20:21], v123, s[4:7], s31 offen offset:2048
    buffer_load_dwordx2 v[22:23], v123, s[4:7], s31 offen offset:3072
    buffer_load_dwordx2 v[24:25], v123, s[4:7], s32 offen offset:0
    buffer_load_dwordx2 v[26:27], v123, s[4:7], s32 offen offset:1024
    buffer_load_dwordx2 v[28:29], v123, s[4:7], s32 offen offset:2048
    buffer_load_dwordx2 v[30:31], v123, s[4:7], s32 offen offset:3072
    buffer_load_dwordx2 v[32:33], v123, s[4:7], s33 offen offset:0
    buffer_load_dwordx2 v[34:35], v123, s[4:7], s33 offen offset:1024
    buffer_load_dwordx2 v[36:37], v123, s[4:7], s33 offen offset:2048
    buffer_load_dwordx2 v[38:39], v123, s[4:7], s33 offen offset:3072
    v_lshlrev_b32 v127, 13, v7
    v_lshl_add_u32 v127, v6, 6, v127
    s_lshl_b32 s25, s2, 14
    buffer_load_dwordx4 v[104:107], v127, s[20:23], s25 offen offset:0
    buffer_load_dwordx4 v[108:111], v127, s[20:23], s25 offen offset:16
    buffer_load_dwordx4 v[112:115], v127, s[20:23], s25 offen offset:32
    buffer_load_dwordx4 v[116:119], v127, s[20:23], s25 offen offset:48
    v_cvt_f32_u32 v120, v6
    v_mul_f32 v121, 0xba000000, v120
    v_cos_f32 v44, v121
    v_sin_f32 v45, v121
    v_mul_f32 v121, 0xba800000, v120
    v_cos_f32 v46, v121
    v_sin_f32 v47, v121
    v_mul_f32 v121, 0xbac00000, v120
    v_cos_f32 v48, v121
    v_sin_f32 v49, v121
    v_mul_f32 v121, 0xbb000000, v120
    v_cos_f32 v50, v121
    v_sin_f32 v51, v121
    v_mul_f32 v121, 0xbb200000, v120
    v_cos_f32 v52, v121
    v_sin_f32 v53, v121
    v_mul_f32 v121, 0xbb400000, v120
    v_cos_f32 v54, v121
    v_sin_f32 v55, v121
    v_mul_f32 v121, 0xbb600000, v120
    v_cos_f32 v56, v121
    v_sin_f32 v57, v121
    v_mul_f32 v121, 0xbb800000, v120
    v_cos_f32 v58, v121
    v_sin_f32 v59, v121
    v_mul_f32 v121, 0xbb900000, v120
    v_cos_f32 v60, v121
    v_sin_f32 v61, v121
    v_mul_f32 v121, 0xbba00000, v120
    v_cos_f32 v62, v121
    v_sin_f32 v63, v121
    v_mul_f32 v121, 0xbbb00000, v120
    v_cos_f32 v64, v121
    v_sin_f32 v65, v121
    v_mul_f32 v121, 0xbbc00000, v120
    v_cos_f32 v66, v121
    v_sin_f32 v67, v121
    v_mul_f32 v121, 0xbbd00000, v120
    v_cos_f32 v68, v121
    v_sin_f32 v69, v121
    v_mul_f32 v121, 0xbbe00000, v120
    v_cos_f32 v70, v121
    v_sin_f32 v71, v121
    v_mul_f32 v121, 0xbbf00000, v120
    v_cos_f32 v72, v121
    v_sin_f32 v73, v121
    v_and_b32 v122, 7, v6
    v_cvt_f32_u32 v120, v122
    v_mul_f32 v121, 0xbc000000, v120
    v_cos_f32 v74, v121
    v_sin_f32 v75, v121
    v_mul_f32 v121, 0xbc800000, v120
    v_cos_f32 v76, v121
    v_sin_f32 v77, v121
    v_mul_f32 v121, 0xbcc00000, v120
    v_cos_f32 v78, v121
    v_sin_f32 v79, v121
    v_mul_f32 v121, 0xbd000000, v120
    v_cos_f32 v80, v121
    v_sin_f32 v81, v121
    v_mul_f32 v121, 0xbd200000, v120
    v_cos_f32 v82, v121
    v_sin_f32 v83, v121
    v_mul_f32 v121, 0xbd400000, v120
    v_cos_f32 v84, v121
    v_sin_f32 v85, v121
    v_mul_f32 v121, 0xbd600000, v120
    v_cos_f32 v86, v121
    v_sin_f32 v87, v121
    v_mul_f32 v121, 0xbd800000, v120
    v_cos_f32 v88, v121
    v_sin_f32 v89, v121
    v_mul_f32 v121, 0xbd900000, v120
    v_cos_f32 v90, v121
    v_sin_f32 v91, v121
    v_mul_f32 v121, 0xbda00000, v120
    v_cos_f32 v92, v121
    v_sin_f32 v93, v121
    v_mul_f32 v121, 0xbdb00000, v120
    v_cos_f32 v94, v121
    v_sin_f32 v95, v121
    v_mul_f32 v121, 0xbdc00000, v120
    v_cos_f32 v96, v121
    v_sin_f32 v97, v121
    v_mul_f32 v121, 0xbdd00000, v120
    v_cos_f32 v98, v121
    v_sin_f32 v99, v121
    v_mul_f32 v121, 0xbde00000, v120
    v_cos_f32 v100, v121
    v_sin_f32 v101, v121
    v_mul_f32 v121, 0xbdf00000, v120
    v_cos_f32 v102, v121
    v_sin_f32 v103, v121
    v_mul_u32_u24 v7, 19456, v7
    v_lshl_add_u32 v124, v6, 3, v7
    v_lshrrev_b32 v120, 3, v6
    v_mul_u32_u24 v120, 1216, v120
    v_add_u32 v120, v120, v7
    v_lshl_add_u32 v125, v122, 3, v120
    v_mul_u32_u24 v126, 72, v122
    v_add_u32 v126, v126, v120
    s_waitcnt vmcnt(4)
    v_pk_add_f32 v[40:41], v[8:9], v[24:25]
    v_pk_add_f32 v[24:25], v[8:9], v[24:25] neg_lo:[0,1] neg_hi:[0,1]
    v_pk_add_f32 v[8:9], v[10:11], v[26:27]
    v_pk_add_f32 v[26:27], v[10:11], v[26:27] neg_lo:[0,1] neg_hi:[0,1]
    v_pk_mul_f32 v[42:43], v[26:27], s[14:15] op_sel:[0,0] op_sel_hi:[0,1] neg_lo:[0,0] neg_hi:[0,1]
    v_pk_fma_f32 v[26:27], v[26:27], s[14:15], v[42:43] op_sel:[1,1,0] op_sel_hi:[1,0,1] neg_lo:[0,0,0] neg_hi:[0,0,0]
    v_pk_add_f32 v[10:11], v[12:13], v[28:29]
    v_pk_add_f32 v[28:29], v[12:13], v[28:29] neg_lo:[0,1] neg_hi:[0,1]
    v_pk_mul_f32 v[42:43], v[28:29], s[12:13] op_sel:[0,0] op_sel_hi:[0,1] neg_lo:[0,0] neg_hi:[0,1]
    v_pk_fma_f32 v[28:29], v[28:29], s[12:13], v[42:43] op_sel:[1,1,0] op_sel_hi:[1,0,1] neg_lo:[0,0,0] neg_hi:[0,0,0]
    v_pk_add_f32 v[12:13], v[14:15], v[30:31]
    v_pk_add_f32 v[30:31], v[14:15], v[30:31] neg_lo:[0,1] neg_hi:[0,1]
    v_pk_mul_f32 v[42:43], v[30:31], s[14:15] op_sel:[0,1] op_sel_hi:[0,0] neg_lo:[0,0] neg_hi:[0,1]
    v_pk_fma_f32 v[30:31], v[30:31], s[14:15], v[42:43] op_sel:[1,0,0] op_sel_hi:[1,1,1] neg_lo:[0,0,0] neg_hi:[0,0,0]
    v_pk_add_f32 v[14:15], v[16:17], v[32:33]
    v_pk_add_f32 v[32:33], v[16:17], v[32:33] op_sel:[1,1] op_sel_hi:[0,0] neg_lo:[0,1] neg_hi:[1,0]
    v_pk_add_f32 v[16:17], v[18:19], v[34:35]
    v_pk_add_f32 v[34:35], v[18:19], v[34:35] neg_lo:[0,1] neg_hi:[0,1]
    v_pk_mul_f32 v[42:43], v[34:35], s[14:15] op_sel:[0,1] op_sel_hi:[0,0] neg_lo:[0,1] neg_hi:[0,1]
    v_pk_fma_f32 v[34:35], v[34:35], s[14:15], v[42:43] op_sel:[1,0,0] op_sel_hi:[1,1,1] neg_lo:[0,0,0] neg_hi:[0,1,0]
    v_pk_add_f32 v[18:19], v[20:21], v[36:37]
    v_pk_add_f32 v[36:37], v[20:21], v[36:37] neg_lo:[0,1] neg_hi:[0,1]
    v_pk_mul_f32 v[42:43], v[36:37], s[12:13] op_sel:[0,0] op_sel_hi:[0,1] neg_lo:[0,1] neg_hi:[0,1]
    v_pk_fma_f32 v[36:37], v[36:37], s[12:13], v[42:43] op_sel:[1,1,0] op_sel_hi:[1,0,1] neg_lo:[0,0,0] neg_hi:[0,1,0]
    v_pk_add_f32 v[20:21], v[22:23], v[38:39]
    v_pk_add_f32 v[38:39], v[22:23], v[38:39] neg_lo:[0,1] neg_hi:[0,1]
    v_pk_mul_f32 v[42:43], v[38:39], s[14:15] op_sel:[0,0] op_sel_hi:[0,1] neg_lo:[0,1] neg_hi:[0,1]
    v_pk_fma_f32 v[38:39], v[38:39], s[14:15], v[42:43] op_sel:[1,1,0] op_sel_hi:[1,0,1] neg_lo:[0,0,0] neg_hi:[0,1,0]
    v_pk_add_f32 v[22:23], v[40:41], v[14:15]
    v_pk_add_f32 v[14:15], v[40:41], v[14:15] neg_lo:[0,1] neg_hi:[0,1]
    v_pk_add_f32 v[40:41], v[8:9], v[16:17]
    v_pk_add_f32 v[16:17], v[8:9], v[16:17] neg_lo:[0,1] neg_hi:[0,1]
    v_pk_mul_f32 v[42:43], v[16:17], s[12:13] op_sel:[0,0] op_sel_hi:[0,1] neg_lo:[0,0] neg_hi:[0,1]
    v_pk_fma_f32 v[16:17], v[16:17], s[12:13], v[42:43] op_sel:[1,1,0] op_sel_hi:[1,0,1] neg_lo:[0,0,0] neg_hi:[0,0,0]
    v_pk_add_f32 v[8:9], v[10:11], v[18:19]
    v_pk_add_f32 v[18:19], v[10:11], v[18:19] op_sel:[1,1] op_sel_hi:[0,0] neg_lo:[0,1] neg_hi:[1,0]
    v_pk_add_f32 v[10:11], v[12:13], v[20:21]
    v_pk_add_f32 v[20:21], v[12:13], v[20:21] neg_lo:[0,1] neg_hi:[0,1]
    v_pk_mul_f32 v[42:43], v[20:21], s[12:13] op_sel:[0,0] op_sel_hi:[0,1] neg_lo:[0,1] neg_hi:[0,1]
    v_pk_fma_f32 v[20:21], v[20:21], s[12:13], v[42:43] op_sel:[1,1,0] op_sel_hi:[1,0,1] neg_lo:[0,0,0] neg_hi:[0,1,0]
    v_pk_add_f32 v[12:13], v[22:23], v[8:9]
    v_pk_add_f32 v[8:9], v[22:23], v[8:9] neg_lo:[0,1] neg_hi:[0,1]
    v_pk_add_f32 v[22:23], v[40:41], v[10:11]
    v_pk_add_f32 v[10:11], v[40:41], v[10:11] op_sel:[1,1] op_sel_hi:[0,0] neg_lo:[0,1] neg_hi:[1,0]
    v_pk_add_f32 v[40:41], v[12:13], v[22:23]
    v_pk_add_f32 v[22:23], v[12:13], v[22:23] neg_lo:[0,1] neg_hi:[0,1]
    v_pk_add_f32 v[12:13], v[8:9], v[10:11]
    v_pk_add_f32 v[10:11], v[8:9], v[10:11] neg_lo:[0,1] neg_hi:[0,1]
    v_pk_add_f32 v[8:9], v[14:15], v[18:19]
    v_pk_add_f32 v[18:19], v[14:15], v[18:19] neg_lo:[0,1] neg_hi:[0,1]
    v_pk_add_f32 v[14:15], v[16:17], v[20:21]
    v_pk_add_f32 v[20:21], v[16:17], v[20:21] op_sel:[1,1] op_sel_hi:[0,0] neg_lo:[0,1] neg_hi:[1,0]
    v_pk_add_f32 v[16:17], v[8:9], v[14:15]
    v_pk_add_f32 v[14:15], v[8:9], v[14:15] neg_lo:[0,1] neg_hi:[0,1]
    v_pk_add_f32 v[8:9], v[18:19], v[20:21]
    v_pk_add_f32 v[20:21], v[18:19], v[20:21] neg_lo:[0,1] neg_hi:[0,1]
    v_pk_add_f32 v[18:19], v[24:25], v[32:33]
    v_pk_add_f32 v[32:33], v[24:25], v[32:33] neg_lo:[0,1] neg_hi:[0,1]
    v_pk_add_f32 v[24:25], v[26:27], v[34:35]
    v_pk_add_f32 v[34:35], v[26:27], v[34:35] neg_lo:[0,1] neg_hi:[0,1]
    v_pk_mul_f32 v[42:43], v[34:35], s[12:13] op_sel:[0,0] op_sel_hi:[0,1] neg_lo:[0,0] neg_hi:[0,1]
    v_pk_fma_f32 v[34:35], v[34:35], s[12:13], v[42:43] op_sel:[1,1,0] op_sel_hi:[1,0,1] neg_lo:[0,0,0] neg_hi:[0,0,0]
    v_pk_add_f32 v[26:27], v[28:29], v[36:37]
    v_pk_add_f32 v[36:37], v[28:29], v[36:37] op_sel:[1,1] op_sel_hi:[0,0] neg_lo:[0,1] neg_hi:[1,0]
    v_pk_add_f32 v[28:29], v[30:31], v[38:39]
    v_pk_add_f32 v[38:39], v[30:31], v[38:39] neg_lo:[0,1] neg_hi:[0,1]
    v_pk_mul_f32 v[42:43], v[38:39], s[12:13] op_sel:[0,0] op_sel_hi:[0,1] neg_lo:[0,1] neg_hi:[0,1]
    v_pk_fma_f32 v[38:39], v[38:39], s[12:13], v[42:43] op_sel:[1,1,0] op_sel_hi:[1,0,1] neg_lo:[0,0,0] neg_hi:[0,1,0]
    v_pk_add_f32 v[30:31], v[18:19], v[26:27]
    v_pk_add_f32 v[26:27], v[18:19], v[26:27] neg_lo:[0,1] neg_hi:[0,1]
    v_pk_add_f32 v[18:19], v[24:25], v[28:29]
    v_pk_add_f32 v[28:29], v[24:25], v[28:29] op_sel:[1,1] op_sel_hi:[0,0] neg_lo:[0,1] neg_hi:[1,0]
    v_pk_add_f32 v[24:25], v[30:31], v[18:19]
    v_pk_add_f32 v[18:19], v[30:31], v[18:19] neg_lo:[0,1] neg_hi:[0,1]
    v_pk_add_f32 v[30:31], v[26:27], v[28:29]
    v_pk_add_f32 v[28:29], v[26:27], v[28:29] neg_lo:[0,1] neg_hi:[0,1]
    v_pk_add_f32 v[26:27], v[32:33], v[36:37]
    v_pk_add_f32 v[36:37], v[32:33], v[36:37] neg_lo:[0,1] neg_hi:[0,1]
    v_pk_add_f32 v[32:33], v[34:35], v[38:39]
    v_pk_add_f32 v[38:39], v[34:35], v[38:39] op_sel:[1,1] op_sel_hi:[0,0] neg_lo:[0,1] neg_hi:[1,0]
    v_pk_add_f32 v[34:35], v[26:27], v[32:33]
    v_pk_add_f32 v[32:33], v[26:27], v[32:33] neg_lo:[0,1] neg_hi:[0,1]
    v_pk_add_f32 v[26:27], v[36:37], v[38:39]
    v_pk_add_f32 v[38:39], v[36:37], v[38:39] neg_lo:[0,1] neg_hi:[0,1]
    v_pk_mul_f32 v[42:43], v[24:25], v[44:45] op_sel:[0,0] op_sel_hi:[0,1] neg_hi:[0,0]
    v_pk_fma_f32 v[24:25], v[24:25], v[44:45], v[42:43] op_sel:[1,1,0] op_sel_hi:[1,0,1] neg_lo:[0,1,0]
    v_pk_mul_f32 v[42:43], v[16:17], v[46:47] op_sel:[0,0] op_sel_hi:[0,1] neg_hi:[0,0]
    v_pk_fma_f32 v[16:17], v[16:17], v[46:47], v[42:43] op_sel:[1,1,0] op_sel_hi:[1,0,1] neg_lo:[0,1,0]
    v_pk_mul_f32 v[42:43], v[34:35], v[48:49] op_sel:[0,0] op_sel_hi:[0,1] neg_hi:[0,0]
    v_pk_fma_f32 v[34:35], v[34:35], v[48:49], v[42:43] op_sel:[1,1,0] op_sel_hi:[1,0,1] neg_lo:[0,1,0]
    v_pk_mul_f32 v[42:43], v[12:13], v[50:51] op_sel:[0,0] op_sel_hi:[0,1] neg_hi:[0,0]
    v_pk_fma_f32 v[12:13], v[12:13], v[50:51], v[42:43] op_sel:[1,1,0] op_sel_hi:[1,0,1] neg_lo:[0,1,0]
    v_pk_mul_f32 v[42:43], v[30:31], v[52:53] op_sel:[0,0] op_sel_hi:[0,1] neg_hi:[0,0]
    v_pk_fma_f32 v[30:31], v[30:31], v[52:53], v[42:43] op_sel:[1,1,0] op_sel_hi:[1,0,1] neg_lo:[0,1,0]
    v_pk_mul_f32 v[42:43], v[8:9], v[54:55] op_sel:[0,0] op_sel_hi:[0,1] neg_hi:[0,0]
    v_pk_fma_f32 v[8:9], v[8:9], v[54:55], v[42:43] op_sel:[1,1,0] op_sel_hi:[1,0,1] neg_lo:[0,1,0]
    v_pk_mul_f32 v[42:43], v[26:27], v[56:57] op_sel:[0,0] op_sel_hi:[0,1] neg_hi:[0,0]
    v_pk_fma_f32 v[26:27], v[26:27], v[56:57], v[42:43] op_sel:[1,1,0] op_sel_hi:[1,0,1] neg_lo:[0,1,0]
    v_pk_mul_f32 v[42:43], v[22:23], v[58:59] op_sel:[0,0] op_sel_hi:[0,1] neg_hi:[0,0]
    v_pk_fma_f32 v[22:23], v[22:23], v[58:59], v[42:43] op_sel:[1,1,0] op_sel_hi:[1,0,1] neg_lo:[0,1,0]
    v_pk_mul_f32 v[42:43], v[18:19], v[60:61] op_sel:[0,0] op_sel_hi:[0,1] neg_hi:[0,0]
    v_pk_fma_f32 v[18:19], v[18:19], v[60:61], v[42:43] op_sel:[1,1,0] op_sel_hi:[1,0,1] neg_lo:[0,1,0]
    v_pk_mul_f32 v[42:43], v[14:15], v[62:63] op_sel:[0,0] op_sel_hi:[0,1] neg_hi:[0,0]
    v_pk_fma_f32 v[14:15], v[14:15], v[62:63], v[42:43] op_sel:[1,1,0] op_sel_hi:[1,0,1] neg_lo:[0,1,0]
    v_pk_mul_f32 v[42:43], v[32:33], v[64:65] op_sel:[0,0] op_sel_hi:[0,1] neg_hi:[0,0]
    v_pk_fma_f32 v[32:33], v[32:33], v[64:65], v[42:43] op_sel:[1,1,0] op_sel_hi:[1,0,1] neg_lo:[0,1,0]
    v_pk_mul_f32 v[42:43], v[10:11], v[66:67] op_sel:[0,0] op_sel_hi:[0,1] neg_hi:[0,0]
    v_pk_fma_f32 v[10:11], v[10:11], v[66:67], v[42:43] op_sel:[1,1,0] op_sel_hi:[1,0,1] neg_lo:[0,1,0]
    v_pk_mul_f32 v[42:43], v[28:29], v[68:69] op_sel:[0,0] op_sel_hi:[0,1] neg_hi:[0,0]
    v_pk_fma_f32 v[28:29], v[28:29], v[68:69], v[42:43] op_sel:[1,1,0] op_sel_hi:[1,0,1] neg_lo:[0,1,0]
    v_pk_mul_f32 v[42:43], v[20:21], v[70:71] op_sel:[0,0] op_sel_hi:[0,1] neg_hi:[0,0]
    v_pk_fma_f32 v[20:21], v[20:21], v[70:71], v[42:43] op_sel:[1,1,0] op_sel_hi:[1,0,1] neg_lo:[0,1,0]
    v_pk_mul_f32 v[42:43], v[38:39], v[72:73] op_sel:[0,0] op_sel_hi:[0,1] neg_hi:[0,0]
    v_pk_fma_f32 v[38:39], v[38:39], v[72:73], v[42:43] op_sel:[1,1,0] op_sel_hi:[1,0,1] neg_lo:[0,1,0]
    ds_write_b64 v124, v[40:41] offset:0
    ds_write_b64 v124, v[24:25] offset:1216
    ds_write_b64 v124, v[16:17] offset:2432
    ds_write_b64 v124, v[34:35] offset:3648
    ds_write_b64 v124, v[12:13] offset:4864
    ds_write_b64 v124, v[30:31] offset:6080
    ds_write_b64 v124, v[8:9] offset:7296
    ds_write_b64 v124, v[26:27] offset:8512
    ds_write_b64 v124, v[22:23] offset:9728
    ds_write_b64 v124, v[18:19] offset:10944
    ds_write_b64 v124, v[14:15] offset:12160
    ds_write_b64 v124, v[32:33] offset:13376
    ds_write_b64 v124, v[10:11] offset:14592
    ds_write_b64 v124, v[28:29] offset:15808
    ds_write_b64 v124, v[20:21] offset:17024
    ds_write_b64 v124, v[38:39] offset:18240
    s_waitcnt lgkmcnt(0)
    s_barrier
    ds_read_b64 v[40:41], v125 offset:0
    ds_read_b64 v[24:25], v125 offset:64
    ds_read_b64 v[16:17], v125 offset:128
    ds_read_b64 v[34:35], v125 offset:192
    ds_read_b64 v[12:13], v125 offset:256
    ds_read_b64 v[30:31], v125 offset:320
    ds_read_b64 v[8:9], v125 offset:384
    ds_read_b64 v[26:27], v125 offset:448
    ds_read_b64 v[22:23], v125 offset:512
    ds_read_b64 v[18:19], v125 offset:576
    ds_read_b64 v[14:15], v125 offset:640
    ds_read_b64 v[32:33], v125 offset:704
    ds_read_b64 v[10:11], v125 offset:768
    ds_read_b64 v[28:29], v125 offset:832
    ds_read_b64 v[20:21], v125 offset:896
    ds_read_b64 v[38:39], v125 offset:960
    s_waitcnt lgkmcnt(0)
    v_pk_add_f32 v[36:37], v[40:41], v[22:23]
    v_pk_add_f32 v[22:23], v[40:41], v[22:23] neg_lo:[0,1] neg_hi:[0,1]
    v_pk_add_f32 v[40:41], v[24:25], v[18:19]
    v_pk_add_f32 v[18:19], v[24:25], v[18:19] neg_lo:[0,1] neg_hi:[0,1]
    v_pk_mul_f32 v[42:43], v[18:19], s[14:15] op_sel:[0,0] op_sel_hi:[0,1] neg_lo:[0,0] neg_hi:[0,1]
    v_pk_fma_f32 v[18:19], v[18:19], s[14:15], v[42:43] op_sel:[1,1,0] op_sel_hi:[1,0,1] neg_lo:[0,0,0] neg_hi:[0,0,0]
    v_pk_add_f32 v[24:25], v[16:17], v[14:15]
    v_pk_add_f32 v[14:15], v[16:17], v[14:15] neg_lo:[0,1] neg_hi:[0,1]
    v_pk_mul_f32 v[42:43], v[14:15], s[12:13] op_sel:[0,0] op_sel_hi:[0,1] neg_lo:[0,0] neg_hi:[0,1]
    v_pk_fma_f32 v[14:15], v[14:15], s[12:13], v[42:43] op_sel:[1,1,0] op_sel_hi:[1,0,1] neg_lo:[0,0,0] neg_hi:[0,0,0]
    v_pk_add_f32 v[16:17], v[34:35], v[32:33]
    v_pk_add_f32 v[32:33], v[34:35], v[32:33] neg_lo:[0,1] neg_hi:[0,1]
    v_pk_mul_f32 v[42:43], v[32:33], s[14:15] op_sel:[0,1] op_sel_hi:[0,0] neg_lo:[0,0] neg_hi:[0,1]
    v_pk_fma_f32 v[32:33], v[32:33], s[14:15], v[42:43] op_sel:[1,0,0] op_sel_hi:[1,1,1] neg_lo:[0,0,0] neg_hi:[0,0,0]
    v_pk_add_f32 v[34:35], v[12:13], v[10:11]
    v_pk_add_f32 v[10:11], v[12:13], v[10:11] op_sel:[1,1] op_sel_hi:[0,0] neg_lo:[0,1] neg_hi:[1,0]
    v_pk_add_f32 v[12:13], v[30:31], v[28:29]
    v_pk_add_f32 v[28:29], v[30:31], v[28:29] neg_lo:[0,1] neg_hi:[0,1]
    v_pk_mul_f32 v[42:43], v[28:29], s[14:15] op_sel:[0,1] op_sel_hi:[0,0] neg_lo:[0,1] neg_hi:[0,1]
    v_pk_fma_f32 v[28:29], v[28:29], s[14:15], v[42:43] op_sel:[1,0,0] op_sel_hi:[1,1,1] neg_lo:[0,0,0] neg_hi:[0,1,0]
    v_pk_add_f32 v[30:31], v[8:9], v[20:21]
    v_pk_add_f32 v[20:21], v[8:9], v[20:21] neg_lo:[0,1] neg_hi:[0,1]
    v_pk_mul_f32 v[42:43], v[20:21], s[12:13] op_sel:[0,0] op_sel_hi:[0,1] neg_lo:[0,1] neg_hi:[0,1]
    v_pk_fma_f32 v[20:21], v[20:21], s[12:13], v[42:43] op_sel:[1,1,0] op_sel_hi:[1,0,1] neg_lo:[0,0,0] neg_hi:[0,1,0]
    v_pk_add_f32 v[8:9], v[26:27], v[38:39]
    v_pk_add_f32 v[38:39], v[26:27], v[38:39] neg_lo:[0,1] neg_hi:[0,1]
    v_pk_mul_f32 v[42:43], v[38:39], s[14:15] op_sel:[0,0] op_sel_hi:[0,1] neg_lo:[0,1] neg_hi:[0,1]
    v_pk_fma_f32 v[38:39], v[38:39], s[14:15], v[42:43] op_sel:[1,1,0] op_sel_hi:[1,0,1] neg_lo:[0,0,0] neg_hi:[0,1,0]
    v_pk_add_f32 v[26:27], v[36:37], v[34:35]
    v_pk_add_f32 v[34:35], v[36:37], v[34:35] neg_lo:[0,1] neg_hi:[0,1]
    v_pk_add_f32 v[36:37], v[40:41], v[12:13]
    v_pk_add_f32 v[12:13], v[40:41], v[12:13] neg_lo:[0,1] neg_hi:[0,1]
    v_pk_mul_f32 v[42:43], v[12:13], s[12:13] op_sel:[0,0] op_sel_hi:[0,1] neg_lo:[0,0] neg_hi:[0,1]
    v_pk_fma_f32 v[12:13], v[12:13], s[12:13], v[42:43] op_sel:[1,1,0] op_sel_hi:[1,0,1] neg_lo:[0,0,0] neg_hi:[0,0,0]
    v_pk_add_f32 v[40:41], v[24:25], v[30:31]
    v_pk_add_f32 v[30:31], v[24:25], v[30:31] op_sel:[1,1] op_sel_hi:[0,0] neg_lo:[0,1] neg_hi:[1,0]
    v_pk_add_f32 v[24:25], v[16:17], v[8:9]
    v_pk_add_f32 v[8:9], v[16:17], v[8:9] neg_lo:[0,1] neg_hi:[0,1]
    v_pk_mul_f32 v[42:43], v[8:9], s[12:13] op_sel:[0,0] op_sel_hi:[0,1] neg_lo:[0,1] neg_hi:[0,1]
    v_pk_fma_f32 v[8:9], v[8:9], s[12:13], v[42:43] op_sel:[1,1,0] op_sel_hi:[1,0,1] neg_lo:[0,0,0] neg_hi:[0,1,0]
    v_pk_add_f32 v[16:17], v[26:27], v[40:41]
    v_pk_add_f32 v[40:41], v[26:27], v[40:41] neg_lo:[0,1] neg_hi:[0,1]
    v_pk_add_f32 v[26:27], v[36:37], v[24:25]
    v_pk_add_f32 v[24:25], v[36:37], v[24:25] op_sel:[1,1] op_sel_hi:[0,0] neg_lo:[0,1] neg_hi:[1,0]
    v_pk_add_f32 v[36:37], v[16:17], v[26:27]
    v_pk_add_f32 v[26:27], v[16:17], v[26:27] neg_lo:[0,1] neg_hi:[0,1]
    v_pk_add_f32 v[16:17], v[40:41], v[24:25]
    v_pk_add_f32 v[24:25], v[40:41], v[24:25] neg_lo:[0,1] neg_hi:[0,1]
    v_pk_add_f32 v[40:41], v[34:35], v[30:31]
    v_pk_add_f32 v[30:31], v[34:35], v[30:31] neg_lo:[0,1] neg_hi:[0,1]
    v_pk_add_f32 v[34:35], v[12:13], v[8:9]
    v_pk_add_f32 v[8:9], v[12:13], v[8:9] op_sel:[1,1] op_sel_hi:[0,0] neg_lo:[0,1] neg_hi:[1,0]
    v_pk_add_f32 v[12:13], v[40:41], v[34:35]
    v_pk_add_f32 v[34:35], v[40:41], v[34:35] neg_lo:[0,1] neg_hi:[0,1]
    v_pk_add_f32 v[40:41], v[30:31], v[8:9]
    v_pk_add_f32 v[8:9], v[30:31], v[8:9] neg_lo:[0,1] neg_hi:[0,1]
    v_pk_add_f32 v[30:31], v[22:23], v[10:11]
    v_pk_add_f32 v[10:11], v[22:23], v[10:11] neg_lo:[0,1] neg_hi:[0,1]
    v_pk_add_f32 v[22:23], v[18:19], v[28:29]
    v_pk_add_f32 v[28:29], v[18:19], v[28:29] neg_lo:[0,1] neg_hi:[0,1]
    v_pk_mul_f32 v[42:43], v[28:29], s[12:13] op_sel:[0,0] op_sel_hi:[0,1] neg_lo:[0,0] neg_hi:[0,1]
    v_pk_fma_f32 v[28:29], v[28:29], s[12:13], v[42:43] op_sel:[1,1,0] op_sel_hi:[1,0,1] neg_lo:[0,0,0] neg_hi:[0,0,0]
    v_pk_add_f32 v[18:19], v[14:15], v[20:21]
    v_pk_add_f32 v[20:21], v[14:15], v[20:21] op_sel:[1,1] op_sel_hi:[0,0] neg_lo:[0,1] neg_hi:[1,0]
    v_pk_add_f32 v[14:15], v[32:33], v[38:39]
    v_pk_add_f32 v[38:39], v[32:33], v[38:39] neg_lo:[0,1] neg_hi:[0,1]
    v_pk_mul_f32 v[42:43], v[38:39], s[12:13] op_sel:[0,0] op_sel_hi:[0,1] neg_lo:[0,1] neg_hi:[0,1]
    v_pk_fma_f32 v[38:39], v[38:39], s[12:13], v[42:43] op_sel:[1,1,0] op_sel_hi:[1,0,1] neg_lo:[0,0,0] neg_hi:[0,1,0]
    v_pk_add_f32 v[32:33], v[30:31], v[18:19]
    v_pk_add_f32 v[18:19], v[30:31], v[18:19] neg_lo:[0,1] neg_hi:[0,1]
    v_pk_add_f32 v[30:31], v[22:23], v[14:15]
    v_pk_add_f32 v[14:15], v[22:23], v[14:15] op_sel:[1,1] op_sel_hi:[0,0] neg_lo:[0,1] neg_hi:[1,0]
    v_pk_add_f32 v[22:23], v[32:33], v[30:31]
    v_pk_add_f32 v[30:31], v[32:33], v[30:31] neg_lo:[0,1] neg_hi:[0,1]
    v_pk_add_f32 v[32:33], v[18:19], v[14:15]
    v_pk_add_f32 v[14:15], v[18:19], v[14:15] neg_lo:[0,1] neg_hi:[0,1]
    v_pk_add_f32 v[18:19], v[10:11], v[20:21]
    v_pk_add_f32 v[20:21], v[10:11], v[20:21] neg_lo:[0,1] neg_hi:[0,1]
    v_pk_add_f32 v[10:11], v[28:29], v[38:39]
    v_pk_add_f32 v[38:39], v[28:29], v[38:39] op_sel:[1,1] op_sel_hi:[0,0] neg_lo:[0,1] neg_hi:[1,0]
    v_pk_add_f32 v[28:29], v[18:19], v[10:11]
    v_pk_add_f32 v[10:11], v[18:19], v[10:11] neg_lo:[0,1] neg_hi:[0,1]
    v_pk_add_f32 v[18:19], v[20:21], v[38:39]
    v_pk_add_f32 v[38:39], v[20:21], v[38:39] neg_lo:[0,1] neg_hi:[0,1]
    v_pk_mul_f32 v[42:43], v[22:23], v[74:75] op_sel:[0,0] op_sel_hi:[0,1] neg_hi:[0,0]
    v_pk_fma_f32 v[22:23], v[22:23], v[74:75], v[42:43] op_sel:[1,1,0] op_sel_hi:[1,0,1] neg_lo:[0,1,0]
    v_pk_mul_f32 v[42:43], v[12:13], v[76:77] op_sel:[0,0] op_sel_hi:[0,1] neg_hi:[0,0]
    v_pk_fma_f32 v[12:13], v[12:13], v[76:77], v[42:43] op_sel:[1,1,0] op_sel_hi:[1,0,1] neg_lo:[0,1,0]
    v_pk_mul_f32 v[42:43], v[28:29], v[78:79] op_sel:[0,0] op_sel_hi:[0,1] neg_hi:[0,0]
    v_pk_fma_f32 v[28:29], v[28:29], v[78:79], v[42:43] op_sel:[1,1,0] op_sel_hi:[1,0,1] neg_lo:[0,1,0]
    v_pk_mul_f32 v[42:43], v[16:17], v[80:81] op_sel:[0,0] op_sel_hi:[0,1] neg_hi:[0,0]
    v_pk_fma_f32 v[16:17], v[16:17], v[80:81], v[42:43] op_sel:[1,1,0] op_sel_hi:[1,0,1] neg_lo:[0,1,0]
    v_pk_mul_f32 v[42:43], v[32:33], v[82:83] op_sel:[0,0] op_sel_hi:[0,1] neg_hi:[0,0]
    v_pk_fma_f32 v[32:33], v[32:33], v[82:83], v[42:43] op_sel:[1,1,0] op_sel_hi:[1,0,1] neg_lo:[0,1,0]
    v_pk_mul_f32 v[42:43], v[40:41], v[84:85] op_sel:[0,0] op_sel_hi:[0,1] neg_hi:[0,0]
    v_pk_fma_f32 v[40:41], v[40:41], v[84:85], v[42:43] op_sel:[1,1,0] op_sel_hi:[1,0,1] neg_lo:[0,1,0]
    v_pk_mul_f32 v[42:43], v[18:19], v[86:87] op_sel:[0,0] op_sel_hi:[0,1] neg_hi:[0,0]
    v_pk_fma_f32 v[18:19], v[18:19], v[86:87], v[42:43] op_sel:[1,1,0] op_sel_hi:[1,0,1] neg_lo:[0,1,0]
    v_pk_mul_f32 v[42:43], v[26:27], v[88:89] op_sel:[0,0] op_sel_hi:[0,1] neg_hi:[0,0]
    v_pk_fma_f32 v[26:27], v[26:27], v[88:89], v[42:43] op_sel:[1,1,0] op_sel_hi:[1,0,1] neg_lo:[0,1,0]
    v_pk_mul_f32 v[42:43], v[30:31], v[90:91] op_sel:[0,0] op_sel_hi:[0,1] neg_hi:[0,0]
    v_pk_fma_f32 v[30:31], v[30:31], v[90:91], v[42:43] op_sel:[1,1,0] op_sel_hi:[1,0,1] neg_lo:[0,1,0]
    v_pk_mul_f32 v[42:43], v[34:35], v[92:93] op_sel:[0,0] op_sel_hi:[0,1] neg_hi:[0,0]
    v_pk_fma_f32 v[34:35], v[34:35], v[92:93], v[42:43] op_sel:[1,1,0] op_sel_hi:[1,0,1] neg_lo:[0,1,0]
    v_pk_mul_f32 v[42:43], v[10:11], v[94:95] op_sel:[0,0] op_sel_hi:[0,1] neg_hi:[0,0]
    v_pk_fma_f32 v[10:11], v[10:11], v[94:95], v[42:43] op_sel:[1,1,0] op_sel_hi:[1,0,1] neg_lo:[0,1,0]
    v_pk_mul_f32 v[42:43], v[24:25], v[96:97] op_sel:[0,0] op_sel_hi:[0,1] neg_hi:[0,0]
    v_pk_fma_f32 v[24:25], v[24:25], v[96:97], v[42:43] op_sel:[1,1,0] op_sel_hi:[1,0,1] neg_lo:[0,1,0]
    v_pk_mul_f32 v[42:43], v[14:15], v[98:99] op_sel:[0,0] op_sel_hi:[0,1] neg_hi:[0,0]
    v_pk_fma_f32 v[14:15], v[14:15], v[98:99], v[42:43] op_sel:[1,1,0] op_sel_hi:[1,0,1] neg_lo:[0,1,0]
    v_pk_mul_f32 v[42:43], v[8:9], v[100:101] op_sel:[0,0] op_sel_hi:[0,1] neg_hi:[0,0]
    v_pk_fma_f32 v[8:9], v[8:9], v[100:101], v[42:43] op_sel:[1,1,0] op_sel_hi:[1,0,1] neg_lo:[0,1,0]
    v_pk_mul_f32 v[42:43], v[38:39], v[102:103] op_sel:[0,0] op_sel_hi:[0,1] neg_hi:[0,0]
    v_pk_fma_f32 v[38:39], v[38:39], v[102:103], v[42:43] op_sel:[1,1,0] op_sel_hi:[1,0,1] neg_lo:[0,1,0]
    ds_write_b64 v125, v[36:37] offset:0
    ds_write_b64 v125, v[22:23] offset:72
    ds_write_b64 v125, v[12:13] offset:144
    ds_write_b64 v125, v[28:29] offset:216
    ds_write_b64 v125, v[16:17] offset:288
    ds_write_b64 v125, v[32:33] offset:360
    ds_write_b64 v125, v[40:41] offset:432
    ds_write_b64 v125, v[18:19] offset:504
    ds_write_b64 v125, v[26:27] offset:576
    ds_write_b64 v125, v[30:31] offset:648
    ds_write_b64 v125, v[34:35] offset:720
    ds_write_b64 v125, v[10:11] offset:792
    ds_write_b64 v125, v[24:25] offset:864
    ds_write_b64 v125, v[14:15] offset:936
    ds_write_b64 v125, v[8:9] offset:1008
    ds_write_b64 v125, v[38:39] offset:1080
    s_waitcnt lgkmcnt(0)
    ds_read_b64 v[36:37], v126 offset:0
    ds_read_b64 v[22:23], v126 offset:8
    ds_read_b64 v[12:13], v126 offset:16
    ds_read_b64 v[28:29], v126 offset:24
    ds_read_b64 v[16:17], v126 offset:32
    ds_read_b64 v[32:33], v126 offset:40
    ds_read_b64 v[40:41], v126 offset:48
    ds_read_b64 v[18:19], v126 offset:56
    ds_read_b64 v[26:27], v126 offset:576
    ds_read_b64 v[30:31], v126 offset:584
    ds_read_b64 v[34:35], v126 offset:592
    ds_read_b64 v[10:11], v126 offset:600
    ds_read_b64 v[24:25], v126 offset:608
    ds_read_b64 v[14:15], v126 offset:616
    ds_read_b64 v[8:9], v126 offset:624
    ds_read_b64 v[38:39], v126 offset:632
    s_waitcnt lgkmcnt(0)
    v_pk_add_f32 v[20:21], v[36:37], v[16:17]
    v_pk_add_f32 v[16:17], v[36:37], v[16:17] neg_lo:[0,1] neg_hi:[0,1]
    v_pk_add_f32 v[36:37], v[22:23], v[32:33]
    v_pk_add_f32 v[32:33], v[22:23], v[32:33] neg_lo:[0,1] neg_hi:[0,1]
    v_pk_mul_f32 v[42:43], v[32:33], s[12:13] op_sel:[0,0] op_sel_hi:[0,1] neg_lo:[0,0] neg_hi:[0,1]
    v_pk_fma_f32 v[32:33], v[32:33], s[12:13], v[42:43] op_sel:[1,1,0] op_sel_hi:[1,0,1] neg_lo:[0,0,0] neg_hi:[0,0,0]
    v_pk_add_f32 v[22:23], v[12:13], v[40:41]
    v_pk_add_f32 v[40:41], v[12:13], v[40:41] op_sel:[1,1] op_sel_hi:[0,0] neg_lo:[0,1] neg_hi:[1,0]
    v_pk_add_f32 v[12:13], v[28:29], v[18:19]
    v_pk_add_f32 v[18:19], v[28:29], v[18:19] neg_lo:[0,1] neg_hi:[0,1]
    v_pk_mul_f32 v[42:43], v[18:19], s[12:13] op_sel:[0,0] op_sel_hi:[0,1] neg_lo:[0,1] neg_hi:[0,1]
    v_pk_fma_f32 v[18:19], v[18:19], s[12:13], v[42:43] op_sel:[1,1,0] op_sel_hi:[1,0,1] neg_lo:[0,0,0] neg_hi:[0,1,0]
    v_pk_add_f32 v[28:29], v[20:21], v[22:23]
    v_pk_add_f32 v[22:23], v[20:21], v[22:23] neg_lo:[0,1] neg_hi:[0,1]
    v_pk_add_f32 v[20:21], v[36:37], v[12:13]
    v_pk_add_f32 v[12:13], v[36:37], v[12:13] op_sel:[1,1] op_sel_hi:[0,0] neg_lo:[0,1] neg_hi:[1,0]
    v_pk_add_f32 v[36:37], v[28:29], v[20:21]
    v_pk_add_f32 v[20:21], v[28:29], v[20:21] neg_lo:[0,1] neg_hi:[0,1]
    v_pk_add_f32 v[28:29], v[22:23], v[12:13]
    v_pk_add_f32 v[12:13], v[22:23], v[12:13] neg_lo:[0,1] neg_hi:[0,1]
    v_pk_add_f32 v[22:23], v[16:17], v[40:41]
    v_pk_add_f32 v[40:41], v[16:17], v[40:41] neg_lo:[0,1] neg_hi:[0,1]
    v_pk_add_f32 v[16:17], v[32:33], v[18:19]
    v_pk_add_f32 v[18:19], v[32:33], v[18:19] op_sel:[1,1] op_sel_hi:[0,0] neg_lo:[0,1] neg_hi:[1,0]
    v_pk_add_f32 v[32:33], v[22:23], v[16:17]
    v_pk_add_f32 v[16:17], v[22:23], v[16:17] neg_lo:[0,1] neg_hi:[0,1]
    v_pk_add_f32 v[22:23], v[40:41], v[18:19]
    v_pk_add_f32 v[18:19], v[40:41], v[18:19] neg_lo:[0,1] neg_hi:[0,1]
    v_pk_add_f32 v[40:41], v[26:27], v[24:25]
    v_pk_add_f32 v[24:25], v[26:27], v[24:25] neg_lo:[0,1] neg_hi:[0,1]
    v_pk_add_f32 v[26:27], v[30:31], v[14:15]
    v_pk_add_f32 v[14:15], v[30:31], v[14:15] neg_lo:[0,1] neg_hi:[0,1]
    v_pk_mul_f32 v[42:43], v[14:15], s[12:13] op_sel:[0,0] op_sel_hi:[0,1] neg_lo:[0,0] neg_hi:[0,1]
    v_pk_fma_f32 v[14:15], v[14:15], s[12:13], v[42:43] op_sel:[1,1,0] op_sel_hi:[1,0,1] neg_lo:[0,0,0] neg_hi:[0,0,0]
    v_pk_add_f32 v[30:31], v[34:35], v[8:9]
    v_pk_add_f32 v[8:9], v[34:35], v[8:9] op_sel:[1,1] op_sel_hi:[0,0] neg_lo:[0,1] neg_hi:[1,0]
    v_pk_add_f32 v[34:35], v[10:11], v[38:39]
    v_pk_add_f32 v[38:39], v[10:11], v[38:39] neg_lo:[0,1] neg_hi:[0,1]
    v_pk_mul_f32 v[42:43], v[38:39], s[12:13] op_sel:[0,0] op_sel_hi:[0,1] neg_lo:[0,1] neg_hi:[0,1]
    v_pk_fma_f32 v[38:39], v[38:39], s[12:13], v[42:43] op_sel:[1,1,0] op_sel_hi:[1,0,1] neg_lo:[0,0,0] neg_hi:[0,1,0]
    v_pk_add_f32 v[10:11], v[40:41], v[30:31]
    v_pk_add_f32 v[30:31], v[40:41], v[30:31] neg_lo:[0,1] neg_hi:[0,1]
    v_pk_add_f32 v[40:41], v[26:27], v[34:35]
    v_pk_add_f32 v[34:35], v[26:27], v[34:35] op_sel:[1,1] op_sel_hi:[0,0] neg_lo:[0,1] neg_hi:[1,0]
    v_pk_add_f32 v[26:27], v[10:11], v[40:41]
    v_pk_add_f32 v[40:41], v[10:11], v[40:41] neg_lo:[0,1] neg_hi:[0,1]
    v_pk_add_f32 v[10:11], v[30:31], v[34:35]
    v_pk_add_f32 v[34:35], v[30:31], v[34:35] neg_lo:[0,1] neg_hi:[0,1]
    v_pk_add_f32 v[30:31], v[24:25], v[8:9]
    v_pk_add_f32 v[8:9], v[24:25], v[8:9] neg_lo:[0,1] neg_hi:[0,1]
    v_pk_add_f32 v[24:25], v[14:15], v[38:39]
    v_pk_add_f32 v[38:39], v[14:15], v[38:39] op_sel:[1,1] op_sel_hi:[0,0] neg_lo:[0,1] neg_hi:[1,0]
    v_pk_add_f32 v[14:15], v[30:31], v[24:25]
    v_pk_add_f32 v[24:25], v[30:31], v[24:25] neg_lo:[0,1] neg_hi:[0,1]
    v_pk_add_f32 v[30:31], v[8:9], v[38:39]
    v_pk_add_f32 v[38:39], v[8:9], v[38:39] neg_lo:[0,1] neg_hi:[0,1]
    s_waitcnt vmcnt(0)
    v_lshlrev_b32 v120, 16, v104
    v_and_b32 v121, 0xffff0000, v104
    v_pk_mul_f32 v[120:121], v[120:121], s[28:29]
    v_pk_mul_f32 v[42:43], v[36:37], v[120:121] op_sel:[0,0] op_sel_hi:[0,1] neg_hi:[0,0]
    v_pk_fma_f32 v[36:37], v[36:37], v[120:121], v[42:43] op_sel:[1,1,0] op_sel_hi:[1,0,1] neg_lo:[0,1,0]
    v_lshlrev_b32 v120, 16, v105
    v_and_b32 v121, 0xffff0000, v105
    v_pk_mul_f32 v[120:121], v[120:121], s[28:29]
    v_pk_mul_f32 v[42:43], v[32:33], v[120:121] op_sel:[0,0] op_sel_hi:[0,1] neg_hi:[0,0]
    v_pk_fma_f32 v[32:33], v[32:33], v[120:121], v[42:43] op_sel:[1,1,0] op_sel_hi:[1,0,1] neg_lo:[0,1,0]
    v_lshlrev_b32 v120, 16, v106
    v_and_b32 v121, 0xffff0000, v106
    v_pk_mul_f32 v[120:121], v[120:121], s[28:29]
    v_pk_mul_f32 v[42:43], v[28:29], v[120:121] op_sel:[0,0] op_sel_hi:[0,1] neg_hi:[0,0]
    v_pk_fma_f32 v[28:29], v[28:29], v[120:121], v[42:43] op_sel:[1,1,0] op_sel_hi:[1,0,1] neg_lo:[0,1,0]
    v_lshlrev_b32 v120, 16, v107
    v_and_b32 v121, 0xffff0000, v107
    v_pk_mul_f32 v[120:121], v[120:121], s[28:29]
    v_pk_mul_f32 v[42:43], v[22:23], v[120:121] op_sel:[0,0] op_sel_hi:[0,1] neg_hi:[0,0]
    v_pk_fma_f32 v[22:23], v[22:23], v[120:121], v[42:43] op_sel:[1,1,0] op_sel_hi:[1,0,1] neg_lo:[0,1,0]
    v_lshlrev_b32 v120, 16, v108
    v_and_b32 v121, 0xffff0000, v108
    v_pk_mul_f32 v[120:121], v[120:121], s[28:29]
    v_pk_mul_f32 v[42:43], v[20:21], v[120:121] op_sel:[0,0] op_sel_hi:[0,1] neg_hi:[0,0]
    v_pk_fma_f32 v[20:21], v[20:21], v[120:121], v[42:43] op_sel:[1,1,0] op_sel_hi:[1,0,1] neg_lo:[0,1,0]
    v_lshlrev_b32 v120, 16, v109
    v_and_b32 v121, 0xffff0000, v109
    v_pk_mul_f32 v[120:121], v[120:121], s[28:29]
    v_pk_mul_f32 v[42:43], v[16:17], v[120:121] op_sel:[0,0] op_sel_hi:[0,1] neg_hi:[0,0]
    v_pk_fma_f32 v[16:17], v[16:17], v[120:121], v[42:43] op_sel:[1,1,0] op_sel_hi:[1,0,1] neg_lo:[0,1,0]
    v_lshlrev_b32 v120, 16, v110
    v_and_b32 v121, 0xffff0000, v110
    v_pk_mul_f32 v[120:121], v[120:121], s[28:29]
    v_pk_mul_f32 v[42:43], v[12:13], v[120:121] op_sel:[0,0] op_sel_hi:[0,1] neg_hi:[0,0]
    v_pk_fma_f32 v[12:13], v[12:13], v[120:121], v[42:43] op_sel:[1,1,0] op_sel_hi:[1,0,1] neg_lo:[0,1,0]
    v_lshlrev_b32 v120, 16, v111
    v_and_b32 v121, 0xffff0000, v111
    v_pk_mul_f32 v[120:121], v[120:121], s[28:29]
    v_pk_mul_f32 v[42:43], v[18:19], v[120:121] op_sel:[0,0] op_sel_hi:[0,1] neg_hi:[0,0]
    v_pk_fma_f32 v[18:19], v[18:19], v[120:121], v[42:43] op_sel:[1,1,0] op_sel_hi:[1,0,1] neg_lo:[0,1,0]
    v_lshlrev_b32 v120, 16, v112
    v_and_b32 v121, 0xffff0000, v112
    v_pk_mul_f32 v[120:121], v[120:121], s[28:29]
    v_pk_mul_f32 v[42:43], v[26:27], v[120:121] op_sel:[0,0] op_sel_hi:[0,1] neg_hi:[0,0]
    v_pk_fma_f32 v[26:27], v[26:27], v[120:121], v[42:43] op_sel:[1,1,0] op_sel_hi:[1,0,1] neg_lo:[0,1,0]
    v_lshlrev_b32 v120, 16, v113
    v_and_b32 v121, 0xffff0000, v113
    v_pk_mul_f32 v[120:121], v[120:121], s[28:29]
    v_pk_mul_f32 v[42:43], v[14:15], v[120:121] op_sel:[0,0] op_sel_hi:[0,1] neg_hi:[0,0]
    v_pk_fma_f32 v[14:15], v[14:15], v[120:121], v[42:43] op_sel:[1,1,0] op_sel_hi:[1,0,1] neg_lo:[0,1,0]
    v_lshlrev_b32 v120, 16, v114
    v_and_b32 v121, 0xffff0000, v114
    v_pk_mul_f32 v[120:121], v[120:121], s[28:29]
    v_pk_mul_f32 v[42:43], v[10:11], v[120:121] op_sel:[0,0] op_sel_hi:[0,1] neg_hi:[0,0]
    v_pk_fma_f32 v[10:11], v[10:11], v[120:121], v[42:43] op_sel:[1,1,0] op_sel_hi:[1,0,1] neg_lo:[0,1,0]
    v_lshlrev_b32 v120, 16, v115
    v_and_b32 v121, 0xffff0000, v115
    v_pk_mul_f32 v[120:121], v[120:121], s[28:29]
    v_pk_mul_f32 v[42:43], v[30:31], v[120:121] op_sel:[0,0] op_sel_hi:[0,1] neg_hi:[0,0]
    v_pk_fma_f32 v[30:31], v[30:31], v[120:121], v[42:43] op_sel:[1,1,0] op_sel_hi:[1,0,1] neg_lo:[0,1,0]
    v_lshlrev_b32 v120, 16, v116
    v_and_b32 v121, 0xffff0000, v116
    v_pk_mul_f32 v[120:121], v[120:121], s[28:29]
    v_pk_mul_f32 v[42:43], v[40:41], v[120:121] op_sel:[0,0] op_sel_hi:[0,1] neg_hi:[0,0]
    v_pk_fma_f32 v[40:41], v[40:41], v[120:121], v[42:43] op_sel:[1,1,0] op_sel_hi:[1,0,1] neg_lo:[0,1,0]
    v_lshlrev_b32 v120, 16, v117
    v_and_b32 v121, 0xffff0000, v117
    v_pk_mul_f32 v[120:121], v[120:121], s[28:29]
    v_pk_mul_f32 v[42:43], v[24:25], v[120:121] op_sel:[0,0] op_sel_hi:[0,1] neg_hi:[0,0]
    v_pk_fma_f32 v[24:25], v[24:25], v[120:121], v[42:43] op_sel:[1,1,0] op_sel_hi:[1,0,1] neg_lo:[0,1,0]
    v_lshlrev_b32 v120, 16, v118
    v_and_b32 v121, 0xffff0000, v118
    v_pk_mul_f32 v[120:121], v[120:121], s[28:29]
    v_pk_mul_f32 v[42:43], v[34:35], v[120:121] op_sel:[0,0] op_sel_hi:[0,1] neg_hi:[0,0]
    v_pk_fma_f32 v[34:35], v[34:35], v[120:121], v[42:43] op_sel:[1,1,0] op_sel_hi:[1,0,1] neg_lo:[0,1,0]
    v_lshlrev_b32 v120, 16, v119
    v_and_b32 v121, 0xffff0000, v119
    v_pk_mul_f32 v[120:121], v[120:121], s[28:29]
    v_pk_mul_f32 v[42:43], v[38:39], v[120:121] op_sel:[0,0] op_sel_hi:[0,1] neg_hi:[0,0]
    v_pk_fma_f32 v[38:39], v[38:39], v[120:121], v[42:43] op_sel:[1,1,0] op_sel_hi:[1,0,1] neg_lo:[0,1,0]
    v_pk_add_f32 v[8:9], v[36:37], v[20:21]
    v_pk_add_f32 v[20:21], v[36:37], v[20:21] neg_lo:[0,1] neg_hi:[0,1]
    v_pk_add_f32 v[36:37], v[32:33], v[16:17]
    v_pk_add_f32 v[16:17], v[32:33], v[16:17] neg_lo:[0,1] neg_hi:[0,1]
    v_pk_mul_f32 v[42:43], v[16:17], s[12:13] op_sel:[0,0] op_sel_hi:[0,1] neg_lo:[0,0] neg_hi:[0,0]
    v_pk_fma_f32 v[16:17], v[16:17], s[12:13], v[42:43] op_sel:[1,1,0] op_sel_hi:[1,0,1] neg_lo:[0,1,0] neg_hi:[0,0,0]
    v_pk_add_f32 v[32:33], v[28:29], v[12:13]
    v_pk_add_f32 v[12:13], v[28:29], v[12:13] op_sel:[1,1] op_sel_hi:[0,0] neg_lo:[1,0] neg_hi:[0,1]
    v_pk_add_f32 v[28:29], v[22:23], v[18:19]
    v_pk_add_f32 v[18:19], v[22:23], v[18:19] neg_lo:[0,1] neg_hi:[0,1]
    v_pk_mul_f32 v[42:43], v[18:19], s[12:13] op_sel:[0,0] op_sel_hi:[0,1] neg_lo:[0,1] neg_hi:[0,0]
    v_pk_fma_f32 v[18:19], v[18:19], s[12:13], v[42:43] op_sel:[1,1,0] op_sel_hi:[1,0,1] neg_lo:[0,1,0] neg_hi:[0,1,0]
    v_pk_add_f32 v[22:23], v[8:9], v[32:33]
    v_pk_add_f32 v[32:33], v[8:9], v[32:33] neg_lo:[0,1] neg_hi:[0,1]
    v_pk_add_f32 v[8:9], v[36:37], v[28:29]
    v_pk_add_f32 v[28:29], v[36:37], v[28:29] op_sel:[1,1] op_sel_hi:[0,0] neg_lo:[1,0] neg_hi:[0,1]
    v_pk_add_f32 v[36:37], v[22:23], v[8:9]
    v_pk_add_f32 v[8:9], v[22:23], v[8:9] neg_lo:[0,1] neg_hi:[0,1]
    v_pk_add_f32 v[22:23], v[32:33], v[28:29]
    v_pk_add_f32 v[28:29], v[32:33], v[28:29] neg_lo:[0,1] neg_hi:[0,1]
    v_pk_add_f32 v[32:33], v[20:21], v[12:13]
    v_pk_add_f32 v[12:13], v[20:21], v[12:13] neg_lo:[0,1] neg_hi:[0,1]
    v_pk_add_f32 v[20:21], v[16:17], v[18:19]
    v_pk_add_f32 v[18:19], v[16:17], v[18:19] op_sel:[1,1] op_sel_hi:[0,0] neg_lo:[1,0] neg_hi:[0,1]
    v_pk_add_f32 v[16:17], v[32:33], v[20:21]
    v_pk_add_f32 v[20:21], v[32:33], v[20:21] neg_lo:[0,1] neg_hi:[0,1]
    v_pk_add_f32 v[32:33], v[12:13], v[18:19]
    v_pk_add_f32 v[18:19], v[12:13], v[18:19] neg_lo:[0,1] neg_hi:[0,1]
    v_pk_add_f32 v[12:13], v[26:27], v[40:41]
    v_pk_add_f32 v[40:41], v[26:27], v[40:41] neg_lo:[0,1] neg_hi:[0,1]
    v_pk_add_f32 v[26:27], v[14:15], v[24:25]
    v_pk_add_f32 v[24:25], v[14:15], v[24:25] neg_lo:[0,1] neg_hi:[0,1]
    v_pk_mul_f32 v[42:43], v[24:25], s[12:13] op_sel:[0,0] op_sel_hi:[0,1] neg_lo:[0,0] neg_hi:[0,0]
    v_pk_fma_f32 v[24:25], v[24:25], s[12:13], v[42:43] op_sel:[1,1,0] op_sel_hi:[1,0,1] neg_lo:[0,1,0] neg_hi:[0,0,0]
    v_pk_add_f32 v[14:15], v[10:11], v[34:35]
    v_pk_add_f32 v[34:35], v[10:11], v[34:35] op_sel:[1,1] op_sel_hi:[0,0] neg_lo:[1,0] neg_hi:[0,1]
    v_pk_add_f32 v[10:11], v[30:31], v[38:39]
    v_pk_add_f32 v[38:39], v[30:31], v[38:39] neg_lo:[0,1] neg_hi:[0,1]
    v_pk_mul_f32 v[42:43], v[38:39], s[12:13] op_sel:[0,0] op_sel_hi:[0,1] neg_lo:[0,1] neg_hi:[0,0]
    v_pk_fma_f32 v[38:39], v[38:39], s[12:13], v[42:43] op_sel:[1,1,0] op_sel_hi:[1,0,1] neg_lo:[0,1,0] neg_hi:[0,1,0]
    v_pk_add_f32 v[30:31], v[12:13], v[14:15]
    v_pk_add_f32 v[14:15], v[12:13], v[14:15] neg_lo:[0,1] neg_hi:[0,1]
    v_pk_add_f32 v[12:13], v[26:27], v[10:11]
    v_pk_add_f32 v[10:11], v[26:27], v[10:11] op_sel:[1,1] op_sel_hi:[0,0] neg_lo:[1,0] neg_hi:[0,1]
    v_pk_add_f32 v[26:27], v[30:31], v[12:13]
    v_pk_add_f32 v[12:13], v[30:31], v[12:13] neg_lo:[0,1] neg_hi:[0,1]
    v_pk_add_f32 v[30:31], v[14:15], v[10:11]
    v_pk_add_f32 v[10:11], v[14:15], v[10:11] neg_lo:[0,1] neg_hi:[0,1]
    v_pk_add_f32 v[14:15], v[40:41], v[34:35]
    v_pk_add_f32 v[34:35], v[40:41], v[34:35] neg_lo:[0,1] neg_hi:[0,1]
    v_pk_add_f32 v[40:41], v[24:25], v[38:39]
    v_pk_add_f32 v[38:39], v[24:25], v[38:39] op_sel:[1,1] op_sel_hi:[0,0] neg_lo:[1,0] neg_hi:[0,1]
    v_pk_add_f32 v[24:25], v[14:15], v[40:41]
    v_pk_add_f32 v[40:41], v[14:15], v[40:41] neg_lo:[0,1] neg_hi:[0,1]
    v_pk_add_f32 v[14:15], v[34:35], v[38:39]
    v_pk_add_f32 v[38:39], v[34:35], v[38:39] neg_lo:[0,1] neg_hi:[0,1]
    ds_write_b64 v126, v[36:37] offset:0
    ds_write_b64 v126, v[16:17] offset:8
    ds_write_b64 v126, v[22:23] offset:16
    ds_write_b64 v126, v[32:33] offset:24
    ds_write_b64 v126, v[8:9] offset:32
    ds_write_b64 v126, v[20:21] offset:40
    ds_write_b64 v126, v[28:29] offset:48
    ds_write_b64 v126, v[18:19] offset:56
    ds_write_b64 v126, v[26:27] offset:576
    ds_write_b64 v126, v[24:25] offset:584
    ds_write_b64 v126, v[30:31] offset:592
    ds_write_b64 v126, v[14:15] offset:600
    ds_write_b64 v126, v[12:13] offset:608
    ds_write_b64 v126, v[40:41] offset:616
    ds_write_b64 v126, v[10:11] offset:624
    ds_write_b64 v126, v[38:39] offset:632
    s_waitcnt lgkmcnt(0)
    ds_read_b64 v[36:37], v125 offset:0
    ds_read_b64 v[16:17], v125 offset:72
    ds_read_b64 v[22:23], v125 offset:144
    ds_read_b64 v[32:33], v125 offset:216
    ds_read_b64 v[8:9], v125 offset:288
    ds_read_b64 v[20:21], v125 offset:360
    ds_read_b64 v[28:29], v125 offset:432
    ds_read_b64 v[18:19], v125 offset:504
    ds_read_b64 v[26:27], v125 offset:576
    ds_read_b64 v[24:25], v125 offset:648
    ds_read_b64 v[30:31], v125 offset:720
    ds_read_b64 v[14:15], v125 offset:792
    ds_read_b64 v[12:13], v125 offset:864
    ds_read_b64 v[40:41], v125 offset:936
    ds_read_b64 v[10:11], v125 offset:1008
    ds_read_b64 v[38:39], v125 offset:1080
    s_waitcnt lgkmcnt(0)
    v_pk_mul_f32 v[42:43], v[16:17], v[74:75] op_sel:[0,0] op_sel_hi:[0,1] neg_hi:[0,1]
    v_pk_fma_f32 v[16:17], v[16:17], v[74:75], v[42:43] op_sel:[1,1,0] op_sel_hi:[1,0,1] neg_lo:[0,0,0]
    v_pk_mul_f32 v[42:43], v[22:23], v[76:77] op_sel:[0,0] op_sel_hi:[0,1] neg_hi:[0,1]
    v_pk_fma_f32 v[22:23], v[22:23], v[76:77], v[42:43] op_sel:[1,1,0] op_sel_hi:[1,0,1] neg_lo:[0,0,0]
    v_pk_mul_f32 v[42:43], v[32:33], v[78:79] op_sel:[0,0] op_sel_hi:[0,1] neg_hi:[0,1]
    v_pk_fma_f32 v[32:33], v[32:33], v[78:79], v[42:43] op_sel:[1,1,0] op_sel_hi:[1,0,1] neg_lo:[0,0,0]
    v_pk_mul_f32 v[42:43], v[8:9], v[80:81] op_sel:[0,0] op_sel_hi:[0,1] neg_hi:[0,1]
    v_pk_fma_f32 v[8:9], v[8:9], v[80:81], v[42:43] op_sel:[1,1,0] op_sel_hi:[1,0,1] neg_lo:[0,0,0]
    v_pk_mul_f32 v[42:43], v[20:21], v[82:83] op_sel:[0,0] op_sel_hi:[0,1] neg_hi:[0,1]
    v_pk_fma_f32 v[20:21], v[20:21], v[82:83], v[42:43] op_sel:[1,1,0] op_sel_hi:[1,0,1] neg_lo:[0,0,0]
    v_pk_mul_f32 v[42:43], v[28:29], v[84:85] op_sel:[0,0] op_sel_hi:[0,1] neg_hi:[0,1]
    v_pk_fma_f32 v[28:29], v[28:29], v[84:85], v[42:43] op_sel:[1,1,0] op_sel_hi:[1,0,1] neg_lo:[0,0,0]
    v_pk_mul_f32 v[42:43], v[18:19], v[86:87] op_sel:[0,0] op_sel_hi:[0,1] neg_hi:[0,1]
    v_pk_fma_f32 v[18:19], v[18:19], v[86:87], v[42:43] op_sel:[1,1,0] op_sel_hi:[1,0,1] neg_lo:[0,0,0]
    v_pk_mul_f32 v[42:43], v[26:27], v[88:89] op_sel:[0,0] op_sel_hi:[0,1] neg_hi:[0,1]
    v_pk_fma_f32 v[26:27], v[26:27], v[88:89], v[42:43] op_sel:[1,1,0] op_sel_hi:[1,0,1] neg_lo:[0,0,0]
    v_pk_mul_f32 v[42:43], v[24:25], v[90:91] op_sel:[0,0] op_sel_hi:[0,1] neg_hi:[0,1]
    v_pk_fma_f32 v[24:25], v[24:25], v[90:91], v[42:43] op_sel:[1,1,0] op_sel_hi:[1,0,1] neg_lo:[0,0,0]
    v_pk_mul_f32 v[42:43], v[30:31], v[92:93] op_sel:[0,0] op_sel_hi:[0,1] neg_hi:[0,1]
    v_pk_fma_f32 v[30:31], v[30:31], v[92:93], v[42:43] op_sel:[1,1,0] op_sel_hi:[1,0,1] neg_lo:[0,0,0]
    v_pk_mul_f32 v[42:43], v[14:15], v[94:95] op_sel:[0,0] op_sel_hi:[0,1] neg_hi:[0,1]
    v_pk_fma_f32 v[14:15], v[14:15], v[94:95], v[42:43] op_sel:[1,1,0] op_sel_hi:[1,0,1] neg_lo:[0,0,0]
    v_pk_mul_f32 v[42:43], v[12:13], v[96:97] op_sel:[0,0] op_sel_hi:[0,1] neg_hi:[0,1]
    v_pk_fma_f32 v[12:13], v[12:13], v[96:97], v[42:43] op_sel:[1,1,0] op_sel_hi:[1,0,1] neg_lo:[0,0,0]
    v_pk_mul_f32 v[42:43], v[40:41], v[98:99] op_sel:[0,0] op_sel_hi:[0,1] neg_hi:[0,1]
    v_pk_fma_f32 v[40:41], v[40:41], v[98:99], v[42:43] op_sel:[1,1,0] op_sel_hi:[1,0,1] neg_lo:[0,0,0]
    v_pk_mul_f32 v[42:43], v[10:11], v[100:101] op_sel:[0,0] op_sel_hi:[0,1] neg_hi:[0,1]
    v_pk_fma_f32 v[10:11], v[10:11], v[100:101], v[42:43] op_sel:[1,1,0] op_sel_hi:[1,0,1] neg_lo:[0,0,0]
    v_pk_mul_f32 v[42:43], v[38:39], v[102:103] op_sel:[0,0] op_sel_hi:[0,1] neg_hi:[0,1]
    v_pk_fma_f32 v[38:39], v[38:39], v[102:103], v[42:43] op_sel:[1,1,0] op_sel_hi:[1,0,1] neg_lo:[0,0,0]
    v_pk_add_f32 v[34:35], v[36:37], v[26:27]
    v_pk_add_f32 v[26:27], v[36:37], v[26:27] neg_lo:[0,1] neg_hi:[0,1]
    v_pk_add_f32 v[36:37], v[16:17], v[24:25]
    v_pk_add_f32 v[24:25], v[16:17], v[24:25] neg_lo:[0,1] neg_hi:[0,1]
    v_pk_mul_f32 v[42:43], v[24:25], s[14:15] op_sel:[0,0] op_sel_hi:[0,1] neg_lo:[0,0] neg_hi:[0,0]
    v_pk_fma_f32 v[24:25], v[24:25], s[14:15], v[42:43] op_sel:[1,1,0] op_sel_hi:[1,0,1] neg_lo:[0,1,0] neg_hi:[0,0,0]
    v_pk_add_f32 v[16:17], v[22:23], v[30:31]
    v_pk_add_f32 v[30:31], v[22:23], v[30:31] neg_lo:[0,1] neg_hi:[0,1]
    v_pk_mul_f32 v[42:43], v[30:31], s[12:13] op_sel:[0,0] op_sel_hi:[0,1] neg_lo:[0,0] neg_hi:[0,0]
    v_pk_fma_f32 v[30:31], v[30:31], s[12:13], v[42:43] op_sel:[1,1,0] op_sel_hi:[1,0,1] neg_lo:[0,1,0] neg_hi:[0,0,0]
    v_pk_add_f32 v[22:23], v[32:33], v[14:15]
    v_pk_add_f32 v[14:15], v[32:33], v[14:15] neg_lo:[0,1] neg_hi:[0,1]
    v_pk_mul_f32 v[42:43], v[14:15], s[14:15] op_sel:[0,1] op_sel_hi:[0,0] neg_lo:[0,0] neg_hi:[0,0]
    v_pk_fma_f32 v[14:15], v[14:15], s[14:15], v[42:43] op_sel:[1,0,0] op_sel_hi:[1,1,1] neg_lo:[0,1,0] neg_hi:[0,0,0]
    v_pk_add_f32 v[32:33], v[8:9], v[12:13]
    v_pk_add_f32 v[12:13], v[8:9], v[12:13] op_sel:[1,1] op_sel_hi:[0,0] neg_lo:[1,0] neg_hi:[0,1]
    v_pk_add_f32 v[8:9], v[20:21], v[40:41]
    v_pk_add_f32 v[40:41], v[20:21], v[40:41] neg_lo:[0,1] neg_hi:[0,1]
    v_pk_mul_f32 v[42:43], v[40:41], s[14:15] op_sel:[0,1] op_sel_hi:[0,0] neg_lo:[0,1] neg_hi:[0,0]
    v_pk_fma_f32 v[40:41], v[40:41], s[14:15], v[42:43] op_sel:[1,0,0] op_sel_hi:[1,1,1] neg_lo:[0,1,0] neg_hi:[0,1,0]
    v_pk_add_f32 v[20:21], v[28:29], v[10:11]
    v_pk_add_f32 v[10:11], v[28:29], v[10:11] neg_lo:[0,1] neg_hi:[0,1]
    v_pk_mul_f32 v[42:43], v[10:11], s[12:13] op_sel:[0,0] op_sel_hi:[0,1] neg_lo:[0,1] neg_hi:[0,0]
    v_pk_fma_f32 v[10:11], v[10:11], s[12:13], v[42:43] op_sel:[1,1,0] op_sel_hi:[1,0,1] neg_lo:[0,1,0] neg_hi:[0,1,0]
    v_pk_add_f32 v[28:29], v[18:19], v[38:39]
    v_pk_add_f32 v[38:39], v[18:19], v[38:39] neg_lo:[0,1] neg_hi:[0,1]
    v_pk_mul_f32 v[42:43], v[38:39], s[14:15] op_sel:[0,0] op_sel_hi:[0,1] neg_lo:[0,1] neg_hi:[0,0]
    v_pk_fma_f32 v[38:39], v[38:39], s[14:15], v[42:43] op_sel:[1,1,0] op_sel_hi:[1,0,1] neg_lo:[0,1,0] neg_hi:[0,1,0]
    v_pk_add_f32 v[18:19], v[34:35], v[32:33]
    v_pk_add_f32 v[32:33], v[34:35], v[32:33] neg_lo:[0,1] neg_hi:[0,1]
    v_pk_add_f32 v[34:35], v[36:37], v[8:9]
    v_pk_add_f32 v[8:9], v[36:37], v[8:9] neg_lo:[0,1] neg_hi:[0,1]
    v_pk_mul_f32 v[42:43], v[8:9], s[12:13] op_sel:[0,0] op_sel_hi:[0,1] neg_lo:[0,0] neg_hi:[0,0]
    v_pk_fma_f32 v[8:9], v[8:9], s[12:13], v[42:43] op_sel:[1,1,0] op_sel_hi:[1,0,1] neg_lo:[0,1,0] neg_hi:[0,0,0]
    v_pk_add_f32 v[36:37], v[16:17], v[20:21]
    v_pk_add_f32 v[20:21], v[16:17], v[20:21] op_sel:[1,1] op_sel_hi:[0,0] neg_lo:[1,0] neg_hi:[0,1]
    v_pk_add_f32 v[16:17], v[22:23], v[28:29]
    v_pk_add_f32 v[28:29], v[22:23], v[28:29] neg_lo:[0,1] neg_hi:[0,1]
    v_pk_mul_f32 v[42:43], v[28:29], s[12:13] op_sel:[0,0] op_sel_hi:[0,1] neg_lo:[0,1] neg_hi:[0,0]
    v_pk_fma_f32 v[28:29], v[28:29], s[12:13], v[42:43] op_sel:[1,1,0] op_sel_hi:[1,0,1] neg_lo:[0,1,0] neg_hi:[0,1,0]
    v_pk_add_f32 v[22:23], v[18:19], v[36:37]
    v_pk_add_f32 v[36:37], v[18:19], v[36:37] neg_lo:[0,1] neg_hi:[0,1]
    v_pk_add_f32 v[18:19], v[34:35], v[16:17]
    v_pk_add_f32 v[16:17], v[34:35], v[16:17] op_sel:[1,1] op_sel_hi:[0,0] neg_lo:[1,0] neg_hi:[0,1]
    v_pk_add_f32 v[34:35], v[22:23], v[18:19]
    v_pk_add_f32 v[18:19], v[22:23], v[18:19] neg_lo:[0,1] neg_hi:[0,1]
    v_pk_add_f32 v[22:23], v[36:37], v[16:17]
    v_pk_add_f32 v[16:17], v[36:37], v[16:17] neg_lo:[0,1] neg_hi:[0,1]
    v_pk_add_f32 v[36:37], v[32:33], v[20:21]
    v_pk_add_f32 v[20:21], v[32:33], v[20:21] neg_lo:[0,1] neg_hi:[0,1]
    v_pk_add_f32 v[32:33], v[8:9], v[28:29]
    v_pk_add_f32 v[28:29], v[8:9], v[28:29] op_sel:[1,1] op_sel_hi:[0,0] neg_lo:[1,0] neg_hi:[0,1]
    v_pk_add_f32 v[8:9], v[36:37], v[32:33]
    v_pk_add_f32 v[32:33], v[36:37], v[32:33] neg_lo:[0,1] neg_hi:[0,1]
    v_pk_add_f32 v[36:37], v[20:21], v[28:29]
    v_pk_add_f32 v[28:29], v[20:21], v[28:29] neg_lo:[0,1] neg_hi:[0,1]
    v_pk_add_f32 v[20:21], v[26:27], v[12:13]
    v_pk_add_f32 v[12:13], v[26:27], v[12:13] neg_lo:[0,1] neg_hi:[0,1]
    v_pk_add_f32 v[26:27], v[24:25], v[40:41]
    v_pk_add_f32 v[40:41], v[24:25], v[40:41] neg_lo:[0,1] neg_hi:[0,1]
    v_pk_mul_f32 v[42:43], v[40:41], s[12:13] op_sel:[0,0] op_sel_hi:[0,1] neg_lo:[0,0] neg_hi:[0,0]
    v_pk_fma_f32 v[40:41], v[40:41], s[12:13], v[42:43] op_sel:[1,1,0] op_sel_hi:[1,0,1] neg_lo:[0,1,0] neg_hi:[0,0,0]
    v_pk_add_f32 v[24:25], v[30:31], v[10:11]
    v_pk_add_f32 v[10:11], v[30:31], v[10:11] op_sel:[1,1] op_sel_hi:[0,0] neg_lo:[1,0] neg_hi:[0,1]
    v_pk_add_f32 v[30:31], v[14:15], v[38:39]
    v_pk_add_f32 v[38:39], v[14:15], v[38:39] neg_lo:[0,1] neg_hi:[0,1]
    v_pk_mul_f32 v[42:43], v[38:39], s[12:13] op_sel:[0,0] op_sel_hi:[0,1] neg_lo:[0,1] neg_hi:[0,0]
    v_pk_fma_f32 v[38:39], v[38:39], s[12:13], v[42:43] op_sel:[1,1,0] op_sel_hi:[1,0,1] neg_lo:[0,1,0] neg_hi:[0,1,0]
    v_pk_add_f32 v[14:15], v[20:21], v[24:25]
    v_pk_add_f32 v[24:25], v[20:21], v[24:25] neg_lo:[0,1] neg_hi:[0,1]
    v_pk_add_f32 v[20:21], v[26:27], v[30:31]
    v_pk_add_f32 v[30:31], v[26:27], v[30:31] op_sel:[1,1] op_sel_hi:[0,0] neg_lo:[1,0] neg_hi:[0,1]
    v_pk_add_f32 v[26:27], v[14:15], v[20:21]
    v_pk_add_f32 v[20:21], v[14:15], v[20:21] neg_lo:[0,1] neg_hi:[0,1]
    v_pk_add_f32 v[14:15], v[24:25], v[30:31]
    v_pk_add_f32 v[30:31], v[24:25], v[30:31] neg_lo:[0,1] neg_hi:[0,1]
    v_pk_add_f32 v[24:25], v[12:13], v[10:11]
    v_pk_add_f32 v[10:11], v[12:13], v[10:11] neg_lo:[0,1] neg_hi:[0,1]
    v_pk_add_f32 v[12:13], v[40:41], v[38:39]
    v_pk_add_f32 v[38:39], v[40:41], v[38:39] op_sel:[1,1] op_sel_hi:[0,0] neg_lo:[1,0] neg_hi:[0,1]
    v_pk_add_f32 v[40:41], v[24:25], v[12:13]
    v_pk_add_f32 v[12:13], v[24:25], v[12:13] neg_lo:[0,1] neg_hi:[0,1]
    v_pk_add_f32 v[24:25], v[10:11], v[38:39]
    v_pk_add_f32 v[38:39], v[10:11], v[38:39] neg_lo:[0,1] neg_hi:[0,1]
    ds_write_b64 v125, v[34:35] offset:0
    ds_write_b64 v125, v[26:27] offset:64
    ds_write_b64 v125, v[8:9] offset:128
    ds_write_b64 v125, v[40:41] offset:192
    ds_write_b64 v125, v[22:23] offset:256
    ds_write_b64 v125, v[14:15] offset:320
    ds_write_b64 v125, v[36:37] offset:384
    ds_write_b64 v125, v[24:25] offset:448
    ds_write_b64 v125, v[18:19] offset:512
    ds_write_b64 v125, v[20:21] offset:576
    ds_write_b64 v125, v[32:33] offset:640
    ds_write_b64 v125, v[12:13] offset:704
    ds_write_b64 v125, v[16:17] offset:768
    ds_write_b64 v125, v[30:31] offset:832
    ds_write_b64 v125, v[28:29] offset:896
    ds_write_b64 v125, v[38:39] offset:960
    s_waitcnt lgkmcnt(0)
    s_barrier
    ds_read_b64 v[34:35], v124 offset:0
    ds_read_b64 v[26:27], v124 offset:1216
    ds_read_b64 v[8:9], v124 offset:2432
    ds_read_b64 v[40:41], v124 offset:3648
    ds_read_b64 v[22:23], v124 offset:4864
    ds_read_b64 v[14:15], v124 offset:6080
    ds_read_b64 v[36:37], v124 offset:7296
    ds_read_b64 v[24:25], v124 offset:8512
    ds_read_b64 v[18:19], v124 offset:9728
    ds_read_b64 v[20:21], v124 offset:10944
    ds_read_b64 v[32:33], v124 offset:12160
    ds_read_b64 v[12:13], v124 offset:13376
    ds_read_b64 v[16:17], v124 offset:14592
    ds_read_b64 v[30:31], v124 offset:15808
    ds_read_b64 v[28:29], v124 offset:17024
    ds_read_b64 v[38:39], v124 offset:18240
    s_waitcnt lgkmcnt(0)
    v_pk_mul_f32 v[42:43], v[26:27], v[44:45] op_sel:[0,0] op_sel_hi:[0,1] neg_hi:[0,1]
    v_pk_fma_f32 v[26:27], v[26:27], v[44:45], v[42:43] op_sel:[1,1,0] op_sel_hi:[1,0,1] neg_lo:[0,0,0]
    v_pk_mul_f32 v[42:43], v[8:9], v[46:47] op_sel:[0,0] op_sel_hi:[0,1] neg_hi:[0,1]
    v_pk_fma_f32 v[8:9], v[8:9], v[46:47], v[42:43] op_sel:[1,1,0] op_sel_hi:[1,0,1] neg_lo:[0,0,0]
    v_pk_mul_f32 v[42:43], v[40:41], v[48:49] op_sel:[0,0] op_sel_hi:[0,1] neg_hi:[0,1]
    v_pk_fma_f32 v[40:41], v[40:41], v[48:49], v[42:43] op_sel:[1,1,0] op_sel_hi:[1,0,1] neg_lo:[0,0,0]
    v_pk_mul_f32 v[42:43], v[22:23], v[50:51] op_sel:[0,0] op_sel_hi:[0,1] neg_hi:[0,1]
    v_pk_fma_f32 v[22:23], v[22:23], v[50:51], v[42:43] op_sel:[1,1,0] op_sel_hi:[1,0,1] neg_lo:[0,0,0]
    v_pk_mul_f32 v[42:43], v[14:15], v[52:53] op_sel:[0,0] op_sel_hi:[0,1] neg_hi:[0,1]
    v_pk_fma_f32 v[14:15], v[14:15], v[52:53], v[42:43] op_sel:[1,1,0] op_sel_hi:[1,0,1] neg_lo:[0,0,0]
    v_pk_mul_f32 v[42:43], v[36:37], v[54:55] op_sel:[0,0] op_sel_hi:[0,1] neg_hi:[0,1]
    v_pk_fma_f32 v[36:37], v[36:37], v[54:55], v[42:43] op_sel:[1,1,0] op_sel_hi:[1,0,1] neg_lo:[0,0,0]
    v_pk_mul_f32 v[42:43], v[24:25], v[56:57] op_sel:[0,0] op_sel_hi:[0,1] neg_hi:[0,1]
    v_pk_fma_f32 v[24:25], v[24:25], v[56:57], v[42:43] op_sel:[1,1,0] op_sel_hi:[1,0,1] neg_lo:[0,0,0]
    v_pk_mul_f32 v[42:43], v[18:19], v[58:59] op_sel:[0,0] op_sel_hi:[0,1] neg_hi:[0,1]
    v_pk_fma_f32 v[18:19], v[18:19], v[58:59], v[42:43] op_sel:[1,1,0] op_sel_hi:[1,0,1] neg_lo:[0,0,0]
    v_pk_mul_f32 v[42:43], v[20:21], v[60:61] op_sel:[0,0] op_sel_hi:[0,1] neg_hi:[0,1]
    v_pk_fma_f32 v[20:21], v[20:21], v[60:61], v[42:43] op_sel:[1,1,0] op_sel_hi:[1,0,1] neg_lo:[0,0,0]
    v_pk_mul_f32 v[42:43], v[32:33], v[62:63] op_sel:[0,0] op_sel_hi:[0,1] neg_hi:[0,1]
    v_pk_fma_f32 v[32:33], v[32:33], v[62:63], v[42:43] op_sel:[1,1,0] op_sel_hi:[1,0,1] neg_lo:[0,0,0]
    v_pk_mul_f32 v[42:43], v[12:13], v[64:65] op_sel:[0,0] op_sel_hi:[0,1] neg_hi:[0,1]
    v_pk_fma_f32 v[12:13], v[12:13], v[64:65], v[42:43] op_sel:[1,1,0] op_sel_hi:[1,0,1] neg_lo:[0,0,0]
    v_pk_mul_f32 v[42:43], v[16:17], v[66:67] op_sel:[0,0] op_sel_hi:[0,1] neg_hi:[0,1]
    v_pk_fma_f32 v[16:17], v[16:17], v[66:67], v[42:43] op_sel:[1,1,0] op_sel_hi:[1,0,1] neg_lo:[0,0,0]
    v_pk_mul_f32 v[42:43], v[30:31], v[68:69] op_sel:[0,0] op_sel_hi:[0,1] neg_hi:[0,1]
    v_pk_fma_f32 v[30:31], v[30:31], v[68:69], v[42:43] op_sel:[1,1,0] op_sel_hi:[1,0,1] neg_lo:[0,0,0]
    v_pk_mul_f32 v[42:43], v[28:29], v[70:71] op_sel:[0,0] op_sel_hi:[0,1] neg_hi:[0,1]
    v_pk_fma_f32 v[28:29], v[28:29], v[70:71], v[42:43] op_sel:[1,1,0] op_sel_hi:[1,0,1] neg_lo:[0,0,0]
    v_pk_mul_f32 v[42:43], v[38:39], v[72:73] op_sel:[0,0] op_sel_hi:[0,1] neg_hi:[0,1]
    v_pk_fma_f32 v[38:39], v[38:39], v[72:73], v[42:43] op_sel:[1,1,0] op_sel_hi:[1,0,1] neg_lo:[0,0,0]
    v_pk_add_f32 v[10:11], v[34:35], v[18:19]
    v_pk_add_f32 v[18:19], v[34:35], v[18:19] neg_lo:[0,1] neg_hi:[0,1]
    v_pk_add_f32 v[34:35], v[26:27], v[20:21]
    v_pk_add_f32 v[20:21], v[26:27], v[20:21] neg_lo:[0,1] neg_hi:[0,1]
    v_pk_mul_f32 v[42:43], v[20:21], s[14:15] op_sel:[0,0] op_sel_hi:[0,1] neg_lo:[0,0] neg_hi:[0,0]
    v_pk_fma_f32 v[20:21], v[20:21], s[14:15], v[42:43] op_sel:[1,1,0] op_sel_hi:[1,0,1] neg_lo:[0,1,0] neg_hi:[0,0,0]
    v_pk_add_f32 v[26:27], v[8:9], v[32:33]
    v_pk_add_f32 v[32:33], v[8:9], v[32:33] neg_lo:[0,1] neg_hi:[0,1]
    v_pk_mul_f32 v[42:43], v[32:33], s[12:13] op_sel:[0,0] op_sel_hi:[0,1] neg_lo:[0,0] neg_hi:[0,0]
    v_pk_fma_f32 v[32:33], v[32:33], s[12:13], v[42:43] op_sel:[1,1,0] op_sel_hi:[1,0,1] neg_lo:[0,1,0] neg_hi:[0,0,0]
    v_pk_add_f32 v[8:9], v[40:41], v[12:13]
    v_pk_add_f32 v[12:13], v[40:41], v[12:13] neg_lo:[0,1] neg_hi:[0,1]
    v_pk_mul_f32 v[42:43], v[12:13], s[14:15] op_sel:[0,1] op_sel_hi:[0,0] neg_lo:[0,0] neg_hi:[0,0]
    v_pk_fma_f32 v[12:13], v[12:13], s[14:15], v[42:43] op_sel:[1,0,0] op_sel_hi:[1,1,1] neg_lo:[0,1,0] neg_hi:[0,0,0]
    v_pk_add_f32 v[40:41], v[22:23], v[16:17]
    v_pk_add_f32 v[16:17], v[22:23], v[16:17] op_sel:[1,1] op_sel_hi:[0,0] neg_lo:[1,0] neg_hi:[0,1]
    v_pk_add_f32 v[22:23], v[14:15], v[30:31]
    v_pk_add_f32 v[30:31], v[14:15], v[30:31] neg_lo:[0,1] neg_hi:[0,1]
    v_pk_mul_f32 v[42:43], v[30:31], s[14:15] op_sel:[0,1] op_sel_hi:[0,0] neg_lo:[0,1] neg_hi:[0,0]
    v_pk_fma_f32 v[30:31], v[30:31], s[14:15], v[42:43] op_sel:[1,0,0] op_sel_hi:[1,1,1] neg_lo:[0,1,0] neg_hi:[0,1,0]
    v_pk_add_f32 v[14:15], v[36:37], v[28:29]
    v_pk_add_f32 v[28:29], v[36:37], v[28:29] neg_lo:[0,1] neg_hi:[0,1]
    v_pk_mul_f32 v[42:43], v[28:29], s[12:13] op_sel:[0,0] op_sel_hi:[0,1] neg_lo:[0,1] neg_hi:[0,0]
    v_pk_fma_f32 v[28:29], v[28:29], s[12:13], v[42:43] op_sel:[1,1,0] op_sel_hi:[1,0,1] neg_lo:[0,1,0] neg_hi:[0,1,0]
    v_pk_add_f32 v[36:37], v[24:25], v[38:39]
    v_pk_add_f32 v[38:39], v[24:25], v[38:39] neg_lo:[0,1] neg_hi:[0,1]
    v_pk_mul_f32 v[42:43], v[38:39], s[14:15] op_sel:[0,0] op_sel_hi:[0,1] neg_lo:[0,1] neg_hi:[0,0]
    v_pk_fma_f32 v[38:39], v[38:39], s[14:15], v[42:43] op_sel:[1,1,0] op_sel_hi:[1,0,1] neg_lo:[0,1,0] neg_hi:[0,1,0]
    v_pk_add_f32 v[24:25], v[10:11], v[40:41]
    v_pk_add_f32 v[40:41], v[10:11], v[40:41] neg_lo:[0,1] neg_hi:[0,1]
    v_pk_add_f32 v[10:11], v[34:35], v[22:23]
    v_pk_add_f32 v[22:23], v[34:35], v[22:23] neg_lo:[0,1] neg_hi:[0,1]
    v_pk_mul_f32 v[42:43], v[22:23], s[12:13] op_sel:[0,0] op_sel_hi:[0,1] neg_lo:[0,0] neg_hi:[0,0]
    v_pk_fma_f32 v[22:23], v[22:23], s[12:13], v[42:43] op_sel:[1,1,0] op_sel_hi:[1,0,1] neg_lo:[0,1,0] neg_hi:[0,0,0]
    v_pk_add_f32 v[34:35], v[26:27], v[14:15]
    v_pk_add_f32 v[14:15], v[26:27], v[14:15] op_sel:[1,1] op_sel_hi:[0,0] neg_lo:[1,0] neg_hi:[0,1]
    v_pk_add_f32 v[26:27], v[8:9], v[36:37]
    v_pk_add_f32 v[36:37], v[8:9], v[36:37] neg_lo:[0,1] neg_hi:[0,1]
    v_pk_mul_f32 v[42:43], v[36:37], s[12:13] op_sel:[0,0] op_sel_hi:[0,1] neg_lo:[0,1] neg_hi:[0,0]
    v_pk_fma_f32 v[36:37], v[36:37], s[12:13], v[42:43] op_sel:[1,1,0] op_sel_hi:[1,0,1] neg_lo:[0,1,0] neg_hi:[0,1,0]
    v_pk_add_f32 v[8:9], v[24:25], v[34:35]
    v_pk_add_f32 v[34:35], v[24:25], v[34:35] neg_lo:[0,1] neg_hi:[0,1]
    v_pk_add_f32 v[24:25], v[10:11], v[26:27]
    v_pk_add_f32 v[26:27], v[10:11], v[26:27] op_sel:[1,1] op_sel_hi:[0,0] neg_lo:[1,0] neg_hi:[0,1]
    v_pk_add_f32 v[10:11], v[8:9], v[24:25]
    v_pk_add_f32 v[24:25], v[8:9], v[24:25] neg_lo:[0,1] neg_hi:[0,1]
    v_pk_add_f32 v[8:9], v[34:35], v[26:27]
    v_pk_add_f32 v[26:27], v[34:35], v[26:27] neg_lo:[0,1] neg_hi:[0,1]
    v_pk_add_f32 v[34:35], v[40:41], v[14:15]
    v_pk_add_f32 v[14:15], v[40:41], v[14:15] neg_lo:[0,1] neg_hi:[0,1]
    v_pk_add_f32 v[40:41], v[22:23], v[36:37]
    v_pk_add_f32 v[36:37], v[22:23], v[36:37] op_sel:[1,1] op_sel_hi:[0,0] neg_lo:[1,0] neg_hi:[0,1]
    v_pk_add_f32 v[22:23], v[34:35], v[40:41]
    v_pk_add_f32 v[40:41], v[34:35], v[40:41] neg_lo:[0,1] neg_hi:[0,1]
    v_pk_add_f32 v[34:35], v[14:15], v[36:37]
    v_pk_add_f32 v[36:37], v[14:15], v[36:37] neg_lo:[0,1] neg_hi:[0,1]
    v_pk_add_f32 v[14:15], v[18:19], v[16:17]
    v_pk_add_f32 v[16:17], v[18:19], v[16:17] neg_lo:[0,1] neg_hi:[0,1]
    v_pk_add_f32 v[18:19], v[20:21], v[30:31]
    v_pk_add_f32 v[30:31], v[20:21], v[30:31] neg_lo:[0,1] neg_hi:[0,1]
    v_pk_mul_f32 v[42:43], v[30:31], s[12:13] op_sel:[0,0] op_sel_hi:[0,1] neg_lo:[0,0] neg_hi:[0,0]
    v_pk_fma_f32 v[30:31], v[30:31], s[12:13], v[42:43] op_sel:[1,1,0] op_sel_hi:[1,0,1] neg_lo:[0,1,0] neg_hi:[0,0,0]
    v_pk_add_f32 v[20:21], v[32:33], v[28:29]
    v_pk_add_f32 v[28:29], v[32:33], v[28:29] op_sel:[1,1] op_sel_hi:[0,0] neg_lo:[1,0] neg_hi:[0,1]
    v_pk_add_f32 v[32:33], v[12:13], v[38:39]
    v_pk_add_f32 v[38:39], v[12:13], v[38:39] neg_lo:[0,1] neg_hi:[0,1]
    v_pk_mul_f32 v[42:43], v[38:39], s[12:13] op_sel:[0,0] op_sel_hi:[0,1] neg_lo:[0,1] neg_hi:[0,0]
    v_pk_fma_f32 v[38:39], v[38:39], s[12:13], v[42:43] op_sel:[1,1,0] op_sel_hi:[1,0,1] neg_lo:[0,1,0] neg_hi:[0,1,0]
    v_pk_add_f32 v[12:13], v[14:15], v[20:21]
    v_pk_add_f32 v[20:21], v[14:15], v[20:21] neg_lo:[0,1] neg_hi:[0,1]
    v_pk_add_f32 v[14:15], v[18:19], v[32:33]
    v_pk_add_f32 v[32:33], v[18:19], v[32:33] op_sel:[1,1] op_sel_hi:[0,0] neg_lo:[1,0] neg_hi:[0,1]
    v_pk_add_f32 v[18:19], v[12:13], v[14:15]
    v_pk_add_f32 v[14:15], v[12:13], v[14:15] neg_lo:[0,1] neg_hi:[0,1]
    v_pk_add_f32 v[12:13], v[20:21], v[32:33]
    v_pk_add_f32 v[32:33], v[20:21], v[32:33] neg_lo:[0,1] neg_hi:[0,1]
    v_pk_add_f32 v[20:21], v[16:17], v[28:29]
    v_pk_add_f32 v[28:29], v[16:17], v[28:29] neg_lo:[0,1] neg_hi:[0,1]
    v_pk_add_f32 v[16:17], v[30:31], v[38:39]
    v_pk_add_f32 v[38:39], v[30:31], v[38:39] op_sel:[1,1] op_sel_hi:[0,0] neg_lo:[1,0] neg_hi:[0,1]
    v_pk_add_f32 v[30:31], v[20:21], v[16:17]
    v_pk_add_f32 v[16:17], v[20:21], v[16:17] neg_lo:[0,1] neg_hi:[0,1]
    v_pk_add_f32 v[20:21], v[28:29], v[38:39]
    v_pk_add_f32 v[38:39], v[28:29], v[38:39] neg_lo:[0,1] neg_hi:[0,1]
    buffer_store_dwordx2 v[10:11], v123, s[8:11], s30 offen offset:0
    buffer_store_dwordx2 v[18:19], v123, s[8:11], s30 offen offset:1024
    buffer_store_dwordx2 v[22:23], v123, s[8:11], s30 offen offset:2048
    buffer_store_dwordx2 v[30:31], v123, s[8:11], s30 offen offset:3072
    buffer_store_dwordx2 v[8:9], v123, s[8:11], s31 offen offset:0
    buffer_store_dwordx2 v[12:13], v123, s[8:11], s31 offen offset:1024
    buffer_store_dwordx2 v[34:35], v123, s[8:11], s31 offen offset:2048
    buffer_store_dwordx2 v[20:21], v123, s[8:11], s31 offen offset:3072
    buffer_store_dwordx2 v[24:25], v123, s[8:11], s32 offen offset:0
    buffer_store_dwordx2 v[14:15], v123, s[8:11], s32 offen offset:1024
    buffer_store_dwordx2 v[40:41], v123, s[8:11], s32 offen offset:2048
    buffer_store_dwordx2 v[16:17], v123, s[8:11], s32 offen offset:3072
    buffer_store_dwordx2 v[26:27], v123, s[8:11], s33 offen offset:0
    buffer_store_dwordx2 v[32:33], v123, s[8:11], s33 offen offset:1024
    buffer_store_dwordx2 v[36:37], v123, s[8:11], s33 offen offset:2048
    buffer_store_dwordx2 v[38:39], v123, s[8:11], s33 offen offset:3072
k2_kernel_b0_end:
    s_endpgm
k2_kernel_r1:
    s_sub_u32 s2, s2, 257
    s_add_u32 s2, s2, 512
    s_load_dwordx4 s[16:19], s[0:1], 8
    s_load_dwordx4 s[20:23], s[0:1], 24
    s_load_dwordx4 s[24:27], s[0:1], 40
    s_load_dwordx2 s[28:29], s[0:1], 56
    s_load_dwordx2 s[30:31], s[0:1], 112
    v_lshrrev_b32 v3, 6, v0
    v_and_b32 v10, 127, v0
    v_readfirstlane_b32 s9, v3
    s_waitcnt lgkmcnt(0)
    s_mov_b32 s32, s16
    s_and_b32 s33, s17, 0xffff
    s_mov_b32 s34, 262144
    s_mov_b32 s35, 0x00020000
    s_mov_b32 s36, s18
    s_and_b32 s37, s19, 0xffff
    s_mov_b32 s38, 262144
    s_mov_b32 s39, 0x00020000
    s_mov_b32 s40, s20
    s_and_b32 s41, s21, 0xffff
    s_mov_b32 s42, 262144
    s_mov_b32 s43, 0x00020000
    s_mov_b32 s44, s22
    s_and_b32 s45, s23, 0xffff
    s_mov_b32 s46, 262144
    s_mov_b32 s47, 0x00020000
    s_mov_b32 s48, s24
    s_and_b32 s49, s25, 0xffff
    s_mov_b32 s50, 262144
    s_mov_b32 s51, 0x00020000
    s_mov_b32 s52, s26
    s_and_b32 s53, s27, 0xffff
    s_mov_b32 s54, 262144
    s_mov_b32 s55, 0x00020000
    s_mov_b32 s56, s28
    s_and_b32 s57, s29, 0xffff
    s_mov_b32 s58, 2048
    s_mov_b32 s59, 0x00020000
    s_add_u32 s60, s30, 25165824
    s_addc_u32 s61, s31, 0
    s_and_b32 s61, s61, 0xffff
    s_mov_b32 s62, 4259840
    s_mov_b32 s63, 0x00020000
    s_lshl_b32 s6, s2, 8
    v_lshlrev_b32 v1, 1, v10
    buffer_load_ushort v2, v1, s[32:35], s6 offen
    buffer_load_ushort v3, v1, s[36:39], s6 offen
    buffer_load_ushort v4, v1, s[40:43], s6 offen
    buffer_load_ushort v5, v1, s[44:47], s6 offen
    buffer_load_ushort v6, v1, s[48:51], s6 offen
    buffer_load_ushort v7, v1, s[52:55], s6 offen
    s_lshl_b32 s7, s2, 1
    v_mov_b32 v9, 0
    buffer_load_ushort v8, v9, s[56:59], s7 offen
    s_waitcnt vmcnt(0)
    v_lshlrev_b32 v2, 16, v2
    v_lshlrev_b32 v3, 16, v3
    v_lshlrev_b32 v4, 16, v4
    v_lshlrev_b32 v5, 16, v5
    v_lshlrev_b32 v6, 16, v6
    v_lshlrev_b32 v7, 16, v7
    v_lshlrev_b32 v8, 16, v8
    v_mul_f32 v8, 0x3fb8aa3b, v8
    v_exp_f32 v8, v8
    s_nop 0
    v_cvt_pk_bf16_f32 v8, v8, v8
    v_lshlrev_b32 v8, 16, v8
    v_mul_f32 v2, v8, v2
    v_mul_f32 v12, 0x3fb8aa3b, v2
    v_mul_f32 v3, v8, v3
    v_mul_f32 v13, 0x3e22f983, v3
    v_mul_f32 v4, v8, v4
    v_mul_f32 v5, v8, v5
    v_mul_f32 v14, v6, v4
    v_fma_f32 v14, -v7, v5, v14
    v_mul_f32 v15, v6, v5
    v_fma_f32 v15, v7, v4, v15
    v_lshlrev_b32 v1, 2, v10
    s_cmp_ge_u32 s9, 2
    s_cbranch_scc1 k2_kernel_b1_roleA
    v_mul_f32 v40, 0x3f800000, v12
    v_mul_f32 v41, 0x3f800000, v13
    v_fract_f32 v41, v41
    v_mul_f32 v44, 0x40000000, v12
    v_mul_f32 v45, 0x40000000, v13
    v_fract_f32 v45, v45
    v_mul_f32 v48, 0x40800000, v12
    v_mul_f32 v49, 0x40800000, v13
    v_fract_f32 v49, v49
    v_mul_f32 v52, 0x41000000, v12
    v_mul_f32 v53, 0x41000000, v13
    v_fract_f32 v53, v53
    v_exp_f32 v40, v40
    v_cos_f32 v42, v41
    v_sin_f32 v43, v41
    v_exp_f32 v44, v44
    v_cos_f32 v46, v45
    v_sin_f32 v47, v45
    v_exp_f32 v48, v48
    v_cos_f32 v50, v49
    v_sin_f32 v51, v49
    v_exp_f32 v52, v52
    v_cos_f32 v54, v53
    v_sin_f32 v55, v53
    v_mul_f32 v16, v40, v42
    v_mul_f32 v17, v40, v43
    v_mul_f32 v18, v44, v46
    v_mul_f32 v19, v44, v47
    v_mul_f32 v20, v48, v50
    v_mul_f32 v21, v48, v51
    v_mul_f32 v22, v52, v54
    v_mul_f32 v23, v52, v55
    v_mov_b32 v56, 0x3f80
    v_and_b32 v2, 63, v0
    v_and_b32 v4, 15, v2
    v_lshrrev_b32 v5, 4, v2
    v_mul_u32_u24 v6, 528, v4
    v_lshl_add_u32 v6, v5, 4, v6
    s_mul_i32 s10, s9, 8448
    v_add_u32 v6, s10, v6
    v_lshl_add_u32 v7, v5, 6, v4
    v_lshlrev_b32 v7, 2, v7
    ds_write_b32 v1, v56 offset:16896
    v_mov_b32 v60, v16
    v_mov_b32 v61, v17
    ds_write_b32 v1, v56 offset:25344
    v_mov_b32 v62, v18
    v_mov_b32 v63, v19
    v_cvt_pk_bf16_f32 v84, v60, v61
    ds_write_b32 v1, v84 offset:17424
    v_pk_mul_f32 v[76:77], v[60:61], v[16:17] op_sel:[0,0] op_sel_hi:[0,1] neg_hi:[0,0]
    v_pk_fma_f32 v[60:61], v[60:61], v[16:17], v[76:77] op_sel:[1,1,0] op_sel_hi:[1,0,1] neg_lo:[0,1,0]
    v_cvt_pk_bf16_f32 v85, v62, v63
    ds_write_b32 v1, v85 offset:25872
    v_pk_mul_f32 v[78:79], v[62:63], v[18:19] op_sel:[0,0] op_sel_hi:[0,1] neg_hi:[0,0]
    v_pk_fma_f32 v[62:63], v[62:63], v[18:19], v[78:79] op_sel:[1,1,0] op_sel_hi:[1,0,1] neg_lo:[0,1,0]
    v_cvt_pk_bf16_f32 v84, v60, v61
    ds_write_b32 v1, v84 offset:17952
    v_pk_mul_f32 v[76:77], v[60:61], v[16:17] op_sel:[0,0] op_sel_hi:[0,1] neg_hi:[0,0]
    v_pk_fma_f32 v[60:61], v[60:61], v[16:17], v[76:77] op_sel:[1,1,0] op_sel_hi:[1,0,1] neg_lo:[0,1,0]
    v_cvt_pk_bf16_f32 v85, v62, v63
    ds_write_b32 v1, v85 offset:26400
    v_pk_mul_f32 v[78:79], v[62:63], v[18:19] op_sel:[0,0] op_sel_hi:[0,1] neg_hi:[0,0]
    v_pk_fma_f32 v[62:63], v[62:63], v[18:19], v[78:79] op_sel:[1,1,0] op_sel_hi:[1,0,1] neg_lo:[0,1,0]
    v_cvt_pk_bf16_f32 v84, v60, v61
    ds_write_b32 v1, v84 offset:18480
    v_pk_mul_f32 v[76:77], v[60:61], v[16:17] op_sel:[0,0] op_sel_hi:[0,1] neg_hi:[0,0]
    v_pk_fma_f32 v[60:61], v[60:61], v[16:17], v[76:77] op_sel:[1,1,0] op_sel_hi:[1,0,1] neg_lo:[0,1,0]
    v_cvt_pk_bf16_f32 v85, v62, v63
    ds_write_b32 v1, v85 offset:26928
    v_pk_mul_f32 v[78:79], v[62:63], v[18:19] op_sel:[0,0] op_sel_hi:[0,1] neg_hi:[0,0]
    v_pk_fma_f32 v[62:63], v[62:63], v[18:19], v[78:79] op_sel:[1,1,0] op_sel_hi:[1,0,1] neg_lo:[0,1,0]
    v_cvt_pk_bf16_f32 v84, v60, v61
    ds_write_b32 v1, v84 offset:19008
    v_pk_mul_f32 v[76:77], v[60:61], v[16:17] op_sel:[0,0] op_sel_hi:[0,1] neg_hi:[0,0]
    v_pk_fma_f32 v[60:61], v[60:61], v[16:17], v[76:77] op_sel:[1,1,0] op_sel_hi:[1,0,1] neg_lo:[0,1,0]
    v_cvt_pk_bf16_f32 v85, v62, v63
    ds_write_b32 v1, v85 offset:27456
    v_pk_mul_f32 v[78:79], v[62:63], v[18:19] op_sel:[0,0] op_sel_hi:[0,1] neg_hi:[0,0]
    v_pk_fma_f32 v[62:63], v[62:63], v[18:19], v[78:79] op_sel:[1,1,0] op_sel_hi:[1,0,1] neg_lo:[0,1,0]
    v_cvt_pk_bf16_f32 v84, v60, v61
    ds_write_b32 v1, v84 offset:19536
    v_pk_mul_f32 v[76:77], v[60:61], v[16:17] op_sel:[0,0] op_sel_hi:[0,1] neg_hi:[0,0]
    v_pk_fma_f32 v[60:61], v[60:61], v[16:17], v[76:77] op_sel:[1,1,0] op_sel_hi:[1,0,1] neg_lo:[0,1,0]
    v_cvt_pk_bf16_f32 v85, v62, v63
    ds_write_b32 v1, v85 offset:27984
    v_pk_mul_f32 v[78:79], v[62:63], v[18:19] op_sel:[0,0] op_sel_hi:[0,1] neg_hi:[0,0]
    v_pk_fma_f32 v[62:63], v[62:63], v[18:19], v[78:79] op_sel:[1,1,0] op_sel_hi:[1,0,1] neg_lo:[0,1,0]
    v_cvt_pk_bf16_f32 v84, v60, v61
    ds_write_b32 v1, v84 offset:20064
    v_pk_mul_f32 v[76:77], v[60:61], v[16:17] op_sel:[0,0] op_sel_hi:[0,1] neg_hi:[0,0]
    v_pk_fma_f32 v[60:61], v[60:61], v[16:17], v[76:77] op_sel:[1,1,0] op_sel_hi:[1,0,1] neg_lo:[0,1,0]
    v_cvt_pk_bf16_f32 v85, v62, v63
    ds_write_b32 v1, v85 offset:28512
    v_pk_mul_f32 v[78:79], v[62:63], v[18:19] op_sel:[0,0] op_sel_hi:[0,1] neg_hi:[0,0]
    v_pk_fma_f32 v[62:63], v[62:63], v[18:19], v[78:79] op_sel:[1,1,0] op_sel_hi:[1,0,1] neg_lo:[0,1,0]
    v_cvt_pk_bf16_f32 v84, v60, v61
    ds_write_b32 v1, v84 offset:20592
    v_pk_mul_f32 v[76:77], v[60:61], v[16:17] op_sel:[0,0] op_sel_hi:[0,1] neg_hi:[0,0]
    v_pk_fma_f32 v[60:61], v[60:61], v[16:17], v[76:77] op_sel:[1,1,0] op_sel_hi:[1,0,1] neg_lo:[0,1,0]
    v_cvt_pk_bf16_f32 v85, v62, v63
    ds_write_b32 v1, v85 offset:29040
    v_pk_mul_f32 v[78:79], v[62:63], v[18:19] op_sel:[0,0] op_sel_hi:[0,1] neg_hi:[0,0]
    v_pk_fma_f32 v[62:63], v[62:63], v[18:19], v[78:79] op_sel:[1,1,0] op_sel_hi:[1,0,1] neg_lo:[0,1,0]
    v_cvt_pk_bf16_f32 v84, v60, v61
    ds_write_b32 v1, v84 offset:21120
    v_pk_mul_f32 v[76:77], v[60:61], v[16:17] op_sel:[0,0] op_sel_hi:[0,1] neg_hi:[0,0]
    v_pk_fma_f32 v[60:61], v[60:61], v[16:17], v[76:77] op_sel:[1,1,0] op_sel_hi:[1,0,1] neg_lo:[0,1,0]
    v_cvt_pk_bf16_f32 v85, v62, v63
    ds_write_b32 v1, v85 offset:29568
    v_pk_mul_f32 v[78:79], v[62:63], v[18:19] op_sel:[0,0] op_sel_hi:[0,1] neg_hi:[0,0]
    v_pk_fma_f32 v[62:63], v[62:63], v[18:19], v[78:79] op_sel:[1,1,0] op_sel_hi:[1,0,1] neg_lo:[0,1,0]
    v_cvt_pk_bf16_f32 v84, v60, v61
    ds_write_b32 v1, v84 offset:21648
    v_pk_mul_f32 v[76:77], v[60:61], v[16:17] op_sel:[0,0] op_sel_hi:[0,1] neg_hi:[0,0]
    v_pk_fma_f32 v[60:61], v[60:61], v[16:17], v[76:77] op_sel:[1,1,0] op_sel_hi:[1,0,1] neg_lo:[0,1,0]
    v_cvt_pk_bf16_f32 v85, v62, v63
    ds_write_b32 v1, v85 offset:30096
    v_pk_mul_f32 v[78:79], v[62:63], v[18:19] op_sel:[0,0] op_sel_hi:[0,1] neg_hi:[0,0]
    v_pk_fma_f32 v[62:63], v[62:63], v[18:19], v[78:79] op_sel:[1,1,0] op_sel_hi:[1,0,1] neg_lo:[0,1,0]
    v_cvt_pk_bf16_f32 v84, v60, v61
    ds_write_b32 v1, v84 offset:22176
    v_pk_mul_f32 v[76:77], v[60:61], v[16:17] op_sel:[0,0] op_sel_hi:[0,1] neg_hi:[0,0]
    v_pk_fma_f32 v[60:61], v[60:61], v[16:17], v[76:77] op_sel:[1,1,0] op_sel_hi:[1,0,1] neg_lo:[0,1,0]
    v_cvt_pk_bf16_f32 v85, v62, v63
    ds_write_b32 v1, v85 offset:30624
    v_pk_mul_f32 v[78:79], v[62:63], v[18:19] op_sel:[0,0] op_sel_hi:[0,1] neg_hi:[0,0]
    v_pk_fma_f32 v[62:63], v[62:63], v[18:19], v[78:79] op_sel:[1,1,0] op_sel_hi:[1,0,1] neg_lo:[0,1,0]
    v_cvt_pk_bf16_f32 v84, v60, v61
    ds_write_b32 v1, v84 offset:22704
    v_pk_mul_f32 v[76:77], v[60:61], v[16:17] op_sel:[0,0] op_sel_hi:[0,1] neg_hi:[0,0]
    v_pk_fma_f32 v[60:61], v[60:61], v[16:17], v[76:77] op_sel:[1,1,0] op_sel_hi:[1,0,1] neg_lo:[0,1,0]
    v_cvt_pk_bf16_f32 v85, v62, v63
    ds_write_b32 v1, v85 offset:31152
    v_pk_mul_f32 v[78:79], v[62:63], v[18:19] op_sel:[0,0] op_sel_hi:[0,1] neg_hi:[0,0]
    v_pk_fma_f32 v[62:63], v[62:63], v[18:19], v[78:79] op_sel:[1,1,0] op_sel_hi:[1,0,1] neg_lo:[0,1,0]
    v_cvt_pk_bf16_f32 v84, v60, v61
    ds_write_b32 v1, v84 offset:23232
    v_pk_mul_f32 v[76:77], v[60:61], v[16:17] op_sel:[0,0] op_sel_hi:[0,1] neg_hi:[0,0]
    v_pk_fma_f32 v[60:61], v[60:61], v[16:17], v[76:77] op_sel:[1,1,0] op_sel_hi:[1,0,1] neg_lo:[0,1,0]
    v_cvt_pk_bf16_f32 v85, v62, v63
    ds_write_b32 v1, v85 offset:31680
    v_pk_mul_f32 v[78:79], v[62:63], v[18:19] op_sel:[0,0] op_sel_hi:[0,1] neg_hi:[0,0]
    v_pk_fma_f32 v[62:63], v[62:63], v[18:19], v[78:79] op_sel:[1,1,0] op_sel_hi:[1,0,1] neg_lo:[0,1,0]
    v_cvt_pk_bf16_f32 v84, v60, v61
    ds_write_b32 v1, v84 offset:23760
    v_pk_mul_f32 v[76:77], v[60:61], v[16:17] op_sel:[0,0] op_sel_hi:[0,1] neg_hi:[0,0]
    v_pk_fma_f32 v[60:61], v[60:61], v[16:17], v[76:77] op_sel:[1,1,0] op_sel_hi:[1,0,1] neg_lo:[0,1,0]
    v_cvt_pk_bf16_f32 v85, v62, v63
    ds_write_b32 v1, v85 offset:32208
    v_pk_mul_f32 v[78:79], v[62:63], v[18:19] op_sel:[0,0] op_sel_hi:[0,1] neg_hi:[0,0]
    v_pk_fma_f32 v[62:63], v[62:63], v[18:19], v[78:79] op_sel:[1,1,0] op_sel_hi:[1,0,1] neg_lo:[0,1,0]
    v_cvt_pk_bf16_f32 v84, v60, v61
    ds_write_b32 v1, v84 offset:24288
    v_pk_mul_f32 v[76:77], v[60:61], v[16:17] op_sel:[0,0] op_sel_hi:[0,1] neg_hi:[0,0]
    v_pk_fma_f32 v[60:61], v[60:61], v[16:17], v[76:77] op_sel:[1,1,0] op_sel_hi:[1,0,1] neg_lo:[0,1,0]
    v_cvt_pk_bf16_f32 v85, v62, v63
    ds_write_b32 v1, v85 offset:32736
    v_pk_mul_f32 v[78:79], v[62:63], v[18:19] op_sel:[0,0] op_sel_hi:[0,1] neg_hi:[0,0]
    v_pk_fma_f32 v[62:63], v[62:63], v[18:19], v[78:79] op_sel:[1,1,0] op_sel_hi:[1,0,1] neg_lo:[0,1,0]
    v_cvt_pk_bf16_f32 v84, v60, v61
    ds_write_b32 v1, v84 offset:24816
    v_cvt_pk_bf16_f32 v85, v62, v63
    ds_write_b32 v1, v85 offset:33264
    s_waitcnt lgkmcnt(0)
    s_barrier
    v_mov_b32 v8, 0
    v_mov_b32 v9, 0
    v_mov_b32 v10, 0
    v_mov_b32 v11, 0
    ds_read_b128 v[88:91], v6 offset:0
    ds_read_b128 v[92:95], v6 offset:16896
    ds_read_b128 v[96:99], v6 offset:64
    ds_read_b128 v[100:103], v6 offset:16960
    ds_read_b128 v[104:107], v6 offset:128
    ds_read_b128 v[108:111], v6 offset:17024
    ds_read_b128 v[112:115], v6 offset:192
    ds_read_b128 v[116:119], v6 offset:17088
    s_waitcnt lgkmcnt(0)
    v_mfma_f32_16x16x32_bf16 v[8:11], v[88:91], v[92:95], v[8:11]
    v_mfma_f32_16x16x32_bf16 v[8:11], v[96:99], v[100:103], v[8:11]
    v_mfma_f32_16x16x32_bf16 v[8:11], v[104:107], v[108:111], v[8:11]
    v_mfma_f32_16x16x32_bf16 v[8:11], v[112:115], v[116:119], v[8:11]
    ds_read_b128 v[88:91], v6 offset:256
    ds_read_b128 v[92:95], v6 offset:17152
    ds_read_b128 v[96:99], v6 offset:320
    ds_read_b128 v[100:103], v6 offset:17216
    ds_read_b128 v[104:107], v6 offset:384
    ds_read_b128 v[108:111], v6 offset:17280
    ds_read_b128 v[112:115], v6 offset:448
    ds_read_b128 v[116:119], v6 offset:17344
    s_waitcnt lgkmcnt(0)
    v_mfma_f32_16x16x32_bf16 v[8:11], v[88:91], v[92:95], v[8:11]
    v_mfma_f32_16x16x32_bf16 v[8:11], v[96:99], v[100:103], v[8:11]
    v_mfma_f32_16x16x32_bf16 v[8:11], v[104:107], v[108:111], v[8:11]
    v_mfma_f32_16x16x32_bf16 v[8:11], v[112:115], v[116:119], v[8:11]
    s_cmp_eq_u32 s9, 1
    s_cbranch_scc1 k2_kernel_b1_k0w1
    s_nop 5
    ds_write_b32 v7, v8 offset:33792
    ds_write_b32 v7, v9 offset:33856
    ds_write_b32 v7, v10 offset:33920
    ds_write_b32 v7, v11 offset:33984
    s_branch k2_kernel_b1_k0d
k2_kernel_b1_k0w1:
    s_nop 7
    v_cmp_gt_u32 vcc, 2, v5
    s_and_saveexec_b64 s[4:5], vcc
    ds_write_b32 v7, v8 offset:34816
    ds_write_b32 v7, v9 offset:34880
    ds_write_b32 v7, v10 offset:34944
    ds_write_b32 v7, v11 offset:35008
    s_mov_b64 exec, s[4:5]
k2_kernel_b1_k0d:
    s_waitcnt lgkmcnt(0)
    s_barrier
    ds_write_b32 v1, v56 offset:16896
    v_mov_b32 v60, v20
    v_mov_b32 v61, v21
    ds_write_b32 v1, v56 offset:25344
    v_mov_b32 v62, v22
    v_mov_b32 v63, v23
    v_cvt_pk_bf16_f32 v84, v60, v61
    ds_write_b32 v1, v84 offset:17424
    v_pk_mul_f32 v[76:77], v[60:61], v[20:21] op_sel:[0,0] op_sel_hi:[0,1] neg_hi:[0,0]
    v_pk_fma_f32 v[60:61], v[60:61], v[20:21], v[76:77] op_sel:[1,1,0] op_sel_hi:[1,0,1] neg_lo:[0,1,0]
    v_cvt_pk_bf16_f32 v85, v62, v63
    ds_write_b32 v1, v85 offset:25872
    v_pk_mul_f32 v[78:79], v[62:63], v[22:23] op_sel:[0,0] op_sel_hi:[0,1] neg_hi:[0,0]
    v_pk_fma_f32 v[62:63], v[62:63], v[22:23], v[78:79] op_sel:[1,1,0] op_sel_hi:[1,0,1] neg_lo:[0,1,0]
    v_cvt_pk_bf16_f32 v84, v60, v61
    ds_write_b32 v1, v84 offset:17952
    v_pk_mul_f32 v[76:77], v[60:61], v[20:21] op_sel:[0,0] op_sel_hi:[0,1] neg_hi:[0,0]
    v_pk_fma_f32 v[60:61], v[60:61], v[20:21], v[76:77] op_sel:[1,1,0] op_sel_hi:[1,0,1] neg_lo:[0,1,0]
    v_cvt_pk_bf16_f32 v85, v62, v63
    ds_write_b32 v1, v85 offset:26400
    v_pk_mul_f32 v[78:79], v[62:63], v[22:23] op_sel:[0,0] op_sel_hi:[0,1] neg_hi:[0,0]
    v_pk_fma_f32 v[62:63], v[62:63], v[22:23], v[78:79] op_sel:[1,1,0] op_sel_hi:[1,0,1] neg_lo:[0,1,0]
    v_cvt_pk_bf16_f32 v84, v60, v61
    ds_write_b32 v1, v84 offset:18480
    v_pk_mul_f32 v[76:77], v[60:61], v[20:21] op_sel:[0,0] op_sel_hi:[0,1] neg_hi:[0,0]
    v_pk_fma_f32 v[60:61], v[60:61], v[20:21], v[76:77] op_sel:[1,1,0] op_sel_hi:[1,0,1] neg_lo:[0,1,0]
    v_cvt_pk_bf16_f32 v85, v62, v63
    ds_write_b32 v1, v85 offset:26928
    v_pk_mul_f32 v[78:79], v[62:63], v[22:23] op_sel:[0,0] op_sel_hi:[0,1] neg_hi:[0,0]
    v_pk_fma_f32 v[62:63], v[62:63], v[22:23], v[78:79] op_sel:[1,1,0] op_sel_hi:[1,0,1] neg_lo:[0,1,0]
    v_cvt_pk_bf16_f32 v84, v60, v61
    ds_write_b32 v1, v84 offset:19008
    v_pk_mul_f32 v[76:77], v[60:61], v[20:21] op_sel:[0,0] op_sel_hi:[0,1] neg_hi:[0,0]
    v_pk_fma_f32 v[60:61], v[60:61], v[20:21], v[76:77] op_sel:[1,1,0] op_sel_hi:[1,0,1] neg_lo:[0,1,0]
    v_cvt_pk_bf16_f32 v85, v62, v63
    ds_write_b32 v1, v85 offset:27456
    v_pk_mul_f32 v[78:79], v[62:63], v[22:23] op_sel:[0,0] op_sel_hi:[0,1] neg_hi:[0,0]
    v_pk_fma_f32 v[62:63], v[62:63], v[22:23], v[78:79] op_sel:[1,1,0] op_sel_hi:[1,0,1] neg_lo:[0,1,0]
    v_cvt_pk_bf16_f32 v84, v60, v61
    ds_write_b32 v1, v84 offset:19536
    v_pk_mul_f32 v[76:77], v[60:61], v[20:21] op_sel:[0,0] op_sel_hi:[0,1] neg_hi:[0,0]
    v_pk_fma_f32 v[60:61], v[60:61], v[20:21], v[76:77] op_sel:[1,1,0] op_sel_hi:[1,0,1] neg_lo:[0,1,0]
    v_cvt_pk_bf16_f32 v85, v62, v63
    ds_write_b32 v1, v85 offset:27984
    v_pk_mul_f32 v[78:79], v[62:63], v[22:23] op_sel:[0,0] op_sel_hi:[0,1] neg_hi:[0,0]
    v_pk_fma_f32 v[62:63], v[62:63], v[22:23], v[78:79] op_sel:[1,1,0] op_sel_hi:[1,0,1] neg_lo:[0,1,0]
    v_cvt_pk_bf16_f32 v84, v60, v61
    ds_write_b32 v1, v84 offset:20064
    v_pk_mul_f32 v[76:77], v[60:61], v[20:21] op_sel:[0,0] op_sel_hi:[0,1] neg_hi:[0,0]
    v_pk_fma_f32 v[60:61], v[60:61], v[20:21], v[76:77] op_sel:[1,1,0] op_sel_hi:[1,0,1] neg_lo:[0,1,0]
    v_cvt_pk_bf16_f32 v85, v62, v63
    ds_write_b32 v1, v85 offset:28512
    v_pk_mul_f32 v[78:79], v[62:63], v[22:23] op_sel:[0,0] op_sel_hi:[0,1] neg_hi:[0,0]
    v_pk_fma_f32 v[62:63], v[62:63], v[22:23], v[78:79] op_sel:[1,1,0] op_sel_hi:[1,0,1] neg_lo:[0,1,0]
    v_cvt_pk_bf16_f32 v84, v60, v61
    ds_write_b32 v1, v84 offset:20592
    v_pk_mul_f32 v[76:77], v[60:61], v[20:21] op_sel:[0,0] op_sel_hi:[0,1] neg_hi:[0,0]
    v_pk_fma_f32 v[60:61], v[60:61], v[20:21], v[76:77] op_sel:[1,1,0] op_sel_hi:[1,0,1] neg_lo:[0,1,0]
    v_cvt_pk_bf16_f32 v85, v62, v63
    ds_write_b32 v1, v85 offset:29040
    v_pk_mul_f32 v[78:79], v[62:63], v[22:23] op_sel:[0,0] op_sel_hi:[0,1] neg_hi:[0,0]
    v_pk_fma_f32 v[62:63], v[62:63], v[22:23], v[78:79] op_sel:[1,1,0] op_sel_hi:[1,0,1] neg_lo:[0,1,0]
    v_cvt_pk_bf16_f32 v84, v60, v61
    ds_write_b32 v1, v84 offset:21120
    v_pk_mul_f32 v[76:77], v[60:61], v[20:21] op_sel:[0,0] op_sel_hi:[0,1] neg_hi:[0,0]
    v_pk_fma_f32 v[60:61], v[60:61], v[20:21], v[76:77] op_sel:[1,1,0] op_sel_hi:[1,0,1] neg_lo:[0,1,0]
    v_cvt_pk_bf16_f32 v85, v62, v63
    ds_write_b32 v1, v85 offset:29568
    v_pk_mul_f32 v[78:79], v[62:63], v[22:23] op_sel:[0,0] op_sel_hi:[0,1] neg_hi:[0,0]
    v_pk_fma_f32 v[62:63], v[62:63], v[22:23], v[78:79] op_sel:[1,1,0] op_sel_hi:[1,0,1] neg_lo:[0,1,0]
    v_cvt_pk_bf16_f32 v84, v60, v61
    ds_write_b32 v1, v84 offset:21648
    v_pk_mul_f32 v[76:77], v[60:61], v[20:21] op_sel:[0,0] op_sel_hi:[0,1] neg_hi:[0,0]
    v_pk_fma_f32 v[60:61], v[60:61], v[20:21], v[76:77] op_sel:[1,1,0] op_sel_hi:[1,0,1] neg_lo:[0,1,0]
    v_cvt_pk_bf16_f32 v85, v62, v63
    ds_write_b32 v1, v85 offset:30096
    v_pk_mul_f32 v[78:79], v[62:63], v[22:23] op_sel:[0,0] op_sel_hi:[0,1] neg_hi:[0,0]
    v_pk_fma_f32 v[62:63], v[62:63], v[22:23], v[78:79] op_sel:[1,1,0] op_sel_hi:[1,0,1] neg_lo:[0,1,0]
    v_cvt_pk_bf16_f32 v84, v60, v61
    ds_write_b32 v1, v84 offset:22176
    v_pk_mul_f32 v[76:77], v[60:61], v[20:21] op_sel:[0,0] op_sel_hi:[0,1] neg_hi:[0,0]
    v_pk_fma_f32 v[60:61], v[60:61], v[20:21], v[76:77] op_sel:[1,1,0] op_sel_hi:[1,0,1] neg_lo:[0,1,0]
    v_cvt_pk_bf16_f32 v85, v62, v63
    ds_write_b32 v1, v85 offset:30624
    v_pk_mul_f32 v[78:79], v[62:63], v[22:23] op_sel:[0,0] op_sel_hi:[0,1] neg_hi:[0,0]
    v_pk_fma_f32 v[62:63], v[62:63], v[22:23], v[78:79] op_sel:[1,1,0] op_sel_hi:[1,0,1] neg_lo:[0,1,0]
    v_cvt_pk_bf16_f32 v84, v60, v61
    ds_write_b32 v1, v84 offset:22704
    v_pk_mul_f32 v[76:77], v[60:61], v[20:21] op_sel:[0,0] op_sel_hi:[0,1] neg_hi:[0,0]
    v_pk_fma_f32 v[60:61], v[60:61], v[20:21], v[76:77] op_sel:[1,1,0] op_sel_hi:[1,0,1] neg_lo:[0,1,0]
    v_cvt_pk_bf16_f32 v85, v62, v63
    ds_write_b32 v1, v85 offset:31152
    v_pk_mul_f32 v[78:79], v[62:63], v[22:23] op_sel:[0,0] op_sel_hi:[0,1] neg_hi:[0,0]
    v_pk_fma_f32 v[62:63], v[62:63], v[22:23], v[78:79] op_sel:[1,1,0] op_sel_hi:[1,0,1] neg_lo:[0,1,0]
    v_cvt_pk_bf16_f32 v84, v60, v61
    ds_write_b32 v1, v84 offset:23232
    v_pk_mul_f32 v[76:77], v[60:61], v[20:21] op_sel:[0,0] op_sel_hi:[0,1] neg_hi:[0,0]
    v_pk_fma_f32 v[60:61], v[60:61], v[20:21], v[76:77] op_sel:[1,1,0] op_sel_hi:[1,0,1] neg_lo:[0,1,0]
    v_cvt_pk_bf16_f32 v85, v62, v63
    ds_write_b32 v1, v85 offset:31680
    v_pk_mul_f32 v[78:79], v[62:63], v[22:23] op_sel:[0,0] op_sel_hi:[0,1] neg_hi:[0,0]
    v_pk_fma_f32 v[62:63], v[62:63], v[22:23], v[78:79] op_sel:[1,1,0] op_sel_hi:[1,0,1] neg_lo:[0,1,0]
    v_cvt_pk_bf16_f32 v84, v60, v61
    ds_write_b32 v1, v84 offset:23760
    v_pk_mul_f32 v[76:77], v[60:61], v[20:21] op_sel:[0,0] op_sel_hi:[0,1] neg_hi:[0,0]
    v_pk_fma_f32 v[60:61], v[60:61], v[20:21], v[76:77] op_sel:[1,1,0] op_sel_hi:[1,0,1] neg_lo:[0,1,0]
    v_cvt_pk_bf16_f32 v85, v62, v63
    ds_write_b32 v1, v85 offset:32208
    v_pk_mul_f32 v[78:79], v[62:63], v[22:23] op_sel:[0,0] op_sel_hi:[0,1] neg_hi:[0,0]
    v_pk_fma_f32 v[62:63], v[62:63], v[22:23], v[78:79] op_sel:[1,1,0] op_sel_hi:[1,0,1] neg_lo:[0,1,0]
    v_cvt_pk_bf16_f32 v84, v60, v61
    ds_write_b32 v1, v84 offset:24288
    v_pk_mul_f32 v[76:77], v[60:61], v[20:21] op_sel:[0,0] op_sel_hi:[0,1] neg_hi:[0,0]
    v_pk_fma_f32 v[60:61], v[60:61], v[20:21], v[76:77] op_sel:[1,1,0] op_sel_hi:[1,0,1] neg_lo:[0,1,0]
    v_cvt_pk_bf16_f32 v85, v62, v63
    ds_write_b32 v1, v85 offset:32736
    v_pk_mul_f32 v[78:79], v[62:63], v[22:23] op_sel:[0,0] op_sel_hi:[0,1] neg_hi:[0,0]
    v_pk_fma_f32 v[62:63], v[62:63], v[22:23], v[78:79] op_sel:[1,1,0] op_sel_hi:[1,0,1] neg_lo:[0,1,0]
    v_cvt_pk_bf16_f32 v84, v60, v61
    ds_write_b32 v1, v84 offset:24816
    v_cvt_pk_bf16_f32 v85, v62, v63
    ds_write_b32 v1, v85 offset:33264
    s_waitcnt lgkmcnt(0)
    s_barrier
    v_mov_b32 v8, 0
    v_mov_b32 v9, 0
    v_mov_b32 v10, 0
    v_mov_b32 v11, 0
    ds_read_b128 v[88:91], v6 offset:0
    ds_read_b128 v[92:95], v6 offset:16896
    ds_read_b128 v[96:99], v6 offset:64
    ds_read_b128 v[100:103], v6 offset:16960
    ds_read_b128 v[104:107], v6 offset:128
    ds_read_b128 v[108:111], v6 offset:17024
    ds_read_b128 v[112:115], v6 offset:192
    ds_read_b128 v[116:119], v6 offset:17088
    s_waitcnt lgkmcnt(0)
    v_mfma_f32_16x16x32_bf16 v[8:11], v[88:91], v[92:95], v[8:11]
    v_mfma_f32_16x16x32_bf16 v[8:11], v[96:99], v[100:103], v[8:11]
    v_mfma_f32_16x16x32_bf16 v[8:11], v[104:107], v[108:111], v[8:11]
    v_mfma_f32_16x16x32_bf16 v[8:11], v[112:115], v[116:119], v[8:11]
    ds_read_b128 v[88:91], v6 offset:256
    ds_read_b128 v[92:95], v6 offset:17152
    ds_read_b128 v[96:99], v6 offset:320
    ds_read_b128 v[100:103], v6 offset:17216
    ds_read_b128 v[104:107], v6 offset:384
    ds_read_b128 v[108:111], v6 offset:17280
    ds_read_b128 v[112:115], v6 offset:448
    ds_read_b128 v[116:119], v6 offset:17344
    s_waitcnt lgkmcnt(0)
    v_mfma_f32_16x16x32_bf16 v[8:11], v[88:91], v[92:95], v[8:11]
    v_mfma_f32_16x16x32_bf16 v[8:11], v[96:99], v[100:103], v[8:11]
    v_mfma_f32_16x16x32_bf16 v[8:11], v[104:107], v[108:111], v[8:11]
    v_mfma_f32_16x16x32_bf16 v[8:11], v[112:115], v[116:119], v[8:11]
    s_cmp_eq_u32 s9, 1
    s_cbranch_scc1 k2_kernel_b1_k1w1
    v_cmp_gt_u32 vcc, 2, v5
    s_and_saveexec_b64 s[4:5], vcc
    s_nop 3
    ds_write_b32 v7, v8 offset:35328
    ds_write_b32 v7, v9 offset:35392
    ds_write_b32 v7, v10 offset:35456
    ds_write_b32 v7, v11 offset:35520
    s_mov_b64 exec, s[4:5]
    s_branch k2_kernel_b1_k1d
k2_kernel_b1_k1w1:
    s_nop 7
    v_cmp_gt_u32 vcc, 2, v5
    s_and_saveexec_b64 s[4:5], vcc
    ds_write_b32 v7, v8 offset:35840
    ds_write_b32 v7, v9 offset:35904
    ds_write_b32 v7, v10 offset:35968
    ds_write_b32 v7, v11 offset:36032
    s_mov_b64 exec, s[4:5]
    v_cmp_eq_u32 vcc, 32, v2
    s_and_saveexec_b64 s[4:5], vcc
    ds_write_b32 v7, v8 offset:35840
    s_mov_b64 exec, s[4:5]
k2_kernel_b1_k1d:
    s_waitcnt lgkmcnt(0)
    s_barrier
    s_branch k2_kernel_b1_expand
k2_kernel_b1_roleA:
    v_mul_f32 v40, 0x41800000, v12
    v_mul_f32 v41, 0x41800000, v13
    v_fract_f32 v41, v41
    v_mul_f32 v44, 0x42000000, v12
    v_mul_f32 v45, 0x42000000, v13
    v_fract_f32 v45, v45
    v_mul_f32 v48, 0x42800000, v12
    v_mul_f32 v49, 0x42800000, v13
    v_fract_f32 v49, v49
    v_mul_f32 v52, 0x43000000, v12
    v_mul_f32 v53, 0x43000000, v13
    v_fract_f32 v53, v53
    v_exp_f32 v40, v40
    v_cos_f32 v42, v41
    v_sin_f32 v43, v41
    v_exp_f32 v44, v44
    v_cos_f32 v46, v45
    v_sin_f32 v47, v45
    v_exp_f32 v48, v48
    v_cos_f32 v50, v49
    v_sin_f32 v51, v49
    v_exp_f32 v52, v52
    v_cos_f32 v54, v53
    v_sin_f32 v55, v53
    v_mul_f32 v24, v40, v42
    v_mul_f32 v25, v40, v43
    v_mul_f32 v26, v44, v46
    v_mul_f32 v27, v44, v47
    v_mul_f32 v28, v48, v50
    v_mul_f32 v29, v48, v51
    v_mul_f32 v30, v52, v54
    v_mul_f32 v31, v52, v55
    v_mul_f32 v40, 0x43800000, v12
    v_mul_f32 v41, 0x43800000, v13
    v_fract_f32 v41, v41
    v_mul_f32 v44, 0x44000000, v12
    v_mul_f32 v45, 0x44000000, v13
    v_fract_f32 v45, v45
    v_mul_f32 v48, 0x44800000, v12
    v_mul_f32 v49, 0x44800000, v13
    v_fract_f32 v49, v49
    v_exp_f32 v40, v40
    v_cos_f32 v42, v41
    v_sin_f32 v43, v41
    v_exp_f32 v44, v44
    v_cos_f32 v46, v45
    v_sin_f32 v47, v45
    v_exp_f32 v48, v48
    v_cos_f32 v50, v49
    v_sin_f32 v51, v49
    v_mul_f32 v32, v40, v42
    v_mul_f32 v33, v40, v43
    v_mul_f32 v34, v44, v46
    v_mul_f32 v35, v44, v47
    v_mul_f32 v36, v48, v50
    v_mul_f32 v37, v48, v51
    v_mov_b32 v60, v14
    v_mov_b32 v61, v15
    v_pk_mul_f32 v[78:79], v[14:15], v[32:33] op_sel:[0,0] op_sel_hi:[0,1] neg_hi:[0,0]
    v_pk_fma_f32 v[62:63], v[14:15], v[32:33], v[78:79] op_sel:[1,1,0] op_sel_hi:[1,0,1] neg_lo:[0,1,0]
    v_cvt_pk_bf16_f32 v84, v60, -v61
    ds_write_b32 v1, v84 offset:0
    v_pk_mul_f32 v[76:77], v[60:61], v[24:25] op_sel:[0,0] op_sel_hi:[0,1] neg_hi:[0,0]
    v_pk_fma_f32 v[60:61], v[60:61], v[24:25], v[76:77] op_sel:[1,1,0] op_sel_hi:[1,0,1] neg_lo:[0,1,0]
    v_cvt_pk_bf16_f32 v85, v62, -v63
    ds_write_b32 v1, v85 offset:8448
    v_pk_mul_f32 v[78:79], v[62:63], v[26:27] op_sel:[0,0] op_sel_hi:[0,1] neg_hi:[0,0]
    v_pk_fma_f32 v[62:63], v[62:63], v[26:27], v[78:79] op_sel:[1,1,0] op_sel_hi:[1,0,1] neg_lo:[0,1,0]
    v_cvt_pk_bf16_f32 v84, v60, -v61
    ds_write_b32 v1, v84 offset:528
    v_pk_mul_f32 v[76:77], v[60:61], v[24:25] op_sel:[0,0] op_sel_hi:[0,1] neg_hi:[0,0]
    v_pk_fma_f32 v[60:61], v[60:61], v[24:25], v[76:77] op_sel:[1,1,0] op_sel_hi:[1,0,1] neg_lo:[0,1,0]
    v_cvt_pk_bf16_f32 v85, v62, -v63
    ds_write_b32 v1, v85 offset:8976
    v_pk_mul_f32 v[78:79], v[62:63], v[26:27] op_sel:[0,0] op_sel_hi:[0,1] neg_hi:[0,0]
    v_pk_fma_f32 v[62:63], v[62:63], v[26:27], v[78:79] op_sel:[1,1,0] op_sel_hi:[1,0,1] neg_lo:[0,1,0]
    v_cvt_pk_bf16_f32 v84, v60, -v61
    ds_write_b32 v1, v84 offset:1056
    v_pk_mul_f32 v[76:77], v[60:61], v[24:25] op_sel:[0,0] op_sel_hi:[0,1] neg_hi:[0,0]
    v_pk_fma_f32 v[60:61], v[60:61], v[24:25], v[76:77] op_sel:[1,1,0] op_sel_hi:[1,0,1] neg_lo:[0,1,0]
    v_cvt_pk_bf16_f32 v85, v62, -v63
    ds_write_b32 v1, v85 offset:9504
    v_pk_mul_f32 v[78:79], v[62:63], v[26:27] op_sel:[0,0] op_sel_hi:[0,1] neg_hi:[0,0]
    v_pk_fma_f32 v[62:63], v[62:63], v[26:27], v[78:79] op_sel:[1,1,0] op_sel_hi:[1,0,1] neg_lo:[0,1,0]
    v_cvt_pk_bf16_f32 v84, v60, -v61
    ds_write_b32 v1, v84 offset:1584
    v_pk_mul_f32 v[76:77], v[60:61], v[24:25] op_sel:[0,0] op_sel_hi:[0,1] neg_hi:[0,0]
    v_pk_fma_f32 v[60:61], v[60:61], v[24:25], v[76:77] op_sel:[1,1,0] op_sel_hi:[1,0,1] neg_lo:[0,1,0]
    v_cvt_pk_bf16_f32 v85, v62, -v63
    ds_write_b32 v1, v85 offset:10032
    v_pk_mul_f32 v[78:79], v[62:63], v[26:27] op_sel:[0,0] op_sel_hi:[0,1] neg_hi:[0,0]
    v_pk_fma_f32 v[62:63], v[62:63], v[26:27], v[78:79] op_sel:[1,1,0] op_sel_hi:[1,0,1] neg_lo:[0,1,0]
    v_cvt_pk_bf16_f32 v84, v60, -v61
    ds_write_b32 v1, v84 offset:2112
    v_pk_mul_f32 v[76:77], v[60:61], v[24:25] op_sel:[0,0] op_sel_hi:[0,1] neg_hi:[0,0]
    v_pk_fma_f32 v[60:61], v[60:61], v[24:25], v[76:77] op_sel:[1,1,0] op_sel_hi:[1,0,1] neg_lo:[0,1,0]
    v_cvt_pk_bf16_f32 v85, v62, -v63
    ds_write_b32 v1, v85 offset:10560
    v_pk_mul_f32 v[78:79], v[62:63], v[26:27] op_sel:[0,0] op_sel_hi:[0,1] neg_hi:[0,0]
    v_pk_fma_f32 v[62:63], v[62:63], v[26:27], v[78:79] op_sel:[1,1,0] op_sel_hi:[1,0,1] neg_lo:[0,1,0]
    v_cvt_pk_bf16_f32 v84, v60, -v61
    ds_write_b32 v1, v84 offset:2640
    v_pk_mul_f32 v[76:77], v[60:61], v[24:25] op_sel:[0,0] op_sel_hi:[0,1] neg_hi:[0,0]
    v_pk_fma_f32 v[60:61], v[60:61], v[24:25], v[76:77] op_sel:[1,1,0] op_sel_hi:[1,0,1] neg_lo:[0,1,0]
    v_cvt_pk_bf16_f32 v85, v62, -v63
    ds_write_b32 v1, v85 offset:11088
    v_pk_mul_f32 v[78:79], v[62:63], v[26:27] op_sel:[0,0] op_sel_hi:[0,1] neg_hi:[0,0]
    v_pk_fma_f32 v[62:63], v[62:63], v[26:27], v[78:79] op_sel:[1,1,0] op_sel_hi:[1,0,1] neg_lo:[0,1,0]
    v_cvt_pk_bf16_f32 v84, v60, -v61
    ds_write_b32 v1, v84 offset:3168
    v_pk_mul_f32 v[76:77], v[60:61], v[24:25] op_sel:[0,0] op_sel_hi:[0,1] neg_hi:[0,0]
    v_pk_fma_f32 v[60:61], v[60:61], v[24:25], v[76:77] op_sel:[1,1,0] op_sel_hi:[1,0,1] neg_lo:[0,1,0]
    v_cvt_pk_bf16_f32 v85, v62, -v63
    ds_write_b32 v1, v85 offset:11616
    v_pk_mul_f32 v[78:79], v[62:63], v[26:27] op_sel:[0,0] op_sel_hi:[0,1] neg_hi:[0,0]
    v_pk_fma_f32 v[62:63], v[62:63], v[26:27], v[78:79] op_sel:[1,1,0] op_sel_hi:[1,0,1] neg_lo:[0,1,0]
    v_cvt_pk_bf16_f32 v84, v60, -v61
    ds_write_b32 v1, v84 offset:3696
    v_pk_mul_f32 v[76:77], v[60:61], v[24:25] op_sel:[0,0] op_sel_hi:[0,1] neg_hi:[0,0]
    v_pk_fma_f32 v[60:61], v[60:61], v[24:25], v[76:77] op_sel:[1,1,0] op_sel_hi:[1,0,1] neg_lo:[0,1,0]
    v_cvt_pk_bf16_f32 v85, v62, -v63
    ds_write_b32 v1, v85 offset:12144
    v_cvt_pk_bf16_f32 v84, v60, -v61
    ds_write_b32 v1, v84 offset:4224
    v_pk_mul_f32 v[76:77], v[60:61], v[24:25] op_sel:[0,0] op_sel_hi:[0,1] neg_hi:[0,0]
    v_pk_fma_f32 v[60:61], v[60:61], v[24:25], v[76:77] op_sel:[1,1,0] op_sel_hi:[1,0,1] neg_lo:[0,1,0]
    v_cvt_pk_bf16_f32 v84, v60, -v61
    ds_write_b32 v1, v84 offset:4752
    v_pk_mul_f32 v[76:77], v[60:61], v[24:25] op_sel:[0,0] op_sel_hi:[0,1] neg_hi:[0,0]
    v_pk_fma_f32 v[60:61], v[60:61], v[24:25], v[76:77] op_sel:[1,1,0] op_sel_hi:[1,0,1] neg_lo:[0,1,0]
    v_cvt_pk_bf16_f32 v84, v60, -v61
    ds_write_b32 v1, v84 offset:5280
    v_pk_mul_f32 v[76:77], v[60:61], v[24:25] op_sel:[0,0] op_sel_hi:[0,1] neg_hi:[0,0]
    v_pk_fma_f32 v[60:61], v[60:61], v[24:25], v[76:77] op_sel:[1,1,0] op_sel_hi:[1,0,1] neg_lo:[0,1,0]
    v_cvt_pk_bf16_f32 v84, v60, -v61
    ds_write_b32 v1, v84 offset:5808
    v_pk_mul_f32 v[76:77], v[60:61], v[24:25] op_sel:[0,0] op_sel_hi:[0,1] neg_hi:[0,0]
    v_pk_fma_f32 v[60:61], v[60:61], v[24:25], v[76:77] op_sel:[1,1,0] op_sel_hi:[1,0,1] neg_lo:[0,1,0]
    v_cvt_pk_bf16_f32 v84, v60, -v61
    ds_write_b32 v1, v84 offset:6336
    v_pk_mul_f32 v[76:77], v[60:61], v[24:25] op_sel:[0,0] op_sel_hi:[0,1] neg_hi:[0,0]
    v_pk_fma_f32 v[60:61], v[60:61], v[24:25], v[76:77] op_sel:[1,1,0] op_sel_hi:[1,0,1] neg_lo:[0,1,0]
    v_cvt_pk_bf16_f32 v84, v60, -v61
    ds_write_b32 v1, v84 offset:6864
    v_pk_mul_f32 v[76:77], v[60:61], v[24:25] op_sel:[0,0] op_sel_hi:[0,1] neg_hi:[0,0]
    v_pk_fma_f32 v[60:61], v[60:61], v[24:25], v[76:77] op_sel:[1,1,0] op_sel_hi:[1,0,1] neg_lo:[0,1,0]
    v_cvt_pk_bf16_f32 v84, v60, -v61
    ds_write_b32 v1, v84 offset:7392
    v_pk_mul_f32 v[76:77], v[60:61], v[24:25] op_sel:[0,0] op_sel_hi:[0,1] neg_hi:[0,0]
    v_pk_fma_f32 v[60:61], v[60:61], v[24:25], v[76:77] op_sel:[1,1,0] op_sel_hi:[1,0,1] neg_lo:[0,1,0]
    v_cvt_pk_bf16_f32 v84, v60, -v61
    ds_write_b32 v1, v84 offset:7920
    s_waitcnt lgkmcnt(0)
    s_barrier
    s_barrier
    v_pk_mul_f32 v[76:77], v[14:15], v[34:35] op_sel:[0,0] op_sel_hi:[0,1] neg_hi:[0,0]
    v_pk_fma_f32 v[60:61], v[14:15], v[34:35], v[76:77] op_sel:[1,1,0] op_sel_hi:[1,0,1] neg_lo:[0,1,0]
    v_pk_mul_f32 v[78:79], v[14:15], v[36:37] op_sel:[0,0] op_sel_hi:[0,1] neg_hi:[0,0]
    v_pk_fma_f32 v[62:63], v[14:15], v[36:37], v[78:79] op_sel:[1,1,0] op_sel_hi:[1,0,1] neg_lo:[0,1,0]
    v_cvt_pk_bf16_f32 v84, v60, -v61
    ds_write_b32 v1, v84 offset:0
    v_pk_mul_f32 v[76:77], v[60:61], v[28:29] op_sel:[0,0] op_sel_hi:[0,1] neg_hi:[0,0]
    v_pk_fma_f32 v[60:61], v[60:61], v[28:29], v[76:77] op_sel:[1,1,0] op_sel_hi:[1,0,1] neg_lo:[0,1,0]
    v_cvt_pk_bf16_f32 v85, v62, -v63
    ds_write_b32 v1, v85 offset:8448
    v_pk_mul_f32 v[78:79], v[62:63], v[30:31] op_sel:[0,0] op_sel_hi:[0,1] neg_hi:[0,0]
    v_pk_fma_f32 v[62:63], v[62:63], v[30:31], v[78:79] op_sel:[1,1,0] op_sel_hi:[1,0,1] neg_lo:[0,1,0]
    v_cvt_pk_bf16_f32 v84, v60, -v61
    ds_write_b32 v1, v84 offset:528
    v_pk_mul_f32 v[76:77], v[60:61], v[28:29] op_sel:[0,0] op_sel_hi:[0,1] neg_hi:[0,0]
    v_pk_fma_f32 v[60:61], v[60:61], v[28:29], v[76:77] op_sel:[1,1,0] op_sel_hi:[1,0,1] neg_lo:[0,1,0]
    v_cvt_pk_bf16_f32 v85, v62, -v63
    ds_write_b32 v1, v85 offset:8976
    v_pk_mul_f32 v[78:79], v[62:63], v[30:31] op_sel:[0,0] op_sel_hi:[0,1] neg_hi:[0,0]
    v_pk_fma_f32 v[62:63], v[62:63], v[30:31], v[78:79] op_sel:[1,1,0] op_sel_hi:[1,0,1] neg_lo:[0,1,0]
    v_cvt_pk_bf16_f32 v84, v60, -v61
    ds_write_b32 v1, v84 offset:1056
    v_pk_mul_f32 v[76:77], v[60:61], v[28:29] op_sel:[0,0] op_sel_hi:[0,1] neg_hi:[0,0]
    v_pk_fma_f32 v[60:61], v[60:61], v[28:29], v[76:77] op_sel:[1,1,0] op_sel_hi:[1,0,1] neg_lo:[0,1,0]
    v_cvt_pk_bf16_f32 v85, v62, -v63
    ds_write_b32 v1, v85 offset:9504
    v_pk_mul_f32 v[78:79], v[62:63], v[30:31] op_sel:[0,0] op_sel_hi:[0,1] neg_hi:[0,0]
    v_pk_fma_f32 v[62:63], v[62:63], v[30:31], v[78:79] op_sel:[1,1,0] op_sel_hi:[1,0,1] neg_lo:[0,1,0]
    v_cvt_pk_bf16_f32 v84, v60, -v61
    ds_write_b32 v1, v84 offset:1584
    v_pk_mul_f32 v[76:77], v[60:61], v[28:29] op_sel:[0,0] op_sel_hi:[0,1] neg_hi:[0,0]
    v_pk_fma_f32 v[60:61], v[60:61], v[28:29], v[76:77] op_sel:[1,1,0] op_sel_hi:[1,0,1] neg_lo:[0,1,0]
    v_cvt_pk_bf16_f32 v85, v62, -v63
    ds_write_b32 v1, v85 offset:10032
    v_pk_mul_f32 v[78:79], v[62:63], v[30:31] op_sel:[0,0] op_sel_hi:[0,1] neg_hi:[0,0]
    v_pk_fma_f32 v[62:63], v[62:63], v[30:31], v[78:79] op_sel:[1,1,0] op_sel_hi:[1,0,1] neg_lo:[0,1,0]
    v_cvt_pk_bf16_f32 v84, v60, -v61
    ds_write_b32 v1, v84 offset:2112
    v_pk_mul_f32 v[76:77], v[60:61], v[28:29] op_sel:[0,0] op_sel_hi:[0,1] neg_hi:[0,0]
    v_pk_fma_f32 v[60:61], v[60:61], v[28:29], v[76:77] op_sel:[1,1,0] op_sel_hi:[1,0,1] neg_lo:[0,1,0]
    v_cvt_pk_bf16_f32 v85, v62, -v63
    ds_write_b32 v1, v85 offset:10560
    v_pk_mul_f32 v[78:79], v[62:63], v[30:31] op_sel:[0,0] op_sel_hi:[0,1] neg_hi:[0,0]
    v_pk_fma_f32 v[62:63], v[62:63], v[30:31], v[78:79] op_sel:[1,1,0] op_sel_hi:[1,0,1] neg_lo:[0,1,0]
    v_cvt_pk_bf16_f32 v84, v60, -v61
    ds_write_b32 v1, v84 offset:2640
    v_pk_mul_f32 v[76:77], v[60:61], v[28:29] op_sel:[0,0] op_sel_hi:[0,1] neg_hi:[0,0]
    v_pk_fma_f32 v[60:61], v[60:61], v[28:29], v[76:77] op_sel:[1,1,0] op_sel_hi:[1,0,1] neg_lo:[0,1,0]
    v_cvt_pk_bf16_f32 v85, v62, -v63
    ds_write_b32 v1, v85 offset:11088
    v_pk_mul_f32 v[78:79], v[62:63], v[30:31] op_sel:[0,0] op_sel_hi:[0,1] neg_hi:[0,0]
    v_pk_fma_f32 v[62:63], v[62:63], v[30:31], v[78:79] op_sel:[1,1,0] op_sel_hi:[1,0,1] neg_lo:[0,1,0]
    v_cvt_pk_bf16_f32 v84, v60, -v61
    ds_write_b32 v1, v84 offset:3168
    v_pk_mul_f32 v[76:77], v[60:61], v[28:29] op_sel:[0,0] op_sel_hi:[0,1] neg_hi:[0,0]
    v_pk_fma_f32 v[60:61], v[60:61], v[28:29], v[76:77] op_sel:[1,1,0] op_sel_hi:[1,0,1] neg_lo:[0,1,0]
    v_cvt_pk_bf16_f32 v85, v62, -v63
    ds_write_b32 v1, v85 offset:11616
    v_pk_mul_f32 v[78:79], v[62:63], v[30:31] op_sel:[0,0] op_sel_hi:[0,1] neg_hi:[0,0]
    v_pk_fma_f32 v[62:63], v[62:63], v[30:31], v[78:79] op_sel:[1,1,0] op_sel_hi:[1,0,1] neg_lo:[0,1,0]
    v_cvt_pk_bf16_f32 v84, v60, -v61
    ds_write_b32 v1, v84 offset:3696
    v_cvt_pk_bf16_f32 v85, v62, -v63
    ds_write_b32 v1, v85 offset:12144
    v_pk_mul_f32 v[78:79], v[62:63], v[30:31] op_sel:[0,0] op_sel_hi:[0,1] neg_hi:[0,0]
    v_pk_fma_f32 v[62:63], v[62:63], v[30:31], v[78:79] op_sel:[1,1,0] op_sel_hi:[1,0,1] neg_lo:[0,1,0]
    v_cvt_pk_bf16_f32 v85, v62, -v63
    ds_write_b32 v1, v85 offset:12672
    s_waitcnt lgkmcnt(0)
    s_barrier
    s_barrier
k2_kernel_b1_expand:
    s_mov_b32 s8, 33792
    v_lshlrev_b32 v1, 3, v0
    v_sub_u32 v1, 2047, v1
    v_subrev_u32 v16, 0, v1
    v_cvt_f32_u32 v16, v16
    v_cvt_pk_bf16_f32 v16, v16, v16
    v_bfe_u32 v24, v16, 7, 8
    v_lshlrev_b32 v16, 16, v16
    v_max_u32 v24, 134, v24
    v_cvt_u32_f32 v16, v16
    v_subrev_u32 v24, 134, v24
    v_lshrrev_b32 v16, v24, v16
    v_lshl_add_u32 v16, v24, 7, v16
    v_lshl_add_u32 v16, v16, 2, s8
    ds_read_b32 v16, v16
    v_subrev_u32 v17, 1, v1
    v_cvt_f32_u32 v17, v17
    v_cvt_pk_bf16_f32 v17, v17, v17
    v_bfe_u32 v25, v17, 7, 8
    v_lshlrev_b32 v17, 16, v17
    v_max_u32 v25, 134, v25
    v_cvt_u32_f32 v17, v17
    v_subrev_u32 v25, 134, v25
    v_lshrrev_b32 v17, v25, v17
    v_lshl_add_u32 v17, v25, 7, v17
    v_lshl_add_u32 v17, v17, 2, s8
    ds_read_b32 v17, v17
    v_subrev_u32 v18, 2, v1
    v_cvt_f32_u32 v18, v18
    v_cvt_pk_bf16_f32 v18, v18, v18
    v_bfe_u32 v26, v18, 7, 8
    v_lshlrev_b32 v18, 16, v18
    v_max_u32 v26, 134, v26
    v_cvt_u32_f32 v18, v18
    v_subrev_u32 v26, 134, v26
    v_lshrrev_b32 v18, v26, v18
    v_lshl_add_u32 v18, v26, 7, v18
    v_lshl_add_u32 v18, v18, 2, s8
    ds_read_b32 v18, v18
    v_subrev_u32 v19, 3, v1
    v_cvt_f32_u32 v19, v19
    v_cvt_pk_bf16_f32 v19, v19, v19
    v_bfe_u32 v27, v19, 7, 8
    v_lshlrev_b32 v19, 16, v19
    v_max_u32 v27, 134, v27
    v_cvt_u32_f32 v19, v19
    v_subrev_u32 v27, 134, v27
    v_lshrrev_b32 v19, v27, v19
    v_lshl_add_u32 v19, v27, 7, v19
    v_lshl_add_u32 v19, v19, 2, s8
    ds_read_b32 v19, v19
    v_subrev_u32 v20, 4, v1
    v_cvt_f32_u32 v20, v20
    v_cvt_pk_bf16_f32 v20, v20, v20
    v_bfe_u32 v28, v20, 7, 8
    v_lshlrev_b32 v20, 16, v20
    v_max_u32 v28, 134, v28
    v_cvt_u32_f32 v20, v20
    v_subrev_u32 v28, 134, v28
    v_lshrrev_b32 v20, v28, v20
    v_lshl_add_u32 v20, v28, 7, v20
    v_lshl_add_u32 v20, v20, 2, s8
    ds_read_b32 v20, v20
    v_subrev_u32 v21, 5, v1
    v_cvt_f32_u32 v21, v21
    v_cvt_pk_bf16_f32 v21, v21, v21
    v_bfe_u32 v29, v21, 7, 8
    v_lshlrev_b32 v21, 16, v21
    v_max_u32 v29, 134, v29
    v_cvt_u32_f32 v21, v21
    v_subrev_u32 v29, 134, v29
    v_lshrrev_b32 v21, v29, v21
    v_lshl_add_u32 v21, v29, 7, v21
    v_lshl_add_u32 v21, v21, 2, s8
    ds_read_b32 v21, v21
    v_subrev_u32 v22, 6, v1
    v_cvt_f32_u32 v22, v22
    v_cvt_pk_bf16_f32 v22, v22, v22
    v_bfe_u32 v30, v22, 7, 8
    v_lshlrev_b32 v22, 16, v22
    v_max_u32 v30, 134, v30
    v_cvt_u32_f32 v22, v22
    v_subrev_u32 v30, 134, v30
    v_lshrrev_b32 v22, v30, v22
    v_lshl_add_u32 v22, v30, 7, v22
    v_lshl_add_u32 v22, v22, 2, s8
    ds_read_b32 v22, v22
    v_subrev_u32 v23, 7, v1
    v_cvt_f32_u32 v23, v23
    v_cvt_pk_bf16_f32 v23, v23, v23
    v_bfe_u32 v31, v23, 7, 8
    v_lshlrev_b32 v23, 16, v23
    v_max_u32 v31, 134, v31
    v_cvt_u32_f32 v23, v23
    v_subrev_u32 v31, 134, v31
    v_lshrrev_b32 v23, v31, v23
    v_lshl_add_u32 v23, v31, 7, v23
    v_lshl_add_u32 v23, v23, 2, s8
    ds_read_b32 v23, v23
    s_waitcnt lgkmcnt(0)
    v_cvt_pk_bf16_f32 v32, v16, v17
    v_cvt_pk_bf16_f32 v33, v18, v19
    v_cvt_pk_bf16_f32 v34, v20, v21
    v_cvt_pk_bf16_f32 v35, v22, v23
    v_lshlrev_b32 v1, 4, v0
    s_mul_i32 s6, s2, 4160
    buffer_store_dwordx4 v[32:35], v1, s[60:63], s6 offen
    v_cmp_gt_u32 vcc, 4, v0
    s_and_saveexec_b64 s[4:5], vcc
    s_cbranch_execz k2_kernel_b1_kend
    v_mov_b32 v40, 0
    v_mov_b32 v41, 0
    v_mov_b32 v42, 0
    v_mov_b32 v43, 0
    s_add_u32 s6, s6, 4096
    buffer_store_dwordx4 v[40:43], v1, s[60:63], s6 offen
k2_kernel_b1_kend:
    s_endpgm
.globl k3_kernel
.p2align 8
.type k3_kernel,@function
k3_kernel:

    s_cmp_lt_u32 s2, 256
    s_cbranch_scc1 k3_kernel_r0
    s_cmp_lt_u32 s2, 512
    s_cbranch_scc1 k3_kernel_r1
    s_endpgm
k3_kernel_r0:
    s_cmp_ge_u32 s2, 256
    s_cbranch_scc1 k3_kernel_b0_end
    s_load_dwordx2 s[22:23], s[0:1], 112
    s_load_dwordx2 s[30:31], s[0:1], 96
    s_load_dwordx2 s[36:37], s[0:1], 64
    s_and_b32 s3, s2, 7
    s_lshl_b32 s3, s3, 5
    s_lshr_b32 s2, s2, 3
    s_add_u32 s2, s2, s3
    v_and_b32 v1, 63, v0
    v_lshrrev_b32 v2, 6, v0
    s_waitcnt lgkmcnt(0)
    s_add_u32 s4, s22, 30408704
    s_addc_u32 s5, s23, 0
    s_and_b32 s5, s5, 0xffff
    s_mov_b32 s6, 4194304
    s_mov_b32 s7, 0x00020000
    s_mov_b32 s8, s30
    s_and_b32 s9, s31, 0xffff
    s_mov_b32 s10, 8388608
    s_mov_b32 s11, 0x00020000
    s_mov_b32 s32, s36
    s_and_b32 s33, s37, 0xffff
    s_mov_b32 s34, 2048
    s_mov_b32 s35, 0x00020000
    s_add_u32 s12, s22, 25165824
    s_addc_u32 s13, s23, 0
    s_and_b32 s13, s13, 0xffff
    s_mov_b32 s14, 4259840
    s_mov_b32 s15, 0x00020000
    s_mul_i32 s24, s2, 16384
    s_mul_i32 s25, s2, 16640
    s_add_u32 s26, s25, 4096
    v_lshlrev_b32 v4, 12, v2
    v_lshl_add_u32 v4, v1, 4, v4
    s_lshl_b32 s27, s2, 3
    v_lshlrev_b32 v15, 1, v2
    buffer_load_ushort v15, v15, s[32:35], s27 offen
    buffer_load_dwordx4 v[16:19], v4, s[4:7], s24 offen offset:0
    buffer_load_dwordx4 v[20:23], v4, s[4:7], s24 offen offset:1024
    buffer_load_dwordx4 v[24:27], v4, s[4:7], s24 offen offset:2048
    buffer_load_dwordx4 v[28:31], v4, s[4:7], s24 offen offset:3072
    v_mul_u32_u24 v4, 4160, v2
    v_lshl_add_u32 v4, v1, 4, v4
    buffer_load_dwordx4 v[32:35], v4, s[12:15], s25 offen offset:0
    buffer_load_dwordx4 v[36:39], v4, s[12:15], s25 offen offset:4
    buffer_load_dwordx4 v[40:43], v4, s[12:15], s25 offen offset:1024
    buffer_load_dwordx4 v[44:47], v4, s[12:15], s25 offen offset:1028
    buffer_load_dwordx4 v[48:51], v4, s[12:15], s25 offen offset:2048
    buffer_load_dwordx4 v[52:55], v4, s[12:15], s25 offen offset:2052
    buffer_load_dwordx4 v[56:59], v4, s[12:15], s25 offen offset:3072
    buffer_load_dwordx4 v[60:63], v4, s[12:15], s25 offen offset:3076
    v_cmp_gt_u32 vcc, 4, v1
    s_and_saveexec_b64 s[28:29], vcc
    buffer_load_dwordx4 v[64:67], v4, s[12:15], s26 offen offset:0
    buffer_load_dwordx4 v[68:71], v4, s[12:15], s26 offen offset:4
    s_mov_b64 exec, s[28:29]
    v_mov_b32 v8, 0
    v_mov_b32 v9, 0
    v_mul_u32_u24 v5, 12960, v2
    v_lshl_add_u32 v7, v1, 3, v5
    ds_write_b64 v7, v[8:9] offset:8320
    s_and_saveexec_b64 s[28:29], vcc
    ds_write_b64 v7, v[8:9] offset:8832
    s_mov_b64 exec, s[28:29]
    v_lshl_add_u32 v7, v1, 4, v5
    s_waitcnt vmcnt(10)
    v_readfirstlane_b32 s38, v15
    v_mul_u32_u24 v5, 12960, v2
    ds_write_b128 v7, v[16:19] offset:8864
    ds_write_b128 v7, v[20:23] offset:9888
    ds_write_b128 v7, v[24:27] offset:10912
    ds_write_b128 v7, v[28:31] offset:11936
    s_waitcnt vmcnt(8)
    v_alignbyte_b32 v36, v36, v32, 2
    v_alignbyte_b32 v37, v37, v33, 2
    v_alignbyte_b32 v38, v38, v34, 2
    v_alignbyte_b32 v39, v39, v35, 2
    ds_write_b128 v7, v[32:35] offset:0
    ds_write_b128 v7, v[36:39] offset:4160
    s_waitcnt vmcnt(6)
    v_alignbyte_b32 v44, v44, v40, 2
    v_alignbyte_b32 v45, v45, v41, 2
    v_alignbyte_b32 v46, v46, v42, 2
    v_alignbyte_b32 v47, v47, v43, 2
    ds_write_b128 v7, v[40:43] offset:1024
    ds_write_b128 v7, v[44:47] offset:5184
    s_waitcnt vmcnt(4)
    v_alignbyte_b32 v52, v52, v48, 2
    v_alignbyte_b32 v53, v53, v49, 2
    v_alignbyte_b32 v54, v54, v50, 2
    v_alignbyte_b32 v55, v55, v51, 2
    ds_write_b128 v7, v[48:51] offset:2048
    ds_write_b128 v7, v[52:55] offset:6208
    s_waitcnt vmcnt(2)
    v_alignbyte_b32 v60, v60, v56, 2
    v_alignbyte_b32 v61, v61, v57, 2
    v_alignbyte_b32 v62, v62, v58, 2
    v_alignbyte_b32 v63, v63, v59, 2
    ds_write_b128 v7, v[56:59] offset:3072
    ds_write_b128 v7, v[60:63] offset:7232
    s_waitcnt vmcnt(0)
    s_and_saveexec_b64 s[28:29], vcc
    v_alignbyte_b32 v68, v68, v64, 2
    v_alignbyte_b32 v69, v69, v65, 2
    v_alignbyte_b32 v70, v70, v66, 2
    v_alignbyte_b32 v71, v71, v67, 2
    ds_write_b128 v7, v[64:67] offset:4096
    ds_write_b128 v7, v[68:71] offset:8256
    s_mov_b64 exec, s[28:29]
    v_and_b32 v8, 15, v1
    v_lshrrev_b32 v9, 5, v1
    v_bfe_u32 v10, v1, 4, 1
    v_lshlrev_b32 v11, 4, v9
    v_add_u32 v11, v11, v8
    v_lshlrev_b32 v12, 3, v10
    v_sub_u32 v11, v12, v11
    v_add_u32 v11, 31, v11
    v_and_b32 v13, 1, v11
    v_sub_u32 v11, v11, v13
    v_mul_u32_u24 v13, 4160, v13
    v_lshl_add_u32 v11, v11, 1, v13
    v_add_u32 v14, v11, v5
    v_lshlrev_b32 v11, 4, v8
    v_lshlrev_b32 v13, 4, v9
    v_sub_u32 v11, v11, v13
    v_add_u32 v11, v11, v12
    v_add_u32 v11, 16, v11
    v_lshl_add_u32 v3, v11, 1, v5
    v_add_u32 v4, 0, v14
    v_add_u32 v5, 1024, v14
    v_add_u32 v6, 2048, v14
    v_add_u32 v7, 3072, v14
    s_waitcnt lgkmcnt(0)
    v_mov_b32 v8, 0
    v_mov_b32 v9, 0
    v_mov_b32 v10, 0
    v_mov_b32 v11, 0
    v_mov_b32 v12, 0
    v_mov_b32 v13, 0
    v_mov_b32 v14, 0
    v_mov_b32 v15, 0
    v_mov_b32 v16, 0
    v_mov_b32 v17, 0
    v_mov_b32 v18, 0
    v_mov_b32 v19, 0
    v_mov_b32 v20, 0
    v_mov_b32 v21, 0
    v_mov_b32 v22, 0
    v_mov_b32 v23, 0
    v_mov_b32 v24, 0
    v_mov_b32 v25, 0
    v_mov_b32 v26, 0
    v_mov_b32 v27, 0
    v_mov_b32 v28, 0
    v_mov_b32 v29, 0
    v_mov_b32 v30, 0
    v_mov_b32 v31, 0
    v_mov_b32 v32, 0
    v_mov_b32 v33, 0
    v_mov_b32 v34, 0
    v_mov_b32 v35, 0
    v_mov_b32 v36, 0
    v_mov_b32 v37, 0
    v_mov_b32 v38, 0
    v_mov_b32 v39, 0
    ds_read_b128 v[40:43], v3 offset:8832
    ds_read_b128 v[44:47], v3 offset:9344
    ds_read_b128 v[48:51], v3 offset:9856
    ds_read_b128 v[52:55], v3 offset:10368
    ds_read_b128 v[56:59], v3 offset:10880
    ds_read_b128 v[60:63], v3 offset:11392
    ds_read_b128 v[64:67], v3 offset:11904
    ds_read_b128 v[68:71], v3 offset:12416
    s_waitcnt lgkmcnt(7)
    ds_read2_b32 v[104:105], v7 offset0:240 offset1:241
    ds_read2_b32 v[106:107], v7 offset0:242 offset1:243
    ds_read2_b32 v[108:109], v7 offset0:112 offset1:113
    ds_read2_b32 v[110:111], v7 offset0:114 offset1:115
    ds_read2_b32 v[112:113], v6 offset0:240 offset1:241
    ds_read2_b32 v[114:115], v6 offset0:242 offset1:243
    ds_read2_b32 v[116:117], v6 offset0:112 offset1:113
    ds_read2_b32 v[118:119], v6 offset0:114 offset1:115
    s_waitcnt lgkmcnt(7)
    ds_read2_b32 v[120:121], v5 offset0:240 offset1:241
    ds_read2_b32 v[122:123], v5 offset0:242 offset1:243
    ds_read2_b32 v[124:125], v5 offset0:112 offset1:113
    ds_read2_b32 v[126:127], v5 offset0:114 offset1:115
    ds_read2_b32 v[128:129], v4 offset0:240 offset1:241
    ds_read2_b32 v[130:131], v4 offset0:242 offset1:243
    ds_read2_b32 v[132:133], v4 offset0:112 offset1:113
    ds_read2_b32 v[134:135], v4 offset0:114 offset1:115
    s_waitcnt lgkmcnt(0)
    ds_read_b128 v[72:75], v3 offset:8768
    ds_read_b128 v[76:79], v3 offset:9280
    ds_read_b128 v[80:83], v3 offset:9792
    ds_read_b128 v[84:87], v3 offset:10304
    ds_read_b128 v[88:91], v3 offset:10816
    ds_read_b128 v[92:95], v3 offset:11328
    ds_read_b128 v[96:99], v3 offset:11840
    ds_read_b128 v[100:103], v3 offset:12352
    v_mfma_f32_16x16x32_bf16 v[8:11], v[104:107], v[40:43], v[8:11]
    v_mfma_f32_16x16x32_bf16 v[12:15], v[104:107], v[44:47], v[12:15]
    v_mfma_f32_16x16x32_bf16 v[16:19], v[104:107], v[48:51], v[16:19]
    v_mfma_f32_16x16x32_bf16 v[20:23], v[104:107], v[52:55], v[20:23]
    v_mfma_f32_16x16x32_bf16 v[24:27], v[104:107], v[56:59], v[24:27]
    v_mfma_f32_16x16x32_bf16 v[28:31], v[104:107], v[60:63], v[28:31]
    v_mfma_f32_16x16x32_bf16 v[32:35], v[104:107], v[64:67], v[32:35]
    v_mfma_f32_16x16x32_bf16 v[36:39], v[104:107], v[68:71], v[36:39]
    v_mfma_f32_16x16x32_bf16 v[12:15], v[108:111], v[40:43], v[12:15]
    v_mfma_f32_16x16x32_bf16 v[16:19], v[108:111], v[44:47], v[16:19]
    v_mfma_f32_16x16x32_bf16 v[20:23], v[108:111], v[48:51], v[20:23]
    v_mfma_f32_16x16x32_bf16 v[24:27], v[108:111], v[52:55], v[24:27]
    s_waitcnt lgkmcnt(7)
    ds_read2_b32 v[136:137], v7 offset0:224 offset1:225
    ds_read2_b32 v[138:139], v7 offset0:226 offset1:227
    ds_read2_b32 v[140:141], v7 offset0:96 offset1:97
    ds_read2_b32 v[142:143], v7 offset0:98 offset1:99
    ds_read2_b32 v[144:145], v6 offset0:224 offset1:225
    ds_read2_b32 v[146:147], v6 offset0:226 offset1:227
    ds_read2_b32 v[148:149], v6 offset0:96 offset1:97
    ds_read2_b32 v[150:151], v6 offset0:98 offset1:99
    s_waitcnt lgkmcnt(7)
    ds_read2_b32 v[152:153], v5 offset0:224 offset1:225
    ds_read2_b32 v[154:155], v5 offset0:226 offset1:227
    ds_read2_b32 v[156:157], v5 offset0:96 offset1:97
    ds_read2_b32 v[158:159], v5 offset0:98 offset1:99
    ds_read2_b32 v[160:161], v4 offset0:224 offset1:225
    ds_read2_b32 v[162:163], v4 offset0:226 offset1:227
    ds_read2_b32 v[164:165], v4 offset0:96 offset1:97
    ds_read2_b32 v[166:167], v4 offset0:98 offset1:99
    v_mfma_f32_16x16x32_bf16 v[28:31], v[108:111], v[56:59], v[28:31]
    v_mfma_f32_16x16x32_bf16 v[32:35], v[108:111], v[60:63], v[32:35]
    v_mfma_f32_16x16x32_bf16 v[36:39], v[108:111], v[64:67], v[36:39]
    v_mfma_f32_16x16x32_bf16 v[16:19], v[112:115], v[40:43], v[16:19]
    v_mfma_f32_16x16x32_bf16 v[20:23], v[112:115], v[44:47], v[20:23]
    v_mfma_f32_16x16x32_bf16 v[24:27], v[112:115], v[48:51], v[24:27]
    v_mfma_f32_16x16x32_bf16 v[28:31], v[112:115], v[52:55], v[28:31]
    v_mfma_f32_16x16x32_bf16 v[32:35], v[112:115], v[56:59], v[32:35]
    v_mfma_f32_16x16x32_bf16 v[36:39], v[112:115], v[60:63], v[36:39]
    v_mfma_f32_16x16x32_bf16 v[20:23], v[116:119], v[40:43], v[20:23]
    v_mfma_f32_16x16x32_bf16 v[24:27], v[116:119], v[44:47], v[24:27]
    v_mfma_f32_16x16x32_bf16 v[28:31], v[116:119], v[48:51], v[28:31]
    v_mfma_f32_16x16x32_bf16 v[32:35], v[116:119], v[52:55], v[32:35]
    v_mfma_f32_16x16x32_bf16 v[36:39], v[116:119], v[56:59], v[36:39]
    v_mfma_f32_16x16x32_bf16 v[24:27], v[120:123], v[40:43], v[24:27]
    v_mfma_f32_16x16x32_bf16 v[28:31], v[120:123], v[44:47], v[28:31]
    v_mfma_f32_16x16x32_bf16 v[32:35], v[120:123], v[48:51], v[32:35]
    v_mfma_f32_16x16x32_bf16 v[36:39], v[120:123], v[52:55], v[36:39]
    v_mfma_f32_16x16x32_bf16 v[28:31], v[124:127], v[40:43], v[28:31]
    v_mfma_f32_16x16x32_bf16 v[32:35], v[124:127], v[44:47], v[32:35]
    v_mfma_f32_16x16x32_bf16 v[36:39], v[124:127], v[48:51], v[36:39]
    v_mfma_f32_16x16x32_bf16 v[32:35], v[128:131], v[40:43], v[32:35]
    v_mfma_f32_16x16x32_bf16 v[36:39], v[128:131], v[44:47], v[36:39]
    v_mfma_f32_16x16x32_bf16 v[36:39], v[132:135], v[40:43], v[36:39]
    s_waitcnt lgkmcnt(0)
    ds_read_b128 v[40:43], v3 offset:8704
    ds_read_b128 v[44:47], v3 offset:9216
    ds_read_b128 v[48:51], v3 offset:9728
    ds_read_b128 v[52:55], v3 offset:10240
    ds_read_b128 v[56:59], v3 offset:10752
    ds_read_b128 v[60:63], v3 offset:11264
    ds_read_b128 v[64:67], v3 offset:11776
    ds_read_b128 v[68:71], v3 offset:12288
    v_mfma_f32_16x16x32_bf16 v[8:11], v[136:139], v[72:75], v[8:11]
    v_mfma_f32_16x16x32_bf16 v[12:15], v[136:139], v[76:79], v[12:15]
    v_mfma_f32_16x16x32_bf16 v[16:19], v[136:139], v[80:83], v[16:19]
    v_mfma_f32_16x16x32_bf16 v[20:23], v[136:139], v[84:87], v[20:23]
    v_mfma_f32_16x16x32_bf16 v[24:27], v[136:139], v[88:91], v[24:27]
    v_mfma_f32_16x16x32_bf16 v[28:31], v[136:139], v[92:95], v[28:31]
    v_mfma_f32_16x16x32_bf16 v[32:35], v[136:139], v[96:99], v[32:35]
    v_mfma_f32_16x16x32_bf16 v[36:39], v[136:139], v[100:103], v[36:39]
    v_mfma_f32_16x16x32_bf16 v[12:15], v[140:143], v[72:75], v[12:15]
    v_mfma_f32_16x16x32_bf16 v[16:19], v[140:143], v[76:79], v[16:19]
    v_mfma_f32_16x16x32_bf16 v[20:23], v[140:143], v[80:83], v[20:23]
    v_mfma_f32_16x16x32_bf16 v[24:27], v[140:143], v[84:87], v[24:27]
    s_waitcnt lgkmcnt(7)
    ds_read2_b32 v[104:105], v7 offset0:208 offset1:209
    ds_read2_b32 v[106:107], v7 offset0:210 offset1:211
    ds_read2_b32 v[108:109], v7 offset0:80 offset1:81
    ds_read2_b32 v[110:111], v7 offset0:82 offset1:83
    ds_read2_b32 v[112:113], v6 offset0:208 offset1:209
    ds_read2_b32 v[114:115], v6 offset0:210 offset1:211
    ds_read2_b32 v[116:117], v6 offset0:80 offset1:81
    ds_read2_b32 v[118:119], v6 offset0:82 offset1:83
    s_waitcnt lgkmcnt(7)
    ds_read2_b32 v[120:121], v5 offset0:208 offset1:209
    ds_read2_b32 v[122:123], v5 offset0:210 offset1:211
    ds_read2_b32 v[124:125], v5 offset0:80 offset1:81
    ds_read2_b32 v[126:127], v5 offset0:82 offset1:83
    ds_read2_b32 v[128:129], v4 offset0:208 offset1:209
    ds_read2_b32 v[130:131], v4 offset0:210 offset1:211
    ds_read2_b32 v[132:133], v4 offset0:80 offset1:81
    ds_read2_b32 v[134:135], v4 offset0:82 offset1:83
    v_mfma_f32_16x16x32_bf16 v[28:31], v[140:143], v[88:91], v[28:31]
    v_mfma_f32_16x16x32_bf16 v[32:35], v[140:143], v[92:95], v[32:35]
    v_mfma_f32_16x16x32_bf16 v[36:39], v[140:143], v[96:99], v[36:39]
    v_mfma_f32_16x16x32_bf16 v[16:19], v[144:147], v[72:75], v[16:19]
    v_mfma_f32_16x16x32_bf16 v[20:23], v[144:147], v[76:79], v[20:23]
    v_mfma_f32_16x16x32_bf16 v[24:27], v[144:147], v[80:83], v[24:27]
    v_mfma_f32_16x16x32_bf16 v[28:31], v[144:147], v[84:87], v[28:31]
    v_mfma_f32_16x16x32_bf16 v[32:35], v[144:147], v[88:91], v[32:35]
    v_mfma_f32_16x16x32_bf16 v[36:39], v[144:147], v[92:95], v[36:39]
    v_mfma_f32_16x16x32_bf16 v[20:23], v[148:151], v[72:75], v[20:23]
    v_mfma_f32_16x16x32_bf16 v[24:27], v[148:151], v[76:79], v[24:27]
    v_mfma_f32_16x16x32_bf16 v[28:31], v[148:151], v[80:83], v[28:31]
    v_mfma_f32_16x16x32_bf16 v[32:35], v[148:151], v[84:87], v[32:35]
    v_mfma_f32_16x16x32_bf16 v[36:39], v[148:151], v[88:91], v[36:39]
    v_mfma_f32_16x16x32_bf16 v[24:27], v[152:155], v[72:75], v[24:27]
    v_mfma_f32_16x16x32_bf16 v[28:31], v[152:155], v[76:79], v[28:31]
    v_mfma_f32_16x16x32_bf16 v[32:35], v[152:155], v[80:83], v[32:35]
    v_mfma_f32_16x16x32_bf16 v[36:39], v[152:155], v[84:87], v[36:39]
    v_mfma_f32_16x16x32_bf16 v[28:31], v[156:159], v[72:75], v[28:31]
    v_mfma_f32_16x16x32_bf16 v[32:35], v[156:159], v[76:79], v[32:35]
    v_mfma_f32_16x16x32_bf16 v[36:39], v[156:159], v[80:83], v[36:39]
    v_mfma_f32_16x16x32_bf16 v[32:35], v[160:163], v[72:75], v[32:35]
    v_mfma_f32_16x16x32_bf16 v[36:39], v[160:163], v[76:79], v[36:39]
    v_mfma_f32_16x16x32_bf16 v[36:39], v[164:167], v[72:75], v[36:39]
    s_waitcnt lgkmcnt(0)
    ds_read_b128 v[72:75], v3 offset:8640
    ds_read_b128 v[76:79], v3 offset:9152
    ds_read_b128 v[80:83], v3 offset:9664
    ds_read_b128 v[84:87], v3 offset:10176
    ds_read_b128 v[88:91], v3 offset:10688
    ds_read_b128 v[92:95], v3 offset:11200
    ds_read_b128 v[96:99], v3 offset:11712
    ds_read_b128 v[100:103], v3 offset:12224
    v_mfma_f32_16x16x32_bf16 v[8:11], v[104:107], v[40:43], v[8:11]
    v_mfma_f32_16x16x32_bf16 v[12:15], v[104:107], v[44:47], v[12:15]
    v_mfma_f32_16x16x32_bf16 v[16:19], v[104:107], v[48:51], v[16:19]
    v_mfma_f32_16x16x32_bf16 v[20:23], v[104:107], v[52:55], v[20:23]
    v_mfma_f32_16x16x32_bf16 v[24:27], v[104:107], v[56:59], v[24:27]
    v_mfma_f32_16x16x32_bf16 v[28:31], v[104:107], v[60:63], v[28:31]
    v_mfma_f32_16x16x32_bf16 v[32:35], v[104:107], v[64:67], v[32:35]
    v_mfma_f32_16x16x32_bf16 v[36:39], v[104:107], v[68:71], v[36:39]
    v_mfma_f32_16x16x32_bf16 v[12:15], v[108:111], v[40:43], v[12:15]
    v_mfma_f32_16x16x32_bf16 v[16:19], v[108:111], v[44:47], v[16:19]
    v_mfma_f32_16x16x32_bf16 v[20:23], v[108:111], v[48:51], v[20:23]
    v_mfma_f32_16x16x32_bf16 v[24:27], v[108:111], v[52:55], v[24:27]
    s_waitcnt lgkmcnt(7)
    ds_read2_b32 v[136:137], v7 offset0:192 offset1:193
    ds_read2_b32 v[138:139], v7 offset0:194 offset1:195
    ds_read2_b32 v[140:141], v7 offset0:64 offset1:65
    ds_read2_b32 v[142:143], v7 offset0:66 offset1:67
    ds_read2_b32 v[144:145], v6 offset0:192 offset1:193
    ds_read2_b32 v[146:147], v6 offset0:194 offset1:195
    ds_read2_b32 v[148:149], v6 offset0:64 offset1:65
    ds_read2_b32 v[150:151], v6 offset0:66 offset1:67
    s_waitcnt lgkmcnt(7)
    ds_read2_b32 v[152:153], v5 offset0:192 offset1:193
    ds_read2_b32 v[154:155], v5 offset0:194 offset1:195
    ds_read2_b32 v[156:157], v5 offset0:64 offset1:65
    ds_read2_b32 v[158:159], v5 offset0:66 offset1:67
    ds_read2_b32 v[160:161], v4 offset0:192 offset1:193
    ds_read2_b32 v[162:163], v4 offset0:194 offset1:195
    ds_read2_b32 v[164:165], v4 offset0:64 offset1:65
    ds_read2_b32 v[166:167], v4 offset0:66 offset1:67
    v_mfma_f32_16x16x32_bf16 v[28:31], v[108:111], v[56:59], v[28:31]
    v_mfma_f32_16x16x32_bf16 v[32:35], v[108:111], v[60:63], v[32:35]
    v_mfma_f32_16x16x32_bf16 v[36:39], v[108:111], v[64:67], v[36:39]
    v_mfma_f32_16x16x32_bf16 v[16:19], v[112:115], v[40:43], v[16:19]
    v_mfma_f32_16x16x32_bf16 v[20:23], v[112:115], v[44:47], v[20:23]
    v_mfma_f32_16x16x32_bf16 v[24:27], v[112:115], v[48:51], v[24:27]
    v_mfma_f32_16x16x32_bf16 v[28:31], v[112:115], v[52:55], v[28:31]
    v_mfma_f32_16x16x32_bf16 v[32:35], v[112:115], v[56:59], v[32:35]
    v_mfma_f32_16x16x32_bf16 v[36:39], v[112:115], v[60:63], v[36:39]
    v_mfma_f32_16x16x32_bf16 v[20:23], v[116:119], v[40:43], v[20:23]
    v_mfma_f32_16x16x32_bf16 v[24:27], v[116:119], v[44:47], v[24:27]
    v_mfma_f32_16x16x32_bf16 v[28:31], v[116:119], v[48:51], v[28:31]
    v_mfma_f32_16x16x32_bf16 v[32:35], v[116:119], v[52:55], v[32:35]
    v_mfma_f32_16x16x32_bf16 v[36:39], v[116:119], v[56:59], v[36:39]
    v_mfma_f32_16x16x32_bf16 v[24:27], v[120:123], v[40:43], v[24:27]
    v_mfma_f32_16x16x32_bf16 v[28:31], v[120:123], v[44:47], v[28:31]
    v_mfma_f32_16x16x32_bf16 v[32:35], v[120:123], v[48:51], v[32:35]
    v_mfma_f32_16x16x32_bf16 v[36:39], v[120:123], v[52:55], v[36:39]
    v_mfma_f32_16x16x32_bf16 v[28:31], v[124:127], v[40:43], v[28:31]
    v_mfma_f32_16x16x32_bf16 v[32:35], v[124:127], v[44:47], v[32:35]
    v_mfma_f32_16x16x32_bf16 v[36:39], v[124:127], v[48:51], v[36:39]
    v_mfma_f32_16x16x32_bf16 v[32:35], v[128:131], v[40:43], v[32:35]
    v_mfma_f32_16x16x32_bf16 v[36:39], v[128:131], v[44:47], v[36:39]
    v_mfma_f32_16x16x32_bf16 v[36:39], v[132:135], v[40:43], v[36:39]
    s_waitcnt lgkmcnt(0)
    ds_read_b128 v[40:43], v3 offset:8576
    ds_read_b128 v[44:47], v3 offset:9088
    ds_read_b128 v[48:51], v3 offset:9600
    ds_read_b128 v[52:55], v3 offset:10112
    ds_read_b128 v[56:59], v3 offset:10624
    ds_read_b128 v[60:63], v3 offset:11136
    ds_read_b128 v[64:67], v3 offset:11648
    ds_read_b128 v[68:71], v3 offset:12160
    v_mfma_f32_16x16x32_bf16 v[8:11], v[136:139], v[72:75], v[8:11]
    v_mfma_f32_16x16x32_bf16 v[12:15], v[136:139], v[76:79], v[12:15]
    v_mfma_f32_16x16x32_bf16 v[16:19], v[136:139], v[80:83], v[16:19]
    v_mfma_f32_16x16x32_bf16 v[20:23], v[136:139], v[84:87], v[20:23]
    v_mfma_f32_16x16x32_bf16 v[24:27], v[136:139], v[88:91], v[24:27]
    v_mfma_f32_16x16x32_bf16 v[28:31], v[136:139], v[92:95], v[28:31]
    v_mfma_f32_16x16x32_bf16 v[32:35], v[136:139], v[96:99], v[32:35]
    v_mfma_f32_16x16x32_bf16 v[36:39], v[136:139], v[100:103], v[36:39]
    v_mfma_f32_16x16x32_bf16 v[12:15], v[140:143], v[72:75], v[12:15]
    v_mfma_f32_16x16x32_bf16 v[16:19], v[140:143], v[76:79], v[16:19]
    v_mfma_f32_16x16x32_bf16 v[20:23], v[140:143], v[80:83], v[20:23]
    v_mfma_f32_16x16x32_bf16 v[24:27], v[140:143], v[84:87], v[24:27]
    s_waitcnt lgkmcnt(7)
    ds_read2_b32 v[104:105], v7 offset0:176 offset1:177
    ds_read2_b32 v[106:107], v7 offset0:178 offset1:179
    ds_read2_b32 v[108:109], v7 offset0:48 offset1:49
    ds_read2_b32 v[110:111], v7 offset0:50 offset1:51
    ds_read2_b32 v[112:113], v6 offset0:176 offset1:177
    ds_read2_b32 v[114:115], v6 offset0:178 offset1:179
    ds_read2_b32 v[116:117], v6 offset0:48 offset1:49
    ds_read2_b32 v[118:119], v6 offset0:50 offset1:51
    s_waitcnt lgkmcnt(7)
    ds_read2_b32 v[120:121], v5 offset0:176 offset1:177
    ds_read2_b32 v[122:123], v5 offset0:178 offset1:179
    ds_read2_b32 v[124:125], v5 offset0:48 offset1:49
    ds_read2_b32 v[126:127], v5 offset0:50 offset1:51
    ds_read2_b32 v[128:129], v4 offset0:176 offset1:177
    ds_read2_b32 v[130:131], v4 offset0:178 offset1:179
    ds_read2_b32 v[132:133], v4 offset0:48 offset1:49
    ds_read2_b32 v[134:135], v4 offset0:50 offset1:51
    v_mfma_f32_16x16x32_bf16 v[28:31], v[140:143], v[88:91], v[28:31]
    v_mfma_f32_16x16x32_bf16 v[32:35], v[140:143], v[92:95], v[32:35]
    v_mfma_f32_16x16x32_bf16 v[36:39], v[140:143], v[96:99], v[36:39]
    v_mfma_f32_16x16x32_bf16 v[16:19], v[144:147], v[72:75], v[16:19]
    v_mfma_f32_16x16x32_bf16 v[20:23], v[144:147], v[76:79], v[20:23]
    v_mfma_f32_16x16x32_bf16 v[24:27], v[144:147], v[80:83], v[24:27]
    v_mfma_f32_16x16x32_bf16 v[28:31], v[144:147], v[84:87], v[28:31]
    v_mfma_f32_16x16x32_bf16 v[32:35], v[144:147], v[88:91], v[32:35]
    v_mfma_f32_16x16x32_bf16 v[36:39], v[144:147], v[92:95], v[36:39]
    v_mfma_f32_16x16x32_bf16 v[20:23], v[148:151], v[72:75], v[20:23]
    v_mfma_f32_16x16x32_bf16 v[24:27], v[148:151], v[76:79], v[24:27]
    v_mfma_f32_16x16x32_bf16 v[28:31], v[148:151], v[80:83], v[28:31]
    v_mfma_f32_16x16x32_bf16 v[32:35], v[148:151], v[84:87], v[32:35]
    v_mfma_f32_16x16x32_bf16 v[36:39], v[148:151], v[88:91], v[36:39]
    v_mfma_f32_16x16x32_bf16 v[24:27], v[152:155], v[72:75], v[24:27]
    v_mfma_f32_16x16x32_bf16 v[28:31], v[152:155], v[76:79], v[28:31]
    v_mfma_f32_16x16x32_bf16 v[32:35], v[152:155], v[80:83], v[32:35]
    v_mfma_f32_16x16x32_bf16 v[36:39], v[152:155], v[84:87], v[36:39]
    v_mfma_f32_16x16x32_bf16 v[28:31], v[156:159], v[72:75], v[28:31]
    v_mfma_f32_16x16x32_bf16 v[32:35], v[156:159], v[76:79], v[32:35]
    v_mfma_f32_16x16x32_bf16 v[36:39], v[156:159], v[80:83], v[36:39]
    v_mfma_f32_16x16x32_bf16 v[32:35], v[160:163], v[72:75], v[32:35]
    v_mfma_f32_16x16x32_bf16 v[36:39], v[160:163], v[76:79], v[36:39]
    v_mfma_f32_16x16x32_bf16 v[36:39], v[164:167], v[72:75], v[36:39]
    s_waitcnt lgkmcnt(0)
    ds_read_b128 v[72:75], v3 offset:8512
    ds_read_b128 v[76:79], v3 offset:9024
    ds_read_b128 v[80:83], v3 offset:9536
    ds_read_b128 v[84:87], v3 offset:10048
    ds_read_b128 v[88:91], v3 offset:10560
    ds_read_b128 v[92:95], v3 offset:11072
    ds_read_b128 v[96:99], v3 offset:11584
    ds_read_b128 v[100:103], v3 offset:12096
    v_mfma_f32_16x16x32_bf16 v[8:11], v[104:107], v[40:43], v[8:11]
    v_mfma_f32_16x16x32_bf16 v[12:15], v[104:107], v[44:47], v[12:15]
    v_mfma_f32_16x16x32_bf16 v[16:19], v[104:107], v[48:51], v[16:19]
    v_mfma_f32_16x16x32_bf16 v[20:23], v[104:107], v[52:55], v[20:23]
    v_mfma_f32_16x16x32_bf16 v[24:27], v[104:107], v[56:59], v[24:27]
    v_mfma_f32_16x16x32_bf16 v[28:31], v[104:107], v[60:63], v[28:31]
    v_mfma_f32_16x16x32_bf16 v[32:35], v[104:107], v[64:67], v[32:35]
    v_mfma_f32_16x16x32_bf16 v[36:39], v[104:107], v[68:71], v[36:39]
    v_mfma_f32_16x16x32_bf16 v[12:15], v[108:111], v[40:43], v[12:15]
    v_mfma_f32_16x16x32_bf16 v[16:19], v[108:111], v[44:47], v[16:19]
    v_mfma_f32_16x16x32_bf16 v[20:23], v[108:111], v[48:51], v[20:23]
    v_mfma_f32_16x16x32_bf16 v[24:27], v[108:111], v[52:55], v[24:27]
    s_waitcnt lgkmcnt(7)
    ds_read2_b32 v[136:137], v7 offset0:160 offset1:161
    ds_read2_b32 v[138:139], v7 offset0:162 offset1:163
    ds_read2_b32 v[140:141], v7 offset0:32 offset1:33
    ds_read2_b32 v[142:143], v7 offset0:34 offset1:35
    ds_read2_b32 v[144:145], v6 offset0:160 offset1:161
    ds_read2_b32 v[146:147], v6 offset0:162 offset1:163
    ds_read2_b32 v[148:149], v6 offset0:32 offset1:33
    ds_read2_b32 v[150:151], v6 offset0:34 offset1:35
    s_waitcnt lgkmcnt(7)
    ds_read2_b32 v[152:153], v5 offset0:160 offset1:161
    ds_read2_b32 v[154:155], v5 offset0:162 offset1:163
    ds_read2_b32 v[156:157], v5 offset0:32 offset1:33
    ds_read2_b32 v[158:159], v5 offset0:34 offset1:35
    ds_read2_b32 v[160:161], v4 offset0:160 offset1:161
    ds_read2_b32 v[162:163], v4 offset0:162 offset1:163
    ds_read2_b32 v[164:165], v4 offset0:32 offset1:33
    ds_read2_b32 v[166:167], v4 offset0:34 offset1:35
    v_mfma_f32_16x16x32_bf16 v[28:31], v[108:111], v[56:59], v[28:31]
    v_mfma_f32_16x16x32_bf16 v[32:35], v[108:111], v[60:63], v[32:35]
    v_mfma_f32_16x16x32_bf16 v[36:39], v[108:111], v[64:67], v[36:39]
    v_mfma_f32_16x16x32_bf16 v[16:19], v[112:115], v[40:43], v[16:19]
    v_mfma_f32_16x16x32_bf16 v[20:23], v[112:115], v[44:47], v[20:23]
    v_mfma_f32_16x16x32_bf16 v[24:27], v[112:115], v[48:51], v[24:27]
    v_mfma_f32_16x16x32_bf16 v[28:31], v[112:115], v[52:55], v[28:31]
    v_mfma_f32_16x16x32_bf16 v[32:35], v[112:115], v[56:59], v[32:35]
    v_mfma_f32_16x16x32_bf16 v[36:39], v[112:115], v[60:63], v[36:39]
    v_mfma_f32_16x16x32_bf16 v[20:23], v[116:119], v[40:43], v[20:23]
    v_mfma_f32_16x16x32_bf16 v[24:27], v[116:119], v[44:47], v[24:27]
    v_mfma_f32_16x16x32_bf16 v[28:31], v[116:119], v[48:51], v[28:31]
    v_mfma_f32_16x16x32_bf16 v[32:35], v[116:119], v[52:55], v[32:35]
    v_mfma_f32_16x16x32_bf16 v[36:39], v[116:119], v[56:59], v[36:39]
    v_mfma_f32_16x16x32_bf16 v[24:27], v[120:123], v[40:43], v[24:27]
    v_mfma_f32_16x16x32_bf16 v[28:31], v[120:123], v[44:47], v[28:31]
    v_mfma_f32_16x16x32_bf16 v[32:35], v[120:123], v[48:51], v[32:35]
    v_mfma_f32_16x16x32_bf16 v[36:39], v[120:123], v[52:55], v[36:39]
    v_mfma_f32_16x16x32_bf16 v[28:31], v[124:127], v[40:43], v[28:31]
    v_mfma_f32_16x16x32_bf16 v[32:35], v[124:127], v[44:47], v[32:35]
    v_mfma_f32_16x16x32_bf16 v[36:39], v[124:127], v[48:51], v[36:39]
    v_mfma_f32_16x16x32_bf16 v[32:35], v[128:131], v[40:43], v[32:35]
    v_mfma_f32_16x16x32_bf16 v[36:39], v[128:131], v[44:47], v[36:39]
    v_mfma_f32_16x16x32_bf16 v[36:39], v[132:135], v[40:43], v[36:39]
    s_waitcnt lgkmcnt(0)
    ds_read_b128 v[40:43], v3 offset:8448
    ds_read_b128 v[44:47], v3 offset:8960
    ds_read_b128 v[48:51], v3 offset:9472
    ds_read_b128 v[52:55], v3 offset:9984
    ds_read_b128 v[56:59], v3 offset:10496
    ds_read_b128 v[60:63], v3 offset:11008
    ds_read_b128 v[64:67], v3 offset:11520
    ds_read_b128 v[68:71], v3 offset:12032
    v_mfma_f32_16x16x32_bf16 v[8:11], v[136:139], v[72:75], v[8:11]
    v_mfma_f32_16x16x32_bf16 v[12:15], v[136:139], v[76:79], v[12:15]
    v_mfma_f32_16x16x32_bf16 v[16:19], v[136:139], v[80:83], v[16:19]
    v_mfma_f32_16x16x32_bf16 v[20:23], v[136:139], v[84:87], v[20:23]
    v_mfma_f32_16x16x32_bf16 v[24:27], v[136:139], v[88:91], v[24:27]
    v_mfma_f32_16x16x32_bf16 v[28:31], v[136:139], v[92:95], v[28:31]
    v_mfma_f32_16x16x32_bf16 v[32:35], v[136:139], v[96:99], v[32:35]
    v_mfma_f32_16x16x32_bf16 v[36:39], v[136:139], v[100:103], v[36:39]
    v_mfma_f32_16x16x32_bf16 v[12:15], v[140:143], v[72:75], v[12:15]
    v_mfma_f32_16x16x32_bf16 v[16:19], v[140:143], v[76:79], v[16:19]
    v_mfma_f32_16x16x32_bf16 v[20:23], v[140:143], v[80:83], v[20:23]
    v_mfma_f32_16x16x32_bf16 v[24:27], v[140:143], v[84:87], v[24:27]
    s_waitcnt lgkmcnt(7)
    ds_read2_b32 v[104:105], v7 offset0:144 offset1:145
    ds_read2_b32 v[106:107], v7 offset0:146 offset1:147
    ds_read2_b32 v[108:109], v7 offset0:16 offset1:17
    ds_read2_b32 v[110:111], v7 offset0:18 offset1:19
    ds_read2_b32 v[112:113], v6 offset0:144 offset1:145
    ds_read2_b32 v[114:115], v6 offset0:146 offset1:147
    ds_read2_b32 v[116:117], v6 offset0:16 offset1:17
    ds_read2_b32 v[118:119], v6 offset0:18 offset1:19
    s_waitcnt lgkmcnt(7)
    ds_read2_b32 v[120:121], v5 offset0:144 offset1:145
    ds_read2_b32 v[122:123], v5 offset0:146 offset1:147
    ds_read2_b32 v[124:125], v5 offset0:16 offset1:17
    ds_read2_b32 v[126:127], v5 offset0:18 offset1:19
    ds_read2_b32 v[128:129], v4 offset0:144 offset1:145
    ds_read2_b32 v[130:131], v4 offset0:146 offset1:147
    ds_read2_b32 v[132:133], v4 offset0:16 offset1:17
    ds_read2_b32 v[134:135], v4 offset0:18 offset1:19
    v_mfma_f32_16x16x32_bf16 v[28:31], v[140:143], v[88:91], v[28:31]
    v_mfma_f32_16x16x32_bf16 v[32:35], v[140:143], v[92:95], v[32:35]
    v_mfma_f32_16x16x32_bf16 v[36:39], v[140:143], v[96:99], v[36:39]
    v_mfma_f32_16x16x32_bf16 v[16:19], v[144:147], v[72:75], v[16:19]
    v_mfma_f32_16x16x32_bf16 v[20:23], v[144:147], v[76:79], v[20:23]
    v_mfma_f32_16x16x32_bf16 v[24:27], v[144:147], v[80:83], v[24:27]
    v_mfma_f32_16x16x32_bf16 v[28:31], v[144:147], v[84:87], v[28:31]
    v_mfma_f32_16x16x32_bf16 v[32:35], v[144:147], v[88:91], v[32:35]
    v_mfma_f32_16x16x32_bf16 v[36:39], v[144:147], v[92:95], v[36:39]
    v_mfma_f32_16x16x32_bf16 v[20:23], v[148:151], v[72:75], v[20:23]
    v_mfma_f32_16x16x32_bf16 v[24:27], v[148:151], v[76:79], v[24:27]
    v_mfma_f32_16x16x32_bf16 v[28:31], v[148:151], v[80:83], v[28:31]
    v_mfma_f32_16x16x32_bf16 v[32:35], v[148:151], v[84:87], v[32:35]
    v_mfma_f32_16x16x32_bf16 v[36:39], v[148:151], v[88:91], v[36:39]
    v_mfma_f32_16x16x32_bf16 v[24:27], v[152:155], v[72:75], v[24:27]
    v_mfma_f32_16x16x32_bf16 v[28:31], v[152:155], v[76:79], v[28:31]
    v_mfma_f32_16x16x32_bf16 v[32:35], v[152:155], v[80:83], v[32:35]
    v_mfma_f32_16x16x32_bf16 v[36:39], v[152:155], v[84:87], v[36:39]
    v_mfma_f32_16x16x32_bf16 v[28:31], v[156:159], v[72:75], v[28:31]
    v_mfma_f32_16x16x32_bf16 v[32:35], v[156:159], v[76:79], v[32:35]
    v_mfma_f32_16x16x32_bf16 v[36:39], v[156:159], v[80:83], v[36:39]
    v_mfma_f32_16x16x32_bf16 v[32:35], v[160:163], v[72:75], v[32:35]
    v_mfma_f32_16x16x32_bf16 v[36:39], v[160:163], v[76:79], v[36:39]
    v_mfma_f32_16x16x32_bf16 v[36:39], v[164:167], v[72:75], v[36:39]
    s_waitcnt lgkmcnt(0)
    ds_read_b128 v[72:75], v3 offset:8384
    ds_read_b128 v[76:79], v3 offset:8896
    ds_read_b128 v[80:83], v3 offset:9408
    ds_read_b128 v[84:87], v3 offset:9920
    ds_read_b128 v[88:91], v3 offset:10432
    ds_read_b128 v[92:95], v3 offset:10944
    ds_read_b128 v[96:99], v3 offset:11456
    ds_read_b128 v[100:103], v3 offset:11968
    v_mfma_f32_16x16x32_bf16 v[8:11], v[104:107], v[40:43], v[8:11]
    v_mfma_f32_16x16x32_bf16 v[12:15], v[104:107], v[44:47], v[12:15]
    v_mfma_f32_16x16x32_bf16 v[16:19], v[104:107], v[48:51], v[16:19]
    v_mfma_f32_16x16x32_bf16 v[20:23], v[104:107], v[52:55], v[20:23]
    v_mfma_f32_16x16x32_bf16 v[24:27], v[104:107], v[56:59], v[24:27]
    v_mfma_f32_16x16x32_bf16 v[28:31], v[104:107], v[60:63], v[28:31]
    v_mfma_f32_16x16x32_bf16 v[32:35], v[104:107], v[64:67], v[32:35]
    v_mfma_f32_16x16x32_bf16 v[36:39], v[104:107], v[68:71], v[36:39]
    v_mfma_f32_16x16x32_bf16 v[12:15], v[108:111], v[40:43], v[12:15]
    v_mfma_f32_16x16x32_bf16 v[16:19], v[108:111], v[44:47], v[16:19]
    v_mfma_f32_16x16x32_bf16 v[20:23], v[108:111], v[48:51], v[20:23]
    v_mfma_f32_16x16x32_bf16 v[24:27], v[108:111], v[52:55], v[24:27]
    s_waitcnt lgkmcnt(7)
    ds_read2_b32 v[136:137], v7 offset0:128 offset1:129
    ds_read2_b32 v[138:139], v7 offset0:130 offset1:131
    ds_read2_b32 v[140:141], v7 offset0:0 offset1:1
    ds_read2_b32 v[142:143], v7 offset0:2 offset1:3
    ds_read2_b32 v[144:145], v6 offset0:128 offset1:129
    ds_read2_b32 v[146:147], v6 offset0:130 offset1:131
    ds_read2_b32 v[148:149], v6 offset0:0 offset1:1
    ds_read2_b32 v[150:151], v6 offset0:2 offset1:3
    s_waitcnt lgkmcnt(7)
    ds_read2_b32 v[152:153], v5 offset0:128 offset1:129
    ds_read2_b32 v[154:155], v5 offset0:130 offset1:131
    ds_read2_b32 v[156:157], v5 offset0:0 offset1:1
    ds_read2_b32 v[158:159], v5 offset0:2 offset1:3
    ds_read2_b32 v[160:161], v4 offset0:128 offset1:129
    ds_read2_b32 v[162:163], v4 offset0:130 offset1:131
    ds_read2_b32 v[164:165], v4 offset0:0 offset1:1
    ds_read2_b32 v[166:167], v4 offset0:2 offset1:3
    v_mfma_f32_16x16x32_bf16 v[28:31], v[108:111], v[56:59], v[28:31]
    v_mfma_f32_16x16x32_bf16 v[32:35], v[108:111], v[60:63], v[32:35]
    v_mfma_f32_16x16x32_bf16 v[36:39], v[108:111], v[64:67], v[36:39]
    v_mfma_f32_16x16x32_bf16 v[16:19], v[112:115], v[40:43], v[16:19]
    v_mfma_f32_16x16x32_bf16 v[20:23], v[112:115], v[44:47], v[20:23]
    v_mfma_f32_16x16x32_bf16 v[24:27], v[112:115], v[48:51], v[24:27]
    v_mfma_f32_16x16x32_bf16 v[28:31], v[112:115], v[52:55], v[28:31]
    v_mfma_f32_16x16x32_bf16 v[32:35], v[112:115], v[56:59], v[32:35]
    v_mfma_f32_16x16x32_bf16 v[36:39], v[112:115], v[60:63], v[36:39]
    v_mfma_f32_16x16x32_bf16 v[20:23], v[116:119], v[40:43], v[20:23]
    v_mfma_f32_16x16x32_bf16 v[24:27], v[116:119], v[44:47], v[24:27]
    v_mfma_f32_16x16x32_bf16 v[28:31], v[116:119], v[48:51], v[28:31]
    v_mfma_f32_16x16x32_bf16 v[32:35], v[116:119], v[52:55], v[32:35]
    v_mfma_f32_16x16x32_bf16 v[36:39], v[116:119], v[56:59], v[36:39]
    v_mfma_f32_16x16x32_bf16 v[24:27], v[120:123], v[40:43], v[24:27]
    v_mfma_f32_16x16x32_bf16 v[28:31], v[120:123], v[44:47], v[28:31]
    v_mfma_f32_16x16x32_bf16 v[32:35], v[120:123], v[48:51], v[32:35]
    v_mfma_f32_16x16x32_bf16 v[36:39], v[120:123], v[52:55], v[36:39]
    v_mfma_f32_16x16x32_bf16 v[28:31], v[124:127], v[40:43], v[28:31]
    v_mfma_f32_16x16x32_bf16 v[32:35], v[124:127], v[44:47], v[32:35]
    v_mfma_f32_16x16x32_bf16 v[36:39], v[124:127], v[48:51], v[36:39]
    v_mfma_f32_16x16x32_bf16 v[32:35], v[128:131], v[40:43], v[32:35]
    v_mfma_f32_16x16x32_bf16 v[36:39], v[128:131], v[44:47], v[36:39]
    v_mfma_f32_16x16x32_bf16 v[36:39], v[132:135], v[40:43], v[36:39]
    s_waitcnt lgkmcnt(0)
    v_mfma_f32_16x16x32_bf16 v[8:11], v[136:139], v[72:75], v[8:11]
    v_mfma_f32_16x16x32_bf16 v[12:15], v[136:139], v[76:79], v[12:15]
    v_mfma_f32_16x16x32_bf16 v[16:19], v[136:139], v[80:83], v[16:19]
    v_mfma_f32_16x16x32_bf16 v[20:23], v[136:139], v[84:87], v[20:23]
    v_mfma_f32_16x16x32_bf16 v[24:27], v[136:139], v[88:91], v[24:27]
    v_mfma_f32_16x16x32_bf16 v[28:31], v[136:139], v[92:95], v[28:31]
    v_mfma_f32_16x16x32_bf16 v[32:35], v[136:139], v[96:99], v[32:35]
    v_mfma_f32_16x16x32_bf16 v[36:39], v[136:139], v[100:103], v[36:39]
    v_mfma_f32_16x16x32_bf16 v[12:15], v[140:143], v[72:75], v[12:15]
    v_mfma_f32_16x16x32_bf16 v[16:19], v[140:143], v[76:79], v[16:19]
    v_mfma_f32_16x16x32_bf16 v[20:23], v[140:143], v[80:83], v[20:23]
    v_mfma_f32_16x16x32_bf16 v[24:27], v[140:143], v[84:87], v[24:27]
    v_mfma_f32_16x16x32_bf16 v[28:31], v[140:143], v[88:91], v[28:31]
    v_mfma_f32_16x16x32_bf16 v[32:35], v[140:143], v[92:95], v[32:35]
    v_mfma_f32_16x16x32_bf16 v[36:39], v[140:143], v[96:99], v[36:39]
    v_mfma_f32_16x16x32_bf16 v[16:19], v[144:147], v[72:75], v[16:19]
    v_mfma_f32_16x16x32_bf16 v[20:23], v[144:147], v[76:79], v[20:23]
    v_mfma_f32_16x16x32_bf16 v[24:27], v[144:147], v[80:83], v[24:27]
    v_mfma_f32_16x16x32_bf16 v[28:31], v[144:147], v[84:87], v[28:31]
    v_mfma_f32_16x16x32_bf16 v[32:35], v[144:147], v[88:91], v[32:35]
    v_mfma_f32_16x16x32_bf16 v[36:39], v[144:147], v[92:95], v[36:39]
    v_mfma_f32_16x16x32_bf16 v[20:23], v[148:151], v[72:75], v[20:23]
    v_mfma_f32_16x16x32_bf16 v[24:27], v[148:151], v[76:79], v[24:27]
    v_mfma_f32_16x16x32_bf16 v[28:31], v[148:151], v[80:83], v[28:31]
    v_mfma_f32_16x16x32_bf16 v[32:35], v[148:151], v[84:87], v[32:35]
    v_mfma_f32_16x16x32_bf16 v[36:39], v[148:151], v[88:91], v[36:39]
    v_mfma_f32_16x16x32_bf16 v[24:27], v[152:155], v[72:75], v[24:27]
    v_mfma_f32_16x16x32_bf16 v[28:31], v[152:155], v[76:79], v[28:31]
    v_mfma_f32_16x16x32_bf16 v[32:35], v[152:155], v[80:83], v[32:35]
    v_mfma_f32_16x16x32_bf16 v[36:39], v[152:155], v[84:87], v[36:39]
    v_mfma_f32_16x16x32_bf16 v[28:31], v[156:159], v[72:75], v[28:31]
    v_mfma_f32_16x16x32_bf16 v[32:35], v[156:159], v[76:79], v[32:35]
    v_mfma_f32_16x16x32_bf16 v[36:39], v[156:159], v[80:83], v[36:39]
    v_mfma_f32_16x16x32_bf16 v[32:35], v[160:163], v[72:75], v[32:35]
    v_mfma_f32_16x16x32_bf16 v[36:39], v[160:163], v[76:79], v[36:39]
    v_mfma_f32_16x16x32_bf16 v[36:39], v[164:167], v[72:75], v[36:39]
    s_waitcnt lgkmcnt(0)
    s_lshl_b32 s38, s38, 16
    v_lshrrev_b32 v41, 4, v1
    v_and_b32 v40, 15, v1
    v_lshlrev_b32 v40, 4, v40
    v_lshl_add_u32 v40, v41, 2, v40
    v_mul_u32_u24 v42, 12960, v2
    v_lshl_add_u32 v42, v40, 1, v42
    ds_read_b64 v[48:49], v42 offset:8864
    ds_read_b64 v[50:51], v42 offset:9376
    ds_read_b64 v[52:53], v42 offset:9888
    ds_read_b64 v[54:55], v42 offset:10400
    ds_read_b64 v[56:57], v42 offset:10912
    ds_read_b64 v[58:59], v42 offset:11424
    ds_read_b64 v[60:61], v42 offset:11936
    ds_read_b64 v[62:63], v42 offset:12448
    v_lshl_add_u32 v43, v40, 2, v2
    v_lshlrev_b32 v43, 1, v43
    s_waitcnt lgkmcnt(0)
    s_barrier
    v_cvt_pk_bf16_f32 v64, v8, v9
    v_lshlrev_b32 v65, 16, v48
    v_and_b32 v66, 0xffff0000, v48
    v_mul_f32 v65, s38, v65
    v_mul_f32 v66, s38, v66
    v_cvt_pk_bf16_f32 v65, v65, v66
    v_lshlrev_b32 v66, 16, v65
    v_and_b32 v67, 0xffff0000, v65
    v_lshlrev_b32 v68, 16, v64
    v_and_b32 v69, 0xffff0000, v64
    v_add_f32 v66, v66, v68
    v_add_f32 v67, v67, v69
    v_cvt_pk_bf16_f32 v70, v66, v67
    ds_write_b16 v43, v70 offset:0
    ds_write_b16_d16_hi v43, v70 offset:8
    v_cvt_pk_bf16_f32 v64, v10, v11
    v_lshlrev_b32 v65, 16, v49
    v_and_b32 v66, 0xffff0000, v49
    v_mul_f32 v65, s38, v65
    v_mul_f32 v66, s38, v66
    v_cvt_pk_bf16_f32 v65, v65, v66
    v_lshlrev_b32 v66, 16, v65
    v_and_b32 v67, 0xffff0000, v65
    v_lshlrev_b32 v68, 16, v64
    v_and_b32 v69, 0xffff0000, v64
    v_add_f32 v66, v66, v68
    v_add_f32 v67, v67, v69
    v_cvt_pk_bf16_f32 v71, v66, v67
    ds_write_b16 v43, v71 offset:16
    ds_write_b16_d16_hi v43, v71 offset:24
    v_cvt_pk_bf16_f32 v64, v12, v13
    v_lshlrev_b32 v65, 16, v50
    v_and_b32 v66, 0xffff0000, v50
    v_mul_f32 v65, s38, v65
    v_mul_f32 v66, s38, v66
    v_cvt_pk_bf16_f32 v65, v65, v66
    v_lshlrev_b32 v66, 16, v65
    v_and_b32 v67, 0xffff0000, v65
    v_lshlrev_b32 v68, 16, v64
    v_and_b32 v69, 0xffff0000, v64
    v_add_f32 v66, v66, v68
    v_add_f32 v67, v67, v69
    v_cvt_pk_bf16_f32 v70, v66, v67
    ds_write_b16 v43, v70 offset:2048
    ds_write_b16_d16_hi v43, v70 offset:2056
    v_cvt_pk_bf16_f32 v64, v14, v15
    v_lshlrev_b32 v65, 16, v51
    v_and_b32 v66, 0xffff0000, v51
    v_mul_f32 v65, s38, v65
    v_mul_f32 v66, s38, v66
    v_cvt_pk_bf16_f32 v65, v65, v66
    v_lshlrev_b32 v66, 16, v65
    v_and_b32 v67, 0xffff0000, v65
    v_lshlrev_b32 v68, 16, v64
    v_and_b32 v69, 0xffff0000, v64
    v_add_f32 v66, v66, v68
    v_add_f32 v67, v67, v69
    v_cvt_pk_bf16_f32 v71, v66, v67
    ds_write_b16 v43, v71 offset:2064
    ds_write_b16_d16_hi v43, v71 offset:2072
    v_cvt_pk_bf16_f32 v64, v16, v17
    v_lshlrev_b32 v65, 16, v52
    v_and_b32 v66, 0xffff0000, v52
    v_mul_f32 v65, s38, v65
    v_mul_f32 v66, s38, v66
    v_cvt_pk_bf16_f32 v65, v65, v66
    v_lshlrev_b32 v66, 16, v65
    v_and_b32 v67, 0xffff0000, v65
    v_lshlrev_b32 v68, 16, v64
    v_and_b32 v69, 0xffff0000, v64
    v_add_f32 v66, v66, v68
    v_add_f32 v67, v67, v69
    v_cvt_pk_bf16_f32 v70, v66, v67
    ds_write_b16 v43, v70 offset:4096
    ds_write_b16_d16_hi v43, v70 offset:4104
    v_cvt_pk_bf16_f32 v64, v18, v19
    v_lshlrev_b32 v65, 16, v53
    v_and_b32 v66, 0xffff0000, v53
    v_mul_f32 v65, s38, v65
    v_mul_f32 v66, s38, v66
    v_cvt_pk_bf16_f32 v65, v65, v66
    v_lshlrev_b32 v66, 16, v65
    v_and_b32 v67, 0xffff0000, v65
    v_lshlrev_b32 v68, 16, v64
    v_and_b32 v69, 0xffff0000, v64
    v_add_f32 v66, v66, v68
    v_add_f32 v67, v67, v69
    v_cvt_pk_bf16_f32 v71, v66, v67
    ds_write_b16 v43, v71 offset:4112
    ds_write_b16_d16_hi v43, v71 offset:4120
    v_cvt_pk_bf16_f32 v64, v20, v21
    v_lshlrev_b32 v65, 16, v54
    v_and_b32 v66, 0xffff0000, v54
    v_mul_f32 v65, s38, v65
    v_mul_f32 v66, s38, v66
    v_cvt_pk_bf16_f32 v65, v65, v66
    v_lshlrev_b32 v66, 16, v65
    v_and_b32 v67, 0xffff0000, v65
    v_lshlrev_b32 v68, 16, v64
    v_and_b32 v69, 0xffff0000, v64
    v_add_f32 v66, v66, v68
    v_add_f32 v67, v67, v69
    v_cvt_pk_bf16_f32 v70, v66, v67
    ds_write_b16 v43, v70 offset:6144
    ds_write_b16_d16_hi v43, v70 offset:6152
    v_cvt_pk_bf16_f32 v64, v22, v23
    v_lshlrev_b32 v65, 16, v55
    v_and_b32 v66, 0xffff0000, v55
    v_mul_f32 v65, s38, v65
    v_mul_f32 v66, s38, v66
    v_cvt_pk_bf16_f32 v65, v65, v66
    v_lshlrev_b32 v66, 16, v65
    v_and_b32 v67, 0xffff0000, v65
    v_lshlrev_b32 v68, 16, v64
    v_and_b32 v69, 0xffff0000, v64
    v_add_f32 v66, v66, v68
    v_add_f32 v67, v67, v69
    v_cvt_pk_bf16_f32 v71, v66, v67
    ds_write_b16 v43, v71 offset:6160
    ds_write_b16_d16_hi v43, v71 offset:6168
    v_cvt_pk_bf16_f32 v64, v24, v25
    v_lshlrev_b32 v65, 16, v56
    v_and_b32 v66, 0xffff0000, v56
    v_mul_f32 v65, s38, v65
    v_mul_f32 v66, s38, v66
    v_cvt_pk_bf16_f32 v65, v65, v66
    v_lshlrev_b32 v66, 16, v65
    v_and_b32 v67, 0xffff0000, v65
    v_lshlrev_b32 v68, 16, v64
    v_and_b32 v69, 0xffff0000, v64
    v_add_f32 v66, v66, v68
    v_add_f32 v67, v67, v69
    v_cvt_pk_bf16_f32 v70, v66, v67
    ds_write_b16 v43, v70 offset:8192
    ds_write_b16_d16_hi v43, v70 offset:8200
    v_cvt_pk_bf16_f32 v64, v26, v27
    v_lshlrev_b32 v65, 16, v57
    v_and_b32 v66, 0xffff0000, v57
    v_mul_f32 v65, s38, v65
    v_mul_f32 v66, s38, v66
    v_cvt_pk_bf16_f32 v65, v65, v66
    v_lshlrev_b32 v66, 16, v65
    v_and_b32 v67, 0xffff0000, v65
    v_lshlrev_b32 v68, 16, v64
    v_and_b32 v69, 0xffff0000, v64
    v_add_f32 v66, v66, v68
    v_add_f32 v67, v67, v69
    v_cvt_pk_bf16_f32 v71, v66, v67
    ds_write_b16 v43, v71 offset:8208
    ds_write_b16_d16_hi v43, v71 offset:8216
    v_cvt_pk_bf16_f32 v64, v28, v29
    v_lshlrev_b32 v65, 16, v58
    v_and_b32 v66, 0xffff0000, v58
    v_mul_f32 v65, s38, v65
    v_mul_f32 v66, s38, v66
    v_cvt_pk_bf16_f32 v65, v65, v66
    v_lshlrev_b32 v66, 16, v65
    v_and_b32 v67, 0xffff0000, v65
    v_lshlrev_b32 v68, 16, v64
    v_and_b32 v69, 0xffff0000, v64
    v_add_f32 v66, v66, v68
    v_add_f32 v67, v67, v69
    v_cvt_pk_bf16_f32 v70, v66, v67
    ds_write_b16 v43, v70 offset:10240
    ds_write_b16_d16_hi v43, v70 offset:10248
    v_cvt_pk_bf16_f32 v64, v30, v31
    v_lshlrev_b32 v65, 16, v59
    v_and_b32 v66, 0xffff0000, v59
    v_mul_f32 v65, s38, v65
    v_mul_f32 v66, s38, v66
    v_cvt_pk_bf16_f32 v65, v65, v66
    v_lshlrev_b32 v66, 16, v65
    v_and_b32 v67, 0xffff0000, v65
    v_lshlrev_b32 v68, 16, v64
    v_and_b32 v69, 0xffff0000, v64
    v_add_f32 v66, v66, v68
    v_add_f32 v67, v67, v69
    v_cvt_pk_bf16_f32 v71, v66, v67
    ds_write_b16 v43, v71 offset:10256
    ds_write_b16_d16_hi v43, v71 offset:10264
    v_cvt_pk_bf16_f32 v64, v32, v33
    v_lshlrev_b32 v65, 16, v60
    v_and_b32 v66, 0xffff0000, v60
    v_mul_f32 v65, s38, v65
    v_mul_f32 v66, s38, v66
    v_cvt_pk_bf16_f32 v65, v65, v66
    v_lshlrev_b32 v66, 16, v65
    v_and_b32 v67, 0xffff0000, v65
    v_lshlrev_b32 v68, 16, v64
    v_and_b32 v69, 0xffff0000, v64
    v_add_f32 v66, v66, v68
    v_add_f32 v67, v67, v69
    v_cvt_pk_bf16_f32 v70, v66, v67
    ds_write_b16 v43, v70 offset:12288
    ds_write_b16_d16_hi v43, v70 offset:12296
    v_cvt_pk_bf16_f32 v64, v34, v35
    v_lshlrev_b32 v65, 16, v61
    v_and_b32 v66, 0xffff0000, v61
    v_mul_f32 v65, s38, v65
    v_mul_f32 v66, s38, v66
    v_cvt_pk_bf16_f32 v65, v65, v66
    v_lshlrev_b32 v66, 16, v65
    v_and_b32 v67, 0xffff0000, v65
    v_lshlrev_b32 v68, 16, v64
    v_and_b32 v69, 0xffff0000, v64
    v_add_f32 v66, v66, v68
    v_add_f32 v67, v67, v69
    v_cvt_pk_bf16_f32 v71, v66, v67
    ds_write_b16 v43, v71 offset:12304
    ds_write_b16_d16_hi v43, v71 offset:12312
    v_cvt_pk_bf16_f32 v64, v36, v37
    v_lshlrev_b32 v65, 16, v62
    v_and_b32 v66, 0xffff0000, v62
    v_mul_f32 v65, s38, v65
    v_mul_f32 v66, s38, v66
    v_cvt_pk_bf16_f32 v65, v65, v66
    v_lshlrev_b32 v66, 16, v65
    v_and_b32 v67, 0xffff0000, v65
    v_lshlrev_b32 v68, 16, v64
    v_and_b32 v69, 0xffff0000, v64
    v_add_f32 v66, v66, v68
    v_add_f32 v67, v67, v69
    v_cvt_pk_bf16_f32 v70, v66, v67
    ds_write_b16 v43, v70 offset:14336
    ds_write_b16_d16_hi v43, v70 offset:14344
    v_cvt_pk_bf16_f32 v64, v38, v39
    v_lshlrev_b32 v65, 16, v63
    v_and_b32 v66, 0xffff0000, v63
    v_mul_f32 v65, s38, v65
    v_mul_f32 v66, s38, v66
    v_cvt_pk_bf16_f32 v65, v65, v66
    v_lshlrev_b32 v66, 16, v65
    v_and_b32 v67, 0xffff0000, v65
    v_lshlrev_b32 v68, 16, v64
    v_and_b32 v69, 0xffff0000, v64
    v_add_f32 v66, v66, v68
    v_add_f32 v67, v67, v69
    v_cvt_pk_bf16_f32 v71, v66, v67
    ds_write_b16 v43, v71 offset:14352
    ds_write_b16_d16_hi v43, v71 offset:14360
    s_waitcnt lgkmcnt(0)
    s_barrier
    v_lshlrev_b32 v40, 3, v0
    ds_read_b64 v[48:49], v40 offset:0
    ds_read_b64 v[50:51], v40 offset:2048
    ds_read_b64 v[52:53], v40 offset:4096
    ds_read_b64 v[54:55], v40 offset:6144
    ds_read_b64 v[56:57], v40 offset:8192
    ds_read_b64 v[58:59], v40 offset:10240
    ds_read_b64 v[60:61], v40 offset:12288
    ds_read_b64 v[62:63], v40 offset:14336
    v_lshlrev_b32 v41, 12, v0
    s_waitcnt lgkmcnt(0)
    s_add_u32 s39, s27, 0
    buffer_store_dwordx2 v[48:49], v41, s[8:11], s39 offen
    s_add_u32 s39, s27, 1048576
    buffer_store_dwordx2 v[50:51], v41, s[8:11], s39 offen
    s_add_u32 s39, s27, 2097152
    buffer_store_dwordx2 v[52:53], v41, s[8:11], s39 offen
    s_add_u32 s39, s27, 3145728
    buffer_store_dwordx2 v[54:55], v41, s[8:11], s39 offen
    s_add_u32 s39, s27, 4194304
    buffer_store_dwordx2 v[56:57], v41, s[8:11], s39 offen
    s_add_u32 s39, s27, 5242880
    buffer_store_dwordx2 v[58:59], v41, s[8:11], s39 offen
    s_add_u32 s39, s27, 6291456
    buffer_store_dwordx2 v[60:61], v41, s[8:11], s39 offen
    s_add_u32 s39, s27, 7340032
    buffer_store_dwordx2 v[62:63], v41, s[8:11], s39 offen
k3_kernel_b0_end:
    s_endpgm
k3_kernel_r1:
    s_sub_u32 s2, s2, 256
    s_cmp_ge_u32 s2, 256
    s_cbranch_scc1 k3_kernel_b1_end
    s_load_dwordx2 s[16:17], s[0:1], 96
    s_load_dwordx2 s[18:19], s[0:1], 112
    s_mov_b32 s12, 0x3f3504f3
    s_mov_b32 s13, 0x3f3504f3
    s_mov_b32 s14, 0x3f6c835e
    s_mov_b32 s15, 0x3ec3ef15
    v_and_b32 v1, 63, v0
    v_lshrrev_b32 v2, 6, v0
    s_waitcnt lgkmcnt(0)
    s_mov_b32 s4, s16
    s_and_b32 s5, s17, 0xffff
    s_mov_b32 s6, 8388608
    s_mov_b32 s7, 0x00020000
    s_add_u32 s8, s18, 9437184
    s_addc_u32 s9, s19, 0
    s_and_b32 s9, s9, 0xffff
    s_mov_b32 s10, 8404992
    s_mov_b32 s11, 0x00020000
    v_and_b32 v8, 7, v0
    v_lshrrev_b32 v9, 3, v0
    v_mul_u32_u24 v10, 4640, v8
    v_lshl_add_u32 v10, v9, 3, v10
    v_lshlrev_b32 v11, 14, v9
    v_lshl_add_u32 v11, v8, 3, v11
    s_lshl_b32 s20, s2, 6
    v_add_u32 v11, s20, v11
    s_mov_b32 s21, 0
    buffer_load_dwordx2 v[16:17], v11, s[8:11], s21 offen
    s_mov_b32 s21, 524288
    buffer_load_dwordx2 v[18:19], v11, s[8:11], s21 offen
    s_mov_b32 s21, 1048576
    buffer_load_dwordx2 v[20:21], v11, s[8:11], s21 offen
    s_mov_b32 s21, 1572864
    buffer_load_dwordx2 v[22:23], v11, s[8:11], s21 offen
    s_mov_b32 s21, 2097152
    buffer_load_dwordx2 v[24:25], v11, s[8:11], s21 offen
    s_mov_b32 s21, 2621440
    buffer_load_dwordx2 v[26:27], v11, s[8:11], s21 offen
    s_mov_b32 s21, 3145728
    buffer_load_dwordx2 v[28:29], v11, s[8:11], s21 offen
    s_mov_b32 s21, 3670016
    buffer_load_dwordx2 v[30:31], v11, s[8:11], s21 offen
    s_mov_b32 s21, 4194304
    buffer_load_dwordx2 v[32:33], v11, s[8:11], s21 offen
    s_mov_b32 s21, 4718592
    buffer_load_dwordx2 v[34:35], v11, s[8:11], s21 offen
    s_mov_b32 s21, 5242880
    buffer_load_dwordx2 v[36:37], v11, s[8:11], s21 offen
    s_mov_b32 s21, 5767168
    buffer_load_dwordx2 v[38:39], v11, s[8:11], s21 offen
    s_mov_b32 s21, 6291456
    buffer_load_dwordx2 v[40:41], v11, s[8:11], s21 offen
    s_mov_b32 s21, 6815744
    buffer_load_dwordx2 v[42:43], v11, s[8:11], s21 offen
    s_mov_b32 s21, 7340032
    buffer_load_dwordx2 v[44:45], v11, s[8:11], s21 offen
    s_mov_b32 s21, 7864320
    buffer_load_dwordx2 v[46:47], v11, s[8:11], s21 offen
    s_mov_b32 s21, 8388608
    buffer_load_dwordx2 v[48:49], v11, s[8:11], s21 offen
    s_waitcnt vmcnt(0)
    v_cmp_gt_u32 vcc, 8, v0
    s_nop 1
    v_cndmask_b32 v17, v17, 0, vcc
    v_mov_b32 v49, 0
    ds_write_b64 v10, v[16:17] offset:0
    ds_write_b64 v10, v[18:19] offset:256
    ds_write_b64 v10, v[20:21] offset:512
    ds_write_b64 v10, v[22:23] offset:768
    ds_write_b64 v10, v[24:25] offset:1024
    ds_write_b64 v10, v[26:27] offset:1280
    ds_write_b64 v10, v[28:29] offset:1536
    ds_write_b64 v10, v[30:31] offset:1792
    ds_write_b64 v10, v[32:33] offset:2048
    ds_write_b64 v10, v[34:35] offset:2304
    ds_write_b64 v10, v[36:37] offset:2560
    ds_write_b64 v10, v[38:39] offset:2816
    ds_write_b64 v10, v[40:41] offset:3072
    ds_write_b64 v10, v[42:43] offset:3328
    ds_write_b64 v10, v[44:45] offset:3584
    ds_write_b64 v10, v[46:47] offset:3840
    s_and_saveexec_b64 s[22:23], vcc
    ds_write_b64 v10, v[48:49] offset:4096
    s_mov_b64 exec, s[22:23]
    s_waitcnt lgkmcnt(0)
    s_barrier
    v_mul_u32_u24 v80, 9280, v2
    v_cvt_f32_u32 v72, v1
    v_mul_f32 v73, 0xbb000000, v72
    v_cos_f32 v44, v73
    v_sin_f32 v45, v73
    v_mul_f32 v73, 0xbb800000, v72
    v_cos_f32 v46, v73
    v_sin_f32 v47, v73
    v_mul_f32 v73, 0xbbc00000, v72
    v_cos_f32 v48, v73
    v_sin_f32 v49, v73
    v_mul_f32 v73, 0xbc000000, v72
    v_cos_f32 v50, v73
    v_sin_f32 v51, v73
    v_mul_f32 v73, 0xbc200000, v72
    v_cos_f32 v52, v73
    v_sin_f32 v53, v73
    v_mul_f32 v73, 0xbc400000, v72
    v_cos_f32 v54, v73
    v_sin_f32 v55, v73
    v_mul_f32 v73, 0xbc600000, v72
    v_cos_f32 v56, v73
    v_sin_f32 v57, v73
    v_and_b32 v74, 7, v1
    v_cvt_f32_u32 v72, v74
    v_mul_f32 v73, 0xbc800000, v72
    v_cos_f32 v58, v73
    v_sin_f32 v59, v73
    v_mul_f32 v73, 0xbd000000, v72
    v_cos_f32 v60, v73
    v_sin_f32 v61, v73
    v_mul_f32 v73, 0xbd400000, v72
    v_cos_f32 v62, v73
    v_sin_f32 v63, v73
    v_mul_f32 v73, 0xbd800000, v72
    v_cos_f32 v64, v73
    v_sin_f32 v65, v73
    v_mul_f32 v73, 0xbda00000, v72
    v_cos_f32 v66, v73
    v_sin_f32 v67, v73
    v_mul_f32 v73, 0xbdc00000, v72
    v_cos_f32 v68, v73
    v_sin_f32 v69, v73
    v_mul_f32 v73, 0xbde00000, v72
    v_cos_f32 v70, v73
    v_sin_f32 v71, v73
    v_lshl_add_u32 v76, v1, 3, v80
    v_lshrrev_b32 v72, 3, v1
    v_mul_u32_u24 v73, 576, v72
    v_lshl_add_u32 v77, v74, 3, v73
    v_add_u32 v77, v77, v80
    v_mov_b32 v78, v76
    v_mul_u32_u24 v73, 520, v72
    v_lshl_add_u32 v79, v74, 6, v73
    v_add_u32 v79, v79, v80
    v_lshlrev_b32 v81, 3, v1
    v_sub_u32 v81, v80, v81
    v_cvt_f32_u32 v72, v1
    v_mul_f32 v72, 0x3a800000, v72
    ds_read_b64 v[8:9], v76 offset:0
    ds_read_b64 v[84:85], v81 offset:4096
    ds_read_b64 v[24:25], v76 offset:4640
    ds_read_b64 v[86:87], v81 offset:8736
    v_add_f32 v73, 0x0, v72
    v_cos_f32 v88, v73
    v_sin_f32 v89, v73
    s_waitcnt lgkmcnt(0)
    v_pk_add_f32 v[90:91], v[8:9], v[84:85] neg_lo:[0,1]
    v_pk_add_f32 v[8:9], v[8:9], v[84:85] neg_hi:[0,1]
    v_pk_mul_f32 v[40:41], v[90:91], v[88:89] op_sel:[0,0] op_sel_hi:[0,1] neg_hi:[0,0]
    v_pk_fma_f32 v[84:85], v[90:91], v[88:89], v[40:41] op_sel:[1,1,0] op_sel_hi:[1,0,1] neg_lo:[0,1,0]
    v_pk_add_f32 v[8:9], v[8:9], v[84:85] op_sel:[0,1] op_sel_hi:[1,0] neg_lo:[0,1]
    v_pk_add_f32 v[90:91], v[24:25], v[86:87] neg_lo:[0,1]
    v_pk_add_f32 v[24:25], v[24:25], v[86:87] neg_hi:[0,1]
    v_pk_mul_f32 v[40:41], v[90:91], v[88:89] op_sel:[0,0] op_sel_hi:[0,1] neg_hi:[0,0]
    v_pk_fma_f32 v[86:87], v[90:91], v[88:89], v[40:41] op_sel:[1,1,0] op_sel_hi:[1,0,1] neg_lo:[0,1,0]
    v_pk_add_f32 v[24:25], v[24:25], v[86:87] op_sel:[0,1] op_sel_hi:[1,0] neg_lo:[0,1]
    ds_read_b64 v[10:11], v76 offset:512
    ds_read_b64 v[84:85], v81 offset:3584
    ds_read_b64 v[26:27], v76 offset:5152
    ds_read_b64 v[86:87], v81 offset:8224
    v_add_f32 v73, 0x3d800000, v72
    v_cos_f32 v88, v73
    v_sin_f32 v89, v73
    s_waitcnt lgkmcnt(0)
    v_pk_add_f32 v[90:91], v[10:11], v[84:85] neg_lo:[0,1]
    v_pk_add_f32 v[10:11], v[10:11], v[84:85] neg_hi:[0,1]
    v_pk_mul_f32 v[40:41], v[90:91], v[88:89] op_sel:[0,0] op_sel_hi:[0,1] neg_hi:[0,0]
    v_pk_fma_f32 v[84:85], v[90:91], v[88:89], v[40:41] op_sel:[1,1,0] op_sel_hi:[1,0,1] neg_lo:[0,1,0]
    v_pk_add_f32 v[10:11], v[10:11], v[84:85] op_sel:[0,1] op_sel_hi:[1,0] neg_lo:[0,1]
    v_pk_add_f32 v[90:91], v[26:27], v[86:87] neg_lo:[0,1]
    v_pk_add_f32 v[26:27], v[26:27], v[86:87] neg_hi:[0,1]
    v_pk_mul_f32 v[40:41], v[90:91], v[88:89] op_sel:[0,0] op_sel_hi:[0,1] neg_hi:[0,0]
    v_pk_fma_f32 v[86:87], v[90:91], v[88:89], v[40:41] op_sel:[1,1,0] op_sel_hi:[1,0,1] neg_lo:[0,1,0]
    v_pk_add_f32 v[26:27], v[26:27], v[86:87] op_sel:[0,1] op_sel_hi:[1,0] neg_lo:[0,1]
    ds_read_b64 v[12:13], v76 offset:1024
    ds_read_b64 v[84:85], v81 offset:3072
    ds_read_b64 v[28:29], v76 offset:5664
    ds_read_b64 v[86:87], v81 offset:7712
    v_add_f32 v73, 0x3e000000, v72
    v_cos_f32 v88, v73
    v_sin_f32 v89, v73
    s_waitcnt lgkmcnt(0)
    v_pk_add_f32 v[90:91], v[12:13], v[84:85] neg_lo:[0,1]
    v_pk_add_f32 v[12:13], v[12:13], v[84:85] neg_hi:[0,1]
    v_pk_mul_f32 v[40:41], v[90:91], v[88:89] op_sel:[0,0] op_sel_hi:[0,1] neg_hi:[0,0]
    v_pk_fma_f32 v[84:85], v[90:91], v[88:89], v[40:41] op_sel:[1,1,0] op_sel_hi:[1,0,1] neg_lo:[0,1,0]
    v_pk_add_f32 v[12:13], v[12:13], v[84:85] op_sel:[0,1] op_sel_hi:[1,0] neg_lo:[0,1]
    v_pk_add_f32 v[90:91], v[28:29], v[86:87] neg_lo:[0,1]
    v_pk_add_f32 v[28:29], v[28:29], v[86:87] neg_hi:[0,1]
    v_pk_mul_f32 v[40:41], v[90:91], v[88:89] op_sel:[0,0] op_sel_hi:[0,1] neg_hi:[0,0]
    v_pk_fma_f32 v[86:87], v[90:91], v[88:89], v[40:41] op_sel:[1,1,0] op_sel_hi:[1,0,1] neg_lo:[0,1,0]
    v_pk_add_f32 v[28:29], v[28:29], v[86:87] op_sel:[0,1] op_sel_hi:[1,0] neg_lo:[0,1]
    ds_read_b64 v[14:15], v76 offset:1536
    ds_read_b64 v[84:85], v81 offset:2560
    ds_read_b64 v[30:31], v76 offset:6176
    ds_read_b64 v[86:87], v81 offset:7200
    v_add_f32 v73, 0x3e400000, v72
    v_cos_f32 v88, v73
    v_sin_f32 v89, v73
    s_waitcnt lgkmcnt(0)
    v_pk_add_f32 v[90:91], v[14:15], v[84:85] neg_lo:[0,1]
    v_pk_add_f32 v[14:15], v[14:15], v[84:85] neg_hi:[0,1]
    v_pk_mul_f32 v[40:41], v[90:91], v[88:89] op_sel:[0,0] op_sel_hi:[0,1] neg_hi:[0,0]
    v_pk_fma_f32 v[84:85], v[90:91], v[88:89], v[40:41] op_sel:[1,1,0] op_sel_hi:[1,0,1] neg_lo:[0,1,0]
    v_pk_add_f32 v[14:15], v[14:15], v[84:85] op_sel:[0,1] op_sel_hi:[1,0] neg_lo:[0,1]
    v_pk_add_f32 v[90:91], v[30:31], v[86:87] neg_lo:[0,1]
    v_pk_add_f32 v[30:31], v[30:31], v[86:87] neg_hi:[0,1]
    v_pk_mul_f32 v[40:41], v[90:91], v[88:89] op_sel:[0,0] op_sel_hi:[0,1] neg_hi:[0,0]
    v_pk_fma_f32 v[86:87], v[90:91], v[88:89], v[40:41] op_sel:[1,1,0] op_sel_hi:[1,0,1] neg_lo:[0,1,0]
    v_pk_add_f32 v[30:31], v[30:31], v[86:87] op_sel:[0,1] op_sel_hi:[1,0] neg_lo:[0,1]
    ds_read_b64 v[16:17], v76 offset:2048
    ds_read_b64 v[84:85], v81 offset:2048
    ds_read_b64 v[32:33], v76 offset:6688
    ds_read_b64 v[86:87], v81 offset:6688
    v_add_f32 v73, 0x3e800000, v72
    v_cos_f32 v88, v73
    v_sin_f32 v89, v73
    s_waitcnt lgkmcnt(0)
    v_pk_add_f32 v[90:91], v[16:17], v[84:85] neg_lo:[0,1]
    v_pk_add_f32 v[16:17], v[16:17], v[84:85] neg_hi:[0,1]
    v_pk_mul_f32 v[40:41], v[90:91], v[88:89] op_sel:[0,0] op_sel_hi:[0,1] neg_hi:[0,0]
    v_pk_fma_f32 v[84:85], v[90:91], v[88:89], v[40:41] op_sel:[1,1,0] op_sel_hi:[1,0,1] neg_lo:[0,1,0]
    v_pk_add_f32 v[16:17], v[16:17], v[84:85] op_sel:[0,1] op_sel_hi:[1,0] neg_lo:[0,1]
    v_pk_add_f32 v[90:91], v[32:33], v[86:87] neg_lo:[0,1]
    v_pk_add_f32 v[32:33], v[32:33], v[86:87] neg_hi:[0,1]
    v_pk_mul_f32 v[40:41], v[90:91], v[88:89] op_sel:[0,0] op_sel_hi:[0,1] neg_hi:[0,0]
    v_pk_fma_f32 v[86:87], v[90:91], v[88:89], v[40:41] op_sel:[1,1,0] op_sel_hi:[1,0,1] neg_lo:[0,1,0]
    v_pk_add_f32 v[32:33], v[32:33], v[86:87] op_sel:[0,1] op_sel_hi:[1,0] neg_lo:[0,1]
    ds_read_b64 v[18:19], v76 offset:2560
    ds_read_b64 v[84:85], v81 offset:1536
    ds_read_b64 v[34:35], v76 offset:7200
    ds_read_b64 v[86:87], v81 offset:6176
    v_add_f32 v73, 0x3ea00000, v72
    v_cos_f32 v88, v73
    v_sin_f32 v89, v73
    s_waitcnt lgkmcnt(0)
    v_pk_add_f32 v[90:91], v[18:19], v[84:85] neg_lo:[0,1]
    v_pk_add_f32 v[18:19], v[18:19], v[84:85] neg_hi:[0,1]
    v_pk_mul_f32 v[40:41], v[90:91], v[88:89] op_sel:[0,0] op_sel_hi:[0,1] neg_hi:[0,0]
    v_pk_fma_f32 v[84:85], v[90:91], v[88:89], v[40:41] op_sel:[1,1,0] op_sel_hi:[1,0,1] neg_lo:[0,1,0]
    v_pk_add_f32 v[18:19], v[18:19], v[84:85] op_sel:[0,1] op_sel_hi:[1,0] neg_lo:[0,1]
    v_pk_add_f32 v[90:91], v[34:35], v[86:87] neg_lo:[0,1]
    v_pk_add_f32 v[34:35], v[34:35], v[86:87] neg_hi:[0,1]
    v_pk_mul_f32 v[40:41], v[90:91], v[88:89] op_sel:[0,0] op_sel_hi:[0,1] neg_hi:[0,0]
    v_pk_fma_f32 v[86:87], v[90:91], v[88:89], v[40:41] op_sel:[1,1,0] op_sel_hi:[1,0,1] neg_lo:[0,1,0]
    v_pk_add_f32 v[34:35], v[34:35], v[86:87] op_sel:[0,1] op_sel_hi:[1,0] neg_lo:[0,1]
    ds_read_b64 v[20:21], v76 offset:3072
    ds_read_b64 v[84:85], v81 offset:1024
    ds_read_b64 v[36:37], v76 offset:7712
    ds_read_b64 v[86:87], v81 offset:5664
    v_add_f32 v73, 0x3ec00000, v72
    v_cos_f32 v88, v73
    v_sin_f32 v89, v73
    s_waitcnt lgkmcnt(0)
    v_pk_add_f32 v[90:91], v[20:21], v[84:85] neg_lo:[0,1]
    v_pk_add_f32 v[20:21], v[20:21], v[84:85] neg_hi:[0,1]
    v_pk_mul_f32 v[40:41], v[90:91], v[88:89] op_sel:[0,0] op_sel_hi:[0,1] neg_hi:[0,0]
    v_pk_fma_f32 v[84:85], v[90:91], v[88:89], v[40:41] op_sel:[1,1,0] op_sel_hi:[1,0,1] neg_lo:[0,1,0]
    v_pk_add_f32 v[20:21], v[20:21], v[84:85] op_sel:[0,1] op_sel_hi:[1,0] neg_lo:[0,1]
    v_pk_add_f32 v[90:91], v[36:37], v[86:87] neg_lo:[0,1]
    v_pk_add_f32 v[36:37], v[36:37], v[86:87] neg_hi:[0,1]
    v_pk_mul_f32 v[40:41], v[90:91], v[88:89] op_sel:[0,0] op_sel_hi:[0,1] neg_hi:[0,0]
    v_pk_fma_f32 v[86:87], v[90:91], v[88:89], v[40:41] op_sel:[1,1,0] op_sel_hi:[1,0,1] neg_lo:[0,1,0]
    v_pk_add_f32 v[36:37], v[36:37], v[86:87] op_sel:[0,1] op_sel_hi:[1,0] neg_lo:[0,1]
    ds_read_b64 v[22:23], v76 offset:3584
    ds_read_b64 v[84:85], v81 offset:512
    ds_read_b64 v[38:39], v76 offset:8224
    ds_read_b64 v[86:87], v81 offset:5152
    v_add_f32 v73, 0x3ee00000, v72
    v_cos_f32 v88, v73
    v_sin_f32 v89, v73
    s_waitcnt lgkmcnt(0)
    v_pk_add_f32 v[90:91], v[22:23], v[84:85] neg_lo:[0,1]
    v_pk_add_f32 v[22:23], v[22:23], v[84:85] neg_hi:[0,1]
    v_pk_mul_f32 v[40:41], v[90:91], v[88:89] op_sel:[0,0] op_sel_hi:[0,1] neg_hi:[0,0]
    v_pk_fma_f32 v[84:85], v[90:91], v[88:89], v[40:41] op_sel:[1,1,0] op_sel_hi:[1,0,1] neg_lo:[0,1,0]
    v_pk_add_f32 v[22:23], v[22:23], v[84:85] op_sel:[0,1] op_sel_hi:[1,0] neg_lo:[0,1]
    v_pk_add_f32 v[90:91], v[38:39], v[86:87] neg_lo:[0,1]
    v_pk_add_f32 v[38:39], v[38:39], v[86:87] neg_hi:[0,1]
    v_pk_mul_f32 v[40:41], v[90:91], v[88:89] op_sel:[0,0] op_sel_hi:[0,1] neg_hi:[0,0]
    v_pk_fma_f32 v[86:87], v[90:91], v[88:89], v[40:41] op_sel:[1,1,0] op_sel_hi:[1,0,1] neg_lo:[0,1,0]
    v_pk_add_f32 v[38:39], v[38:39], v[86:87] op_sel:[0,1] op_sel_hi:[1,0] neg_lo:[0,1]
    v_pk_add_f32 v[40:41], v[8:9], v[16:17]
    v_pk_add_f32 v[16:17], v[8:9], v[16:17] neg_lo:[0,1] neg_hi:[0,1]
    v_pk_add_f32 v[8:9], v[10:11], v[18:19]
    v_pk_add_f32 v[18:19], v[10:11], v[18:19] neg_lo:[0,1] neg_hi:[0,1]
    v_pk_mul_f32 v[42:43], v[18:19], s[12:13] op_sel:[0,0] op_sel_hi:[0,1] neg_lo:[0,0] neg_hi:[0,0]
    v_pk_fma_f32 v[18:19], v[18:19], s[12:13], v[42:43] op_sel:[1,1,0] op_sel_hi:[1,0,1] neg_lo:[0,1,0] neg_hi:[0,0,0]
    v_pk_add_f32 v[10:11], v[12:13], v[20:21]
    v_pk_add_f32 v[20:21], v[12:13], v[20:21] op_sel:[1,1] op_sel_hi:[0,0] neg_lo:[1,0] neg_hi:[0,1]
    v_pk_add_f32 v[12:13], v[14:15], v[22:23]
    v_pk_add_f32 v[22:23], v[14:15], v[22:23] neg_lo:[0,1] neg_hi:[0,1]
    v_pk_mul_f32 v[42:43], v[22:23], s[12:13] op_sel:[0,0] op_sel_hi:[0,1] neg_lo:[0,1] neg_hi:[0,0]
    v_pk_fma_f32 v[22:23], v[22:23], s[12:13], v[42:43] op_sel:[1,1,0] op_sel_hi:[1,0,1] neg_lo:[0,1,0] neg_hi:[0,1,0]
    v_pk_add_f32 v[14:15], v[40:41], v[10:11]
    v_pk_add_f32 v[10:11], v[40:41], v[10:11] neg_lo:[0,1] neg_hi:[0,1]
    v_pk_add_f32 v[40:41], v[8:9], v[12:13]
    v_pk_add_f32 v[12:13], v[8:9], v[12:13] op_sel:[1,1] op_sel_hi:[0,0] neg_lo:[1,0] neg_hi:[0,1]
    v_pk_add_f32 v[8:9], v[14:15], v[40:41]
    v_pk_add_f32 v[40:41], v[14:15], v[40:41] neg_lo:[0,1] neg_hi:[0,1]
    v_pk_add_f32 v[14:15], v[10:11], v[12:13]
    v_pk_add_f32 v[12:13], v[10:11], v[12:13] neg_lo:[0,1] neg_hi:[0,1]
    v_pk_add_f32 v[10:11], v[16:17], v[20:21]
    v_pk_add_f32 v[20:21], v[16:17], v[20:21] neg_lo:[0,1] neg_hi:[0,1]
    v_pk_add_f32 v[16:17], v[18:19], v[22:23]
    v_pk_add_f32 v[22:23], v[18:19], v[22:23] op_sel:[1,1] op_sel_hi:[0,0] neg_lo:[1,0] neg_hi:[0,1]
    v_pk_add_f32 v[18:19], v[10:11], v[16:17]
    v_pk_add_f32 v[16:17], v[10:11], v[16:17] neg_lo:[0,1] neg_hi:[0,1]
    v_pk_add_f32 v[10:11], v[20:21], v[22:23]
    v_pk_add_f32 v[22:23], v[20:21], v[22:23] neg_lo:[0,1] neg_hi:[0,1]
    v_pk_mul_f32 v[42:43], v[18:19], v[44:45] op_sel:[0,0] op_sel_hi:[0,1] neg_hi:[0,1]
    v_pk_fma_f32 v[18:19], v[18:19], v[44:45], v[42:43] op_sel:[1,1,0] op_sel_hi:[1,0,1] neg_lo:[0,0,0]
    v_pk_mul_f32 v[42:43], v[14:15], v[46:47] op_sel:[0,0] op_sel_hi:[0,1] neg_hi:[0,1]
    v_pk_fma_f32 v[14:15], v[14:15], v[46:47], v[42:43] op_sel:[1,1,0] op_sel_hi:[1,0,1] neg_lo:[0,0,0]
    v_pk_mul_f32 v[42:43], v[10:11], v[48:49] op_sel:[0,0] op_sel_hi:[0,1] neg_hi:[0,1]
    v_pk_fma_f32 v[10:11], v[10:11], v[48:49], v[42:43] op_sel:[1,1,0] op_sel_hi:[1,0,1] neg_lo:[0,0,0]
    v_pk_mul_f32 v[42:43], v[40:41], v[50:51] op_sel:[0,0] op_sel_hi:[0,1] neg_hi:[0,1]
    v_pk_fma_f32 v[40:41], v[40:41], v[50:51], v[42:43] op_sel:[1,1,0] op_sel_hi:[1,0,1] neg_lo:[0,0,0]
    v_pk_mul_f32 v[42:43], v[16:17], v[52:53] op_sel:[0,0] op_sel_hi:[0,1] neg_hi:[0,1]
    v_pk_fma_f32 v[16:17], v[16:17], v[52:53], v[42:43] op_sel:[1,1,0] op_sel_hi:[1,0,1] neg_lo:[0,0,0]
    v_pk_mul_f32 v[42:43], v[12:13], v[54:55] op_sel:[0,0] op_sel_hi:[0,1] neg_hi:[0,1]
    v_pk_fma_f32 v[12:13], v[12:13], v[54:55], v[42:43] op_sel:[1,1,0] op_sel_hi:[1,0,1] neg_lo:[0,0,0]
    v_pk_mul_f32 v[42:43], v[22:23], v[56:57] op_sel:[0,0] op_sel_hi:[0,1] neg_hi:[0,1]
    v_pk_fma_f32 v[22:23], v[22:23], v[56:57], v[42:43] op_sel:[1,1,0] op_sel_hi:[1,0,1] neg_lo:[0,0,0]
    ds_write_b64 v76, v[8:9] offset:0
    ds_write_b64 v76, v[18:19] offset:576
    ds_write_b64 v76, v[14:15] offset:1152
    ds_write_b64 v76, v[10:11] offset:1728
    ds_write_b64 v76, v[40:41] offset:2304
    ds_write_b64 v76, v[16:17] offset:2880
    ds_write_b64 v76, v[12:13] offset:3456
    ds_write_b64 v76, v[22:23] offset:4032
    v_pk_add_f32 v[20:21], v[24:25], v[32:33]
    v_pk_add_f32 v[32:33], v[24:25], v[32:33] neg_lo:[0,1] neg_hi:[0,1]
    v_pk_add_f32 v[24:25], v[26:27], v[34:35]
    v_pk_add_f32 v[34:35], v[26:27], v[34:35] neg_lo:[0,1] neg_hi:[0,1]
    v_pk_mul_f32 v[42:43], v[34:35], s[12:13] op_sel:[0,0] op_sel_hi:[0,1] neg_lo:[0,0] neg_hi:[0,0]
    v_pk_fma_f32 v[34:35], v[34:35], s[12:13], v[42:43] op_sel:[1,1,0] op_sel_hi:[1,0,1] neg_lo:[0,1,0] neg_hi:[0,0,0]
    v_pk_add_f32 v[26:27], v[28:29], v[36:37]
    v_pk_add_f32 v[36:37], v[28:29], v[36:37] op_sel:[1,1] op_sel_hi:[0,0] neg_lo:[1,0] neg_hi:[0,1]
    v_pk_add_f32 v[28:29], v[30:31], v[38:39]
    v_pk_add_f32 v[38:39], v[30:31], v[38:39] neg_lo:[0,1] neg_hi:[0,1]
    v_pk_mul_f32 v[42:43], v[38:39], s[12:13] op_sel:[0,0] op_sel_hi:[0,1] neg_lo:[0,1] neg_hi:[0,0]
    v_pk_fma_f32 v[38:39], v[38:39], s[12:13], v[42:43] op_sel:[1,1,0] op_sel_hi:[1,0,1] neg_lo:[0,1,0] neg_hi:[0,1,0]
    v_pk_add_f32 v[30:31], v[20:21], v[26:27]
    v_pk_add_f32 v[26:27], v[20:21], v[26:27] neg_lo:[0,1] neg_hi:[0,1]
    v_pk_add_f32 v[20:21], v[24:25], v[28:29]
    v_pk_add_f32 v[28:29], v[24:25], v[28:29] op_sel:[1,1] op_sel_hi:[0,0] neg_lo:[1,0] neg_hi:[0,1]
    v_pk_add_f32 v[24:25], v[30:31], v[20:21]
    v_pk_add_f32 v[20:21], v[30:31], v[20:21] neg_lo:[0,1] neg_hi:[0,1]
    v_pk_add_f32 v[30:31], v[26:27], v[28:29]
    v_pk_add_f32 v[28:29], v[26:27], v[28:29] neg_lo:[0,1] neg_hi:[0,1]
    v_pk_add_f32 v[26:27], v[32:33], v[36:37]
    v_pk_add_f32 v[36:37], v[32:33], v[36:37] neg_lo:[0,1] neg_hi:[0,1]
    v_pk_add_f32 v[32:33], v[34:35], v[38:39]
    v_pk_add_f32 v[38:39], v[34:35], v[38:39] op_sel:[1,1] op_sel_hi:[0,0] neg_lo:[1,0] neg_hi:[0,1]
    v_pk_add_f32 v[34:35], v[26:27], v[32:33]
    v_pk_add_f32 v[32:33], v[26:27], v[32:33] neg_lo:[0,1] neg_hi:[0,1]
    v_pk_add_f32 v[26:27], v[36:37], v[38:39]
    v_pk_add_f32 v[38:39], v[36:37], v[38:39] neg_lo:[0,1] neg_hi:[0,1]
    v_pk_mul_f32 v[42:43], v[34:35], v[44:45] op_sel:[0,0] op_sel_hi:[0,1] neg_hi:[0,1]
    v_pk_fma_f32 v[34:35], v[34:35], v[44:45], v[42:43] op_sel:[1,1,0] op_sel_hi:[1,0,1] neg_lo:[0,0,0]
    v_pk_mul_f32 v[42:43], v[30:31], v[46:47] op_sel:[0,0] op_sel_hi:[0,1] neg_hi:[0,1]
    v_pk_fma_f32 v[30:31], v[30:31], v[46:47], v[42:43] op_sel:[1,1,0] op_sel_hi:[1,0,1] neg_lo:[0,0,0]
    v_pk_mul_f32 v[42:43], v[26:27], v[48:49] op_sel:[0,0] op_sel_hi:[0,1] neg_hi:[0,1]
    v_pk_fma_f32 v[26:27], v[26:27], v[48:49], v[42:43] op_sel:[1,1,0] op_sel_hi:[1,0,1] neg_lo:[0,0,0]
    v_pk_mul_f32 v[42:43], v[20:21], v[50:51] op_sel:[0,0] op_sel_hi:[0,1] neg_hi:[0,1]
    v_pk_fma_f32 v[20:21], v[20:21], v[50:51], v[42:43] op_sel:[1,1,0] op_sel_hi:[1,0,1] neg_lo:[0,0,0]
    v_pk_mul_f32 v[42:43], v[32:33], v[52:53] op_sel:[0,0] op_sel_hi:[0,1] neg_hi:[0,1]
    v_pk_fma_f32 v[32:33], v[32:33], v[52:53], v[42:43] op_sel:[1,1,0] op_sel_hi:[1,0,1] neg_lo:[0,0,0]
    v_pk_mul_f32 v[42:43], v[28:29], v[54:55] op_sel:[0,0] op_sel_hi:[0,1] neg_hi:[0,1]
    v_pk_fma_f32 v[28:29], v[28:29], v[54:55], v[42:43] op_sel:[1,1,0] op_sel_hi:[1,0,1] neg_lo:[0,0,0]
    v_pk_mul_f32 v[42:43], v[38:39], v[56:57] op_sel:[0,0] op_sel_hi:[0,1] neg_hi:[0,1]
    v_pk_fma_f32 v[38:39], v[38:39], v[56:57], v[42:43] op_sel:[1,1,0] op_sel_hi:[1,0,1] neg_lo:[0,0,0]
    ds_write_b64 v76, v[24:25] offset:4640
    ds_write_b64 v76, v[34:35] offset:5216
    ds_write_b64 v76, v[30:31] offset:5792
    ds_write_b64 v76, v[26:27] offset:6368
    ds_write_b64 v76, v[20:21] offset:6944
    ds_write_b64 v76, v[32:33] offset:7520
    ds_write_b64 v76, v[28:29] offset:8096
    ds_write_b64 v76, v[38:39] offset:8672
    s_waitcnt lgkmcnt(0)
    ds_read_b64 v[8:9], v77 offset:0
    ds_read_b64 v[18:19], v77 offset:64
    ds_read_b64 v[14:15], v77 offset:128
    ds_read_b64 v[10:11], v77 offset:192
    ds_read_b64 v[40:41], v77 offset:256
    ds_read_b64 v[16:17], v77 offset:320
    ds_read_b64 v[12:13], v77 offset:384
    ds_read_b64 v[22:23], v77 offset:448
    ds_read_b64 v[24:25], v77 offset:4640
    ds_read_b64 v[34:35], v77 offset:4704
    ds_read_b64 v[30:31], v77 offset:4768
    ds_read_b64 v[26:27], v77 offset:4832
    ds_read_b64 v[20:21], v77 offset:4896
    ds_read_b64 v[32:33], v77 offset:4960
    ds_read_b64 v[28:29], v77 offset:5024
    ds_read_b64 v[38:39], v77 offset:5088
    s_waitcnt lgkmcnt(0)
    v_pk_add_f32 v[36:37], v[8:9], v[40:41]
    v_pk_add_f32 v[40:41], v[8:9], v[40:41] neg_lo:[0,1] neg_hi:[0,1]
    v_pk_add_f32 v[8:9], v[18:19], v[16:17]
    v_pk_add_f32 v[16:17], v[18:19], v[16:17] neg_lo:[0,1] neg_hi:[0,1]
    v_pk_mul_f32 v[42:43], v[16:17], s[12:13] op_sel:[0,0] op_sel_hi:[0,1] neg_lo:[0,0] neg_hi:[0,0]
    v_pk_fma_f32 v[16:17], v[16:17], s[12:13], v[42:43] op_sel:[1,1,0] op_sel_hi:[1,0,1] neg_lo:[0,1,0] neg_hi:[0,0,0]
    v_pk_add_f32 v[18:19], v[14:15], v[12:13]
    v_pk_add_f32 v[12:13], v[14:15], v[12:13] op_sel:[1,1] op_sel_hi:[0,0] neg_lo:[1,0] neg_hi:[0,1]
    v_pk_add_f32 v[14:15], v[10:11], v[22:23]
    v_pk_add_f32 v[22:23], v[10:11], v[22:23] neg_lo:[0,1] neg_hi:[0,1]
    v_pk_mul_f32 v[42:43], v[22:23], s[12:13] op_sel:[0,0] op_sel_hi:[0,1] neg_lo:[0,1] neg_hi:[0,0]
    v_pk_fma_f32 v[22:23], v[22:23], s[12:13], v[42:43] op_sel:[1,1,0] op_sel_hi:[1,0,1] neg_lo:[0,1,0] neg_hi:[0,1,0]
    v_pk_add_f32 v[10:11], v[36:37], v[18:19]
    v_pk_add_f32 v[18:19], v[36:37], v[18:19] neg_lo:[0,1] neg_hi:[0,1]
    v_pk_add_f32 v[36:37], v[8:9], v[14:15]
    v_pk_add_f32 v[14:15], v[8:9], v[14:15] op_sel:[1,1] op_sel_hi:[0,0] neg_lo:[1,0] neg_hi:[0,1]
    v_pk_add_f32 v[8:9], v[10:11], v[36:37]
    v_pk_add_f32 v[36:37], v[10:11], v[36:37] neg_lo:[0,1] neg_hi:[0,1]
    v_pk_add_f32 v[10:11], v[18:19], v[14:15]
    v_pk_add_f32 v[14:15], v[18:19], v[14:15] neg_lo:[0,1] neg_hi:[0,1]
    v_pk_add_f32 v[18:19], v[40:41], v[12:13]
    v_pk_add_f32 v[12:13], v[40:41], v[12:13] neg_lo:[0,1] neg_hi:[0,1]
    v_pk_add_f32 v[40:41], v[16:17], v[22:23]
    v_pk_add_f32 v[22:23], v[16:17], v[22:23] op_sel:[1,1] op_sel_hi:[0,0] neg_lo:[1,0] neg_hi:[0,1]
    v_pk_add_f32 v[16:17], v[18:19], v[40:41]
    v_pk_add_f32 v[40:41], v[18:19], v[40:41] neg_lo:[0,1] neg_hi:[0,1]
    v_pk_add_f32 v[18:19], v[12:13], v[22:23]
    v_pk_add_f32 v[22:23], v[12:13], v[22:23] neg_lo:[0,1] neg_hi:[0,1]
    v_pk_mul_f32 v[42:43], v[16:17], v[58:59] op_sel:[0,0] op_sel_hi:[0,1] neg_hi:[0,1]
    v_pk_fma_f32 v[16:17], v[16:17], v[58:59], v[42:43] op_sel:[1,1,0] op_sel_hi:[1,0,1] neg_lo:[0,0,0]
    v_pk_mul_f32 v[42:43], v[10:11], v[60:61] op_sel:[0,0] op_sel_hi:[0,1] neg_hi:[0,1]
    v_pk_fma_f32 v[10:11], v[10:11], v[60:61], v[42:43] op_sel:[1,1,0] op_sel_hi:[1,0,1] neg_lo:[0,0,0]
    v_pk_mul_f32 v[42:43], v[18:19], v[62:63] op_sel:[0,0] op_sel_hi:[0,1] neg_hi:[0,1]
    v_pk_fma_f32 v[18:19], v[18:19], v[62:63], v[42:43] op_sel:[1,1,0] op_sel_hi:[1,0,1] neg_lo:[0,0,0]
    v_pk_mul_f32 v[42:43], v[36:37], v[64:65] op_sel:[0,0] op_sel_hi:[0,1] neg_hi:[0,1]
    v_pk_fma_f32 v[36:37], v[36:37], v[64:65], v[42:43] op_sel:[1,1,0] op_sel_hi:[1,0,1] neg_lo:[0,0,0]
    v_pk_mul_f32 v[42:43], v[40:41], v[66:67] op_sel:[0,0] op_sel_hi:[0,1] neg_hi:[0,1]
    v_pk_fma_f32 v[40:41], v[40:41], v[66:67], v[42:43] op_sel:[1,1,0] op_sel_hi:[1,0,1] neg_lo:[0,0,0]
    v_pk_mul_f32 v[42:43], v[14:15], v[68:69] op_sel:[0,0] op_sel_hi:[0,1] neg_hi:[0,1]
    v_pk_fma_f32 v[14:15], v[14:15], v[68:69], v[42:43] op_sel:[1,1,0] op_sel_hi:[1,0,1] neg_lo:[0,0,0]
    v_pk_mul_f32 v[42:43], v[22:23], v[70:71] op_sel:[0,0] op_sel_hi:[0,1] neg_hi:[0,1]
    v_pk_fma_f32 v[22:23], v[22:23], v[70:71], v[42:43] op_sel:[1,1,0] op_sel_hi:[1,0,1] neg_lo:[0,0,0]
    ds_write_b64 v78, v[8:9] offset:0
    ds_write_b64 v78, v[16:17] offset:520
    ds_write_b64 v78, v[10:11] offset:1040
    ds_write_b64 v78, v[18:19] offset:1560
    ds_write_b64 v78, v[36:37] offset:2080
    ds_write_b64 v78, v[40:41] offset:2600
    ds_write_b64 v78, v[14:15] offset:3120
    ds_write_b64 v78, v[22:23] offset:3640
    v_pk_add_f32 v[12:13], v[24:25], v[20:21]
    v_pk_add_f32 v[20:21], v[24:25], v[20:21] neg_lo:[0,1] neg_hi:[0,1]
    v_pk_add_f32 v[24:25], v[34:35], v[32:33]
    v_pk_add_f32 v[32:33], v[34:35], v[32:33] neg_lo:[0,1] neg_hi:[0,1]
    v_pk_mul_f32 v[42:43], v[32:33], s[12:13] op_sel:[0,0] op_sel_hi:[0,1] neg_lo:[0,0] neg_hi:[0,0]
    v_pk_fma_f32 v[32:33], v[32:33], s[12:13], v[42:43] op_sel:[1,1,0] op_sel_hi:[1,0,1] neg_lo:[0,1,0] neg_hi:[0,0,0]
    v_pk_add_f32 v[34:35], v[30:31], v[28:29]
    v_pk_add_f32 v[28:29], v[30:31], v[28:29] op_sel:[1,1] op_sel_hi:[0,0] neg_lo:[1,0] neg_hi:[0,1]
    v_pk_add_f32 v[30:31], v[26:27], v[38:39]
    v_pk_add_f32 v[38:39], v[26:27], v[38:39] neg_lo:[0,1] neg_hi:[0,1]
    v_pk_mul_f32 v[42:43], v[38:39], s[12:13] op_sel:[0,0] op_sel_hi:[0,1] neg_lo:[0,1] neg_hi:[0,0]
    v_pk_fma_f32 v[38:39], v[38:39], s[12:13], v[42:43] op_sel:[1,1,0] op_sel_hi:[1,0,1] neg_lo:[0,1,0] neg_hi:[0,1,0]
    v_pk_add_f32 v[26:27], v[12:13], v[34:35]
    v_pk_add_f32 v[34:35], v[12:13], v[34:35] neg_lo:[0,1] neg_hi:[0,1]
    v_pk_add_f32 v[12:13], v[24:25], v[30:31]
    v_pk_add_f32 v[30:31], v[24:25], v[30:31] op_sel:[1,1] op_sel_hi:[0,0] neg_lo:[1,0] neg_hi:[0,1]
    v_pk_add_f32 v[24:25], v[26:27], v[12:13]
    v_pk_add_f32 v[12:13], v[26:27], v[12:13] neg_lo:[0,1] neg_hi:[0,1]
    v_pk_add_f32 v[26:27], v[34:35], v[30:31]
    v_pk_add_f32 v[30:31], v[34:35], v[30:31] neg_lo:[0,1] neg_hi:[0,1]
    v_pk_add_f32 v[34:35], v[20:21], v[28:29]
    v_pk_add_f32 v[28:29], v[20:21], v[28:29] neg_lo:[0,1] neg_hi:[0,1]
    v_pk_add_f32 v[20:21], v[32:33], v[38:39]
    v_pk_add_f32 v[38:39], v[32:33], v[38:39] op_sel:[1,1] op_sel_hi:[0,0] neg_lo:[1,0] neg_hi:[0,1]
    v_pk_add_f32 v[32:33], v[34:35], v[20:21]
    v_pk_add_f32 v[20:21], v[34:35], v[20:21] neg_lo:[0,1] neg_hi:[0,1]
    v_pk_add_f32 v[34:35], v[28:29], v[38:39]
    v_pk_add_f32 v[38:39], v[28:29], v[38:39] neg_lo:[0,1] neg_hi:[0,1]
    v_pk_mul_f32 v[42:43], v[32:33], v[58:59] op_sel:[0,0] op_sel_hi:[0,1] neg_hi:[0,1]
    v_pk_fma_f32 v[32:33], v[32:33], v[58:59], v[42:43] op_sel:[1,1,0] op_sel_hi:[1,0,1] neg_lo:[0,0,0]
    v_pk_mul_f32 v[42:43], v[26:27], v[60:61] op_sel:[0,0] op_sel_hi:[0,1] neg_hi:[0,1]
    v_pk_fma_f32 v[26:27], v[26:27], v[60:61], v[42:43] op_sel:[1,1,0] op_sel_hi:[1,0,1] neg_lo:[0,0,0]
    v_pk_mul_f32 v[42:43], v[34:35], v[62:63] op_sel:[0,0] op_sel_hi:[0,1] neg_hi:[0,1]
    v_pk_fma_f32 v[34:35], v[34:35], v[62:63], v[42:43] op_sel:[1,1,0] op_sel_hi:[1,0,1] neg_lo:[0,0,0]
    v_pk_mul_f32 v[42:43], v[12:13], v[64:65] op_sel:[0,0] op_sel_hi:[0,1] neg_hi:[0,1]
    v_pk_fma_f32 v[12:13], v[12:13], v[64:65], v[42:43] op_sel:[1,1,0] op_sel_hi:[1,0,1] neg_lo:[0,0,0]
    v_pk_mul_f32 v[42:43], v[20:21], v[66:67] op_sel:[0,0] op_sel_hi:[0,1] neg_hi:[0,1]
    v_pk_fma_f32 v[20:21], v[20:21], v[66:67], v[42:43] op_sel:[1,1,0] op_sel_hi:[1,0,1] neg_lo:[0,0,0]
    v_pk_mul_f32 v[42:43], v[30:31], v[68:69] op_sel:[0,0] op_sel_hi:[0,1] neg_hi:[0,1]
    v_pk_fma_f32 v[30:31], v[30:31], v[68:69], v[42:43] op_sel:[1,1,0] op_sel_hi:[1,0,1] neg_lo:[0,0,0]
    v_pk_mul_f32 v[42:43], v[38:39], v[70:71] op_sel:[0,0] op_sel_hi:[0,1] neg_hi:[0,1]
    v_pk_fma_f32 v[38:39], v[38:39], v[70:71], v[42:43] op_sel:[1,1,0] op_sel_hi:[1,0,1] neg_lo:[0,0,0]
    ds_write_b64 v78, v[24:25] offset:4640
    ds_write_b64 v78, v[32:33] offset:5160
    ds_write_b64 v78, v[26:27] offset:5680
    ds_write_b64 v78, v[34:35] offset:6200
    ds_write_b64 v78, v[12:13] offset:6720
    ds_write_b64 v78, v[20:21] offset:7240
    ds_write_b64 v78, v[30:31] offset:7760
    ds_write_b64 v78, v[38:39] offset:8280
    s_waitcnt lgkmcnt(0)
    ds_read_b64 v[8:9], v79 offset:0
    ds_read_b64 v[16:17], v79 offset:8
    ds_read_b64 v[10:11], v79 offset:16
    ds_read_b64 v[18:19], v79 offset:24
    ds_read_b64 v[36:37], v79 offset:32
    ds_read_b64 v[40:41], v79 offset:40
    ds_read_b64 v[14:15], v79 offset:48
    ds_read_b64 v[22:23], v79 offset:56
    ds_read_b64 v[24:25], v79 offset:4640
    ds_read_b64 v[32:33], v79 offset:4648
    ds_read_b64 v[26:27], v79 offset:4656
    ds_read_b64 v[34:35], v79 offset:4664
    ds_read_b64 v[12:13], v79 offset:4672
    ds_read_b64 v[20:21], v79 offset:4680
    ds_read_b64 v[30:31], v79 offset:4688
    ds_read_b64 v[38:39], v79 offset:4696
    s_waitcnt lgkmcnt(0)
    v_pk_add_f32 v[28:29], v[8:9], v[36:37]
    v_pk_add_f32 v[36:37], v[8:9], v[36:37] neg_lo:[0,1] neg_hi:[0,1]
    v_pk_add_f32 v[8:9], v[16:17], v[40:41]
    v_pk_add_f32 v[40:41], v[16:17], v[40:41] neg_lo:[0,1] neg_hi:[0,1]
    v_pk_mul_f32 v[42:43], v[40:41], s[12:13] op_sel:[0,0] op_sel_hi:[0,1] neg_lo:[0,0] neg_hi:[0,0]
    v_pk_fma_f32 v[40:41], v[40:41], s[12:13], v[42:43] op_sel:[1,1,0] op_sel_hi:[1,0,1] neg_lo:[0,1,0] neg_hi:[0,0,0]
    v_pk_add_f32 v[16:17], v[10:11], v[14:15]
    v_pk_add_f32 v[14:15], v[10:11], v[14:15] op_sel:[1,1] op_sel_hi:[0,0] neg_lo:[1,0] neg_hi:[0,1]
    v_pk_add_f32 v[10:11], v[18:19], v[22:23]
    v_pk_add_f32 v[22:23], v[18:19], v[22:23] neg_lo:[0,1] neg_hi:[0,1]
    v_pk_mul_f32 v[42:43], v[22:23], s[12:13] op_sel:[0,0] op_sel_hi:[0,1] neg_lo:[0,1] neg_hi:[0,0]
    v_pk_fma_f32 v[22:23], v[22:23], s[12:13], v[42:43] op_sel:[1,1,0] op_sel_hi:[1,0,1] neg_lo:[0,1,0] neg_hi:[0,1,0]
    v_pk_add_f32 v[18:19], v[28:29], v[16:17]
    v_pk_add_f32 v[16:17], v[28:29], v[16:17] neg_lo:[0,1] neg_hi:[0,1]
    v_pk_add_f32 v[28:29], v[8:9], v[10:11]
    v_pk_add_f32 v[10:11], v[8:9], v[10:11] op_sel:[1,1] op_sel_hi:[0,0] neg_lo:[1,0] neg_hi:[0,1]
    v_pk_add_f32 v[8:9], v[18:19], v[28:29]
    v_pk_add_f32 v[28:29], v[18:19], v[28:29] neg_lo:[0,1] neg_hi:[0,1]
    v_pk_add_f32 v[18:19], v[16:17], v[10:11]
    v_pk_add_f32 v[10:11], v[16:17], v[10:11] neg_lo:[0,1] neg_hi:[0,1]
    v_pk_add_f32 v[16:17], v[36:37], v[14:15]
    v_pk_add_f32 v[14:15], v[36:37], v[14:15] neg_lo:[0,1] neg_hi:[0,1]
    v_pk_add_f32 v[36:37], v[40:41], v[22:23]
    v_pk_add_f32 v[22:23], v[40:41], v[22:23] op_sel:[1,1] op_sel_hi:[0,0] neg_lo:[1,0] neg_hi:[0,1]
    v_pk_add_f32 v[40:41], v[16:17], v[36:37]
    v_pk_add_f32 v[36:37], v[16:17], v[36:37] neg_lo:[0,1] neg_hi:[0,1]
    v_pk_add_f32 v[16:17], v[14:15], v[22:23]
    v_pk_add_f32 v[22:23], v[14:15], v[22:23] neg_lo:[0,1] neg_hi:[0,1]
    v_pk_add_f32 v[14:15], v[24:25], v[12:13]
    v_pk_add_f32 v[12:13], v[24:25], v[12:13] neg_lo:[0,1] neg_hi:[0,1]
    v_pk_add_f32 v[24:25], v[32:33], v[20:21]
    v_pk_add_f32 v[20:21], v[32:33], v[20:21] neg_lo:[0,1] neg_hi:[0,1]
    v_pk_mul_f32 v[42:43], v[20:21], s[12:13] op_sel:[0,0] op_sel_hi:[0,1] neg_lo:[0,0] neg_hi:[0,0]
    v_pk_fma_f32 v[20:21], v[20:21], s[12:13], v[42:43] op_sel:[1,1,0] op_sel_hi:[1,0,1] neg_lo:[0,1,0] neg_hi:[0,0,0]
    v_pk_add_f32 v[32:33], v[26:27], v[30:31]
    v_pk_add_f32 v[30:31], v[26:27], v[30:31] op_sel:[1,1] op_sel_hi:[0,0] neg_lo:[1,0] neg_hi:[0,1]
    v_pk_add_f32 v[26:27], v[34:35], v[38:39]
    v_pk_add_f32 v[38:39], v[34:35], v[38:39] neg_lo:[0,1] neg_hi:[0,1]
    v_pk_mul_f32 v[42:43], v[38:39], s[12:13] op_sel:[0,0] op_sel_hi:[0,1] neg_lo:[0,1] neg_hi:[0,0]
    v_pk_fma_f32 v[38:39], v[38:39], s[12:13], v[42:43] op_sel:[1,1,0] op_sel_hi:[1,0,1] neg_lo:[0,1,0] neg_hi:[0,1,0]
    v_pk_add_f32 v[34:35], v[14:15], v[32:33]
    v_pk_add_f32 v[32:33], v[14:15], v[32:33] neg_lo:[0,1] neg_hi:[0,1]
    v_pk_add_f32 v[14:15], v[24:25], v[26:27]
    v_pk_add_f32 v[26:27], v[24:25], v[26:27] op_sel:[1,1] op_sel_hi:[0,0] neg_lo:[1,0] neg_hi:[0,1]
    v_pk_add_f32 v[24:25], v[34:35], v[14:15]
    v_pk_add_f32 v[14:15], v[34:35], v[14:15] neg_lo:[0,1] neg_hi:[0,1]
    v_pk_add_f32 v[34:35], v[32:33], v[26:27]
    v_pk_add_f32 v[26:27], v[32:33], v[26:27] neg_lo:[0,1] neg_hi:[0,1]
    v_pk_add_f32 v[32:33], v[12:13], v[30:31]
    v_pk_add_f32 v[30:31], v[12:13], v[30:31] neg_lo:[0,1] neg_hi:[0,1]
    v_pk_add_f32 v[12:13], v[20:21], v[38:39]
    v_pk_add_f32 v[38:39], v[20:21], v[38:39] op_sel:[1,1] op_sel_hi:[0,0] neg_lo:[1,0] neg_hi:[0,1]
    v_pk_add_f32 v[20:21], v[32:33], v[12:13]
    v_pk_add_f32 v[12:13], v[32:33], v[12:13] neg_lo:[0,1] neg_hi:[0,1]
    v_pk_add_f32 v[32:33], v[30:31], v[38:39]
    v_pk_add_f32 v[38:39], v[30:31], v[38:39] neg_lo:[0,1] neg_hi:[0,1]
    v_lshlrev_b32 v82, 13, v2
    v_lshl_add_u32 v82, v1, 2, v82
    s_lshl_b32 s20, s2, 15
    s_add_u32 s21, s20, 4096
    v_cvt_pk_bf16_f32 v8, v8, v9
    buffer_store_dword v8, v82, s[4:7], s20 offen offset:2048
    v_cvt_pk_bf16_f32 v40, v40, v41
    buffer_store_dword v40, v82, s[4:7], s20 offen offset:2304
    v_cvt_pk_bf16_f32 v18, v18, v19
    buffer_store_dword v18, v82, s[4:7], s20 offen offset:2560
    v_cvt_pk_bf16_f32 v16, v16, v17
    buffer_store_dword v16, v82, s[4:7], s20 offen offset:2816
    v_cvt_pk_bf16_f32 v28, v28, v29
    buffer_store_dword v28, v82, s[4:7], s20 offen offset:3072
    v_cvt_pk_bf16_f32 v36, v36, v37
    buffer_store_dword v36, v82, s[4:7], s20 offen offset:3328
    v_cvt_pk_bf16_f32 v10, v10, v11
    buffer_store_dword v10, v82, s[4:7], s20 offen offset:3584
    v_cvt_pk_bf16_f32 v22, v22, v23
    buffer_store_dword v22, v82, s[4:7], s20 offen offset:3840
    v_cvt_pk_bf16_f32 v24, v24, v25
    buffer_store_dword v24, v82, s[4:7], s21 offen offset:2048
    v_cvt_pk_bf16_f32 v20, v20, v21
    buffer_store_dword v20, v82, s[4:7], s21 offen offset:2304
    v_cvt_pk_bf16_f32 v34, v34, v35
    buffer_store_dword v34, v82, s[4:7], s21 offen offset:2560
    v_cvt_pk_bf16_f32 v32, v32, v33
    buffer_store_dword v32, v82, s[4:7], s21 offen offset:2816
    v_cvt_pk_bf16_f32 v14, v14, v15
    buffer_store_dword v14, v82, s[4:7], s21 offen offset:3072
    v_cvt_pk_bf16_f32 v12, v12, v13
    buffer_store_dword v12, v82, s[4:7], s21 offen offset:3328
    v_cvt_pk_bf16_f32 v26, v26, v27
    buffer_store_dword v26, v82, s[4:7], s21 offen offset:3584
    v_cvt_pk_bf16_f32 v38, v38, v39
    buffer_store_dword v38, v82, s[4:7], s21 offen offset:3840
k3_kernel_b1_end:
    s_endpgm
.section .rodata,"a"
.p2align 6
.amdhsa_kernel k1_kernel
  .amdhsa_next_free_vgpr 120
  .amdhsa_next_free_sgpr 100
  .amdhsa_accum_offset 120
  .amdhsa_group_segment_fixed_size 0
  .amdhsa_kernarg_size 120
  .amdhsa_user_sgpr_count 2
  .amdhsa_user_sgpr_kernarg_segment_ptr 1
  .amdhsa_system_sgpr_workgroup_id_x 1
.end_amdhsa_kernel
.amdhsa_kernel k2_kernel
  .amdhsa_next_free_vgpr 128
  .amdhsa_next_free_sgpr 100
  .amdhsa_accum_offset 128
  .amdhsa_group_segment_fixed_size 0
  .amdhsa_kernarg_size 120
  .amdhsa_user_sgpr_count 2
  .amdhsa_user_sgpr_kernarg_segment_ptr 1
  .amdhsa_system_sgpr_workgroup_id_x 1
.end_amdhsa_kernel
.amdhsa_kernel k3_kernel
  .amdhsa_next_free_vgpr 168
  .amdhsa_next_free_sgpr 100
  .amdhsa_accum_offset 168
  .amdhsa_group_segment_fixed_size 0
  .amdhsa_kernarg_size 120
  .amdhsa_user_sgpr_count 2
  .amdhsa_user_sgpr_kernarg_segment_ptr 1
  .amdhsa_system_sgpr_workgroup_id_x 1
.end_amdhsa_kernel
```
